```python
import torch

def _softmax(x, axis=-1):
    return torch.softmax(x, dim=axis)
def _gelu(x):
    return torch.nn.functional.gelu(x, approximate="tanh")
def _silu(x):
    return torch.nn.functional.silu(x)
def _sigmoid(x):
    return torch.sigmoid(x)
def _layernorm(x, axis=-1, eps=1e-5):
    m = x.mean(dim=axis, keepdim=True)
    v = x.var(dim=axis, keepdim=True, unbiased=False)
    return (x - m) / torch.sqrt(v + eps)
def _scatter_add(tgt, idx, src, axis=0):
    return tgt.clone().index_add_(axis, idx, src)
def _segment_sum(src, seg, n):
    out = torch.zeros((n,) + src.shape[1:], dtype=src.dtype)
    return out.index_add_(0, seg, src)
def _pad(x, pw):
    flat = tuple(v for pair in reversed(pw) for v in pair)
    return torch.nn.functional.pad(x, flat)

kernel_name = 'gated_mix__ssm_conv_s4d__linear_kernel_hedgehog__prompt'

def setup_inputs():

    _w = (lambda a: (lambda t: t.to(torch.bfloat16) if t.is_floating_point() else t)(torch.as_tensor(a)))
    def _A_setup():
        Bsz, L, D, N = 1, 2048, 640, 128
        return {
            "u": _w((lambda *s: torch.randn(*s, dtype=torch.bfloat16) * 0.05)(Bsz, L, D)),
            "log_A_real": _w((lambda *s: torch.randn(*s, dtype=torch.bfloat16) * 6.4)(D, N) * 0.5),
            "A_imag": _w((lambda *s: torch.randn(*s, dtype=torch.bfloat16) * 0.05)(D, N) * 3.14),
            "C_real": _w((lambda *s: torch.randn(*s, dtype=torch.bfloat16) * 0.2)(D, N) / N ** 0.5),
            "C_imag": _w((lambda *s: torch.randn(*s, dtype=torch.bfloat16) * 0.2)(D, N) / N ** 0.5),
            "log_dt": _w((lambda *s: torch.randn(*s, dtype=torch.bfloat16) * 0.05)(D) * 0.5 - 4.0),
            "D_skip": _w((lambda *s: torch.randn(*s, dtype=torch.bfloat16) * 0.05)(D)),
        }
    _A_in = _A_setup()

    def _B_setup():
        B, S, D, H = 1, 2048, 640, 32
        Dh = D // H
        return {
            "x": _w((lambda *s: torch.randn(*s, dtype=torch.bfloat16) * 0.05)(B, S, D)),
            "wqkv": _w((lambda *s: torch.randn(*s, dtype=torch.bfloat16) * 0.8)(D, 3 * D)),
            "w_phi": _w((lambda *s: torch.randn(*s, dtype=torch.bfloat16) * 0.8)(H, Dh, Dh) * (Dh ** -0.5)),
            "wo": _w((lambda *s: torch.randn(*s, dtype=torch.bfloat16) * 0.05)(D, D)),
        }
    _B_in = _B_setup()

    return {
        "A_u": _A_in["u"],
        "A_log_A_real": _A_in["log_A_real"],
        "A_A_imag": _A_in["A_imag"],
        "A_C_real": _A_in["C_real"],
        "A_C_imag": _A_in["C_imag"],
        "A_log_dt": _A_in["log_dt"],
        "A_D_skip": _A_in["D_skip"],
        "B_x": _B_in["x"],
        "B_wqkv": _B_in["wqkv"],
        "B_w_phi": _B_in["w_phi"],
        "B_wo": _B_in["wo"],
        "gate_w": _w((lambda *s: torch.randn(*s, dtype=torch.bfloat16) * 0.05)(640) * 16.0),
    }

def reference(A_u, A_log_A_real, A_A_imag, A_C_real, A_C_imag, A_log_dt, A_D_skip, B_x, B_wqkv, B_w_phi, B_wo, gate_w):
    def _A_ref(u, log_A_real, A_imag, C_real, C_imag, log_dt, D_skip):
        L = u.shape[1]
        dt = torch.exp(log_dt)
        A = -torch.exp(log_A_real) + 1j * A_imag
        C = (C_real + 1j * C_imag) * dt[:, None]
        pos = (lambda x, dt: x.to(dt))(torch.arange(L), log_dt.dtype)
        P = torch.exp((A * dt[:, None])[:, :, None] * pos[None, None, :])
        K = 2.0 * torch.einsum("dn,dnl->dl", C, P).real
        L2 = 2 * L
        u_t = (lambda x, *d: x.permute(*d))(u, 0, 2, 1)
        Kf = (lambda x, *a, **k: torch.fft.rfft(x.float(), *a, **k))(K, L2)
        Uf = (lambda x, *a, **k: torch.fft.rfft(x.float(), *a, **k))(u_t, L2)
        y = (lambda x, *a, **k: torch.fft.irfft(x, *a, **k).to(torch.bfloat16))(Uf * Kf[None, :, :], L2)[:, :, :L]
        y = (lambda x, *d: x.permute(*d))(y, 0, 2, 1)
        return y + u * D_skip[None, None, :]

    def _B_ref(x, wqkv, w_phi, wo):
        B, S, D = x.shape
        H = 32; Dh = D // H
        qkv = (lambda x, *d: x.permute(*d))((x @ wqkv).reshape(B, S, 3, H, Dh), 2, 0, 3, 1, 4)
        q, k, v = qkv[0], qkv[1], qkv[2]
        pq = torch.einsum("bhsd,hdf->bhsf", q, w_phi)
        pk = torch.einsum("bhsd,hdf->bhsf", k, w_phi)
        phi_q = torch.concatenate([_softmax(pq, axis=-1), _softmax(-pq, axis=-1)], axis=-1)
        phi_k = torch.concatenate([_softmax(pk, axis=-1), _softmax(-pk, axis=-1)], axis=-1)
        kv = torch.einsum("bhsf,bhsd->bhfd", phi_k, v)
        z  = torch.einsum("bhsf->bhf", phi_k)
        num = torch.einsum("bhqf,bhfd->bhqd", phi_q, kv)
        den = torch.einsum("bhqf,bhf->bhq", phi_q, z)[..., None] + 1e-6
        o = num / den
        return (lambda x, *d: x.permute(*d))(o, 0, 2, 1, 3).reshape(B, S, D) @ wo

    x = A_u
    g = _sigmoid((x * gate_w).sum(-1, keepdims=True))
    a = _A_ref(x, A_log_A_real, A_A_imag, A_C_real, A_C_imag, A_log_dt, A_D_skip)
    b = _B_ref(x, B_wqkv, B_w_phi, B_wo)
    return g * a + (1 - g) * b
```

```asm
; @launch grid=(256,1,1) block=(512,1,1) lds=163840
.amdgcn_target "amdgcn-amd-amdhsa--gfx950"
.text
.p2align 12
.globl gated_mix__ssm_conv_s4d__linear_kernel_hedgehog__prompt_kernel
.p2align 8
.type gated_mix__ssm_conv_s4d__linear_kernel_hedgehog__prompt_kernel,@function
gated_mix__ssm_conv_s4d__linear_kernel_hedgehog__prompt_kernel:
L_codebeg:
    s_load_dwordx2 s[28:29], s[0:1], 0
    s_load_dwordx2 s[32:33], s[0:1], 64
    v_readfirstlane_b32 s24, v0
    s_getpc_b64 s[74:75]
L_pc:
    s_lshr_b32 s73, s2, 3
    s_mul_i32 s73, s73, 2560
    v_lshrrev_b32 v2, 4, v0
    v_min_u32_e64 v2, 19, v2
    v_lshl_add_u32 v2, v2, 7, s73
    v_min_u32 v2, L_codeend - L_pc - 4, v2
    global_load_dword v255, v2, s[74:75]
    s_cmpk_ge_u32 s2, 176
    s_cbranch_scc1 L_conv
    s_cmpk_ge_u32 s24, 256
    s_cbranch_scc1 L_ldr
    s_cmpk_ge_u32 s2, 128
    s_cbranch_scc1 L_hot
    s_branch L_kv
L_ldr:
    s_setprio 3
    s_lshr_b32 s24, s24, 6
    s_and_b32 s22, s2, 7
    s_lshr_b32 s23, s2, 3
    s_and_b32 s26, s24, 3
    v_and_b32 v1, 63, v0
    v_lshrrev_b32 v2, 3, v1
    v_mul_u32_u24 v2, 1280, v2
    v_lshrrev_b32 v3, 4, v1
    v_and_b32 v4, 7, v1
    v_xor_b32_e64 v3, v3, v4
    v_lshl_add_u32 v10, v3, 4, v2
    s_mov_b32 s31, 0x20000
    s_mov_b32 s34, 2457600
    s_mov_b32 s35, 0x20000
    s_mul_i32 s46, s26, 61440
    s_mul_i32 s47, s22, 160
    s_add_u32 s46, s46, s47
    v_lshl_add_u32 v7, v1, 4, s46
    v_mul_u32_u24 v8, 6554, v1
    s_cmpk_ge_u32 s2, 128
    s_cbranch_scc1 L_q
    s_lshr_b32 s25, s23, 1
    s_and_b32 s25, s25, 7
    s_and_b32 s73, s22, 7
    s_add_u32 s25, s25, s73
    s_and_b32 s25, s25, 7
    s_mul_i32 s25, s25, 5
    s_lshr_b32 s25, s25, 2
    v_xor_b32_e64 v11, 64, v10
    s_lshl_b32 s40, s23, 2
    s_add_u32 s40, s40, s26
    s_mul_i32 s40, s40, 40960
    s_lshl_b32 s41, s26, 12
    s_mul_i32 s42, s26, 5120
    s_add_u32 s42, s42, 65536
    s_mov_b32 s43, s25
    s_mov_b32 s44, s25
    s_mov_b32 s30, 2621440
    s_movk_i32 s47, 1760
    s_movk_i32 s49, -640
    v_add_u32 v7, 1280, v7
    v_lshrrev_b32 v3, 16, v8
    v_and_b32_e64 v4, 1, v3
    v_mad_u32_u24 v12, v3, s47, v7
    v_mad_i32_i24 v12, v4, s49, v12
    v_add_u32 v8, 419456, v8
    v_add_u32 v7, 1024, v7
    v_lshrrev_b32 v3, 16, v8
    v_and_b32 v4, 1, v3
    v_mad_u32_u24 v13, v3, s47, v7
    v_mad_i32_i24 v13, v4, s49, v13
    v_add_u32 v8, 419456, v8
    v_add_u32 v7, 1024, v7
    v_lshrrev_b32 v3, 16, v8
    v_and_b32 v4, 1, v3
    v_mad_u32_u24 v14, v3, s47, v7
    s_movk_i32 s49, -1920
    s_movk_i32 s48, 1280
    v_lshrrev_b32 v5, 4, v3
    v_xor_b32 v5, v5, v4
    v_mad_u32_u24 v14, v5, s48, v14
    v_mad_i32_i24 v14, v4, s49, v14
    v_add_u32 v8, 419456, v8
    v_add_u32 v7, 2304, v7
    v_lshrrev_b32 v3, 16, v8
    v_and_b32 v4, 1, v3
    v_mad_u32_u24 v15, v3, s47, v7
    s_movk_i32 s49, -3200
    v_mad_i32_i24 v15, v4, s49, v15
    v_add_u32 v8, 419456, v8
    v_add_u32 v7, 1024, v7
    v_lshrrev_b32 v3, 16, v8
    v_and_b32_e64 v4, 1, v3
    v_mad_u32_u24 v16, v3, s47, v7
    v_mad_i32_i24 v16, v4, s49, v16
    s_branch L_kvgo
L_q:
    s_mul_i32 s25, s23, 11
    s_sub_u32 s25, s25, 171
    s_lshr_b32 s25, s25, 3
    s_and_b32 s25, s25, 7
    s_and_b32 s73, s22, 7
    s_add_u32 s25, s25, s73
    s_and_b32 s25, s25, 7
    s_mul_i32 s25, s25, 5
    s_lshr_b32 s25, s25, 2
    s_sub_u32 s54, s23, 16
    s_mul_i32 s50, s54, 11
    s_cmp_eq_u32 s54, 5
    s_subb_u32 s50, s50, 0
    s_and_b32 s45, s26, 1
    s_lshl_b32 s45, s45, 6
    v_xor_b32 v10, s45, v10
    v_xor_b32_e64 v11, 64, v10
    s_mul_i32 s40, s50, 40960
    s_mul_i32 s45, s26, 112640
    s_add_u32 s40, s40, s45
    s_mul_i32 s41, s26, 11264
    s_mul_i32 s42, s26, 2560
    s_add_u32 s42, s42, 135168
    s_mov_b32 s43, s25
    s_mov_b32 s44, s25
    s_and_b32 s49, s22, 4
    s_lshl_b32 s49, s49, 9
    s_movk_i32 s47, 3840
    s_movk_i32 s48, -160
    v_lshrrev_b32 v3, 16, v8
    v_mad_i32_i24 v12, v3, s48, v7
    v_mad_u32_u24 v12, v3, s47, v12
    v_add_u32 v8, 419456, v8
    v_add_u32 v7, 1024, v7
    v_lshrrev_b32_e64 v3, 16, v8
    v_mad_i32_i24 v13, v3, s48, v7
    v_lshrrev_b32 v5, 1, v3
    v_and_b32 v5, 4, v5
    v_xor_b32_e64 v3, v5, v3
    v_mad_u32_u24 v13, v3, s47, v13
    v_add_u32 v8, 419456, v8
    v_add_u32 v7, 1024, v7
    v_lshrrev_b32_e64 v3, 16, v8
    v_mad_i32_i24 v14, v3, s48, v7
    v_xor_b32_e64 v3, 4, v3
    v_mad_u32_u24 v14, v3, s47, v14
    s_cmp_ge_u32 s54, 4
    s_cselect_b32 s47, 10, 11
    s_add_u32 s47, s47, s50
    s_mul_i32 s30, s47, 40960
    s_waitcnt lgkmcnt(0)
    s_mul_i32 s48, s44, 245760
    s_add_u32 m0, s42, 0
    s_nop 0
    buffer_load_dwordx4 v12, s[32:35], s48 offen lds
    s_add_u32 m0, s42, 1024
    s_nop 0
    buffer_load_dwordx4 v13, s[32:35], s48 offen lds
    s_add_u32 m0, s42, 2048
    s_mov_b32 exec_hi, 0
    buffer_load_dwordx4 v14, s[32:35], s48 offen lds
    s_mov_b32 exec_hi, -1
    s_add_u32 s44, s44, 1
    s_cmp_eq_u32 s44, 10
    s_cselect_b32 s44, 0, s44
    s_load_dwordx16 s[4:19], s[0:1], 0
    s_load_dwordx8 s[56:63], s[0:1], 64
    s_load_dwordx4 s[64:67], s[0:1], 96
    s_load_dwordx2 s[20:21], s[0:1], 112
    s_lshl_b32 s45, s43, 7
    s_add_u32 s45, s45, s40
    s_add_u32 s55, s41, 0
    s_xor_b32 m0, s55, s49
    s_nop 0
    buffer_load_dwordx4 v10, s[28:31], s45 offen lds
    s_add_u32 s55, s41, 1024
    s_xor_b32 m0, s55, s49
    s_add_u32 s45, s45, 10240
    buffer_load_dwordx4 v11, s[28:31], s45 offen lds
    s_add_u32 s55, s41, 2048
    s_xor_b32 m0, s55, s49
    s_add_u32 s45, s45, 10240
    buffer_load_dwordx4 v10, s[28:31], s45 offen lds
    s_add_u32 s55, s41, 3072
    s_xor_b32 m0, s55, s49
    s_add_u32 s45, s45, 10240
    buffer_load_dwordx4 v11, s[28:31], s45 offen lds
    s_add_u32 s55, s41, 4096
    s_xor_b32 m0, s55, s49
    s_branch L_over_hot
L_hot:
    s_branch L_qcons
L_over_hot:
    s_add_u32 s45, s45, 10240
    buffer_load_dwordx4 v10, s[28:31], s45 offen lds
    s_add_u32 s55, s41, 5120
    s_xor_b32 m0, s55, s49
    s_add_u32 s45, s45, 10240
    buffer_load_dwordx4 v11, s[28:31], s45 offen lds
    s_add_u32 s55, s41, 6144
    s_xor_b32 m0, s55, s49
    s_add_u32 s45, s45, 10240
    buffer_load_dwordx4 v10, s[28:31], s45 offen lds
    s_add_u32 s55, s41, 7168
    s_xor_b32 m0, s55, s49
    s_add_u32 s45, s45, 10240
    buffer_load_dwordx4 v11, s[28:31], s45 offen lds
    s_add_u32 s55, s41, 8192
    s_xor_b32 m0, s55, s49
    s_add_u32 s45, s45, 10240
    buffer_load_dwordx4 v10, s[28:31], s45 offen lds
    s_add_u32 s55, s41, 9216
    s_xor_b32 m0, s55, s49
    s_add_u32 s45, s45, 10240
    buffer_load_dwordx4 v11, s[28:31], s45 offen lds
    s_add_u32 s55, s41, 10240
    s_xor_b32 m0, s55, s49
    s_add_u32 s45, s45, 10240
    buffer_load_dwordx4 v10, s[28:31], s45 offen lds
    s_add_u32 s43, s43, 1
    s_cmp_eq_u32 s43, 10
    s_cselect_b32 s43, 0, s43
    s_getreg_b32 s72, hwreg(HW_REG_XCC_ID, 0, 4)
    s_or_b32 s72, s72, 0x80
    s_mul_i32 s72, s72, 0x01010101
    s_lshl_b32 s69, s22, 2
    s_lshr_b32 s73, s23, 3
    s_add_u32 s69, s69, s73
    s_and_b32 s70, s23, 7
    s_add_u32 s73, s23, 1
    s_and_b32 s73, s73, 3
    s_mul_i32 s73, s73, 10240
    s_add_u32 s71, s73, 102400
    s_waitcnt lgkmcnt(0)
    s_mov_b32 s36, s62
    s_and_b32 s37, s63, 0xffff
    s_mov_b32 s38, 1280
    s_mov_b32 s39, 0x20000
    v_lshlrev_b32_e64 v2, 4, v1
    s_lshl_b32 s47, s26, 10
    s_add_u32 m0, s47, 155648
    s_nop 0
    buffer_load_dwordx4 v2, s[36:39], s47 offen lds
    s_mul_i32 s48, s44, 245760
    s_add_u32 m0, s42, 10240
    s_nop 0
    buffer_load_dwordx4 v12, s[32:35], s48 offen lds
    s_add_u32 m0, s42, 11264
    s_nop 0
    buffer_load_dwordx4 v13, s[32:35], s48 offen lds
    s_add_u32 m0, s42, 12288
    s_mov_b32 exec_hi, 0
    buffer_load_dwordx4 v14, s[32:35], s48 offen lds
    s_mov_b32 exec_hi, -1
    s_add_u32 s44, s44, 1
    s_cmp_eq_u32 s44, 10
    s_cselect_b32 s44, 0, s44
    s_setprio 0
    s_lshl_b32 s74, s22, 5
    s_add_u32 s74, s74, s23
    s_and_b32 s75, s72, 0xff
    v_mul_u32_u24 v28, 22, v1
    v_add_u32 v28, s74, v28
    v_lshlrev_b32 v29, 3, v28
    v_lshlrev_b32 v29, v29, s75
    v_and_b32 v28, 0xfc, v28
    s_mov_b64 s[74:75], 1
    s_add_u32 s73, s23, s22
    s_and_b32 s73, s73, 3
    s_cmp_eq_u32 s24, 4
    s_cselect_b32 s73, s73, -1
    s_lshl_b32 s45, s43, 7
    s_add_u32 s45, s45, s40
    s_add_u32 s55, s41, 45056
    s_xor_b32 m0, s55, s49
    s_nop 0
    buffer_load_dwordx4 v10, s[28:31], s45 offen lds
    s_add_u32 s55, s41, 46080
    s_xor_b32 m0, s55, s49
    s_add_u32 s45, s45, 10240
    buffer_load_dwordx4 v11, s[28:31], s45 offen lds
    s_add_u32 s55, s41, 47104
    s_xor_b32 m0, s55, s49
    s_add_u32 s45, s45, 10240
    buffer_load_dwordx4 v10, s[28:31], s45 offen lds
    s_add_u32 s55, s41, 48128
    s_xor_b32 m0, s55, s49
    s_add_u32 s45, s45, 10240
    buffer_load_dwordx4 v11, s[28:31], s45 offen lds
    s_add_u32 s55, s41, 49152
    s_xor_b32 m0, s55, s49
    s_add_u32 s45, s45, 10240
    buffer_load_dwordx4 v10, s[28:31], s45 offen lds
    s_add_u32 s55, s41, 50176
    s_xor_b32 m0, s55, s49
    s_add_u32 s45, s45, 10240
    buffer_load_dwordx4 v11, s[28:31], s45 offen lds
    s_add_u32 s55, s41, 51200
    s_xor_b32 m0, s55, s49
    s_add_u32 s45, s45, 10240
    buffer_load_dwordx4 v10, s[28:31], s45 offen lds
    s_add_u32 s55, s41, 52224
    s_xor_b32 m0, s55, s49
    s_add_u32 s45, s45, 10240
    buffer_load_dwordx4 v11, s[28:31], s45 offen lds
    s_add_u32 s55, s41, 53248
    s_xor_b32 m0, s55, s49
    s_add_u32 s45, s45, 10240
    buffer_load_dwordx4 v10, s[28:31], s45 offen lds
    s_add_u32 s55, s41, 54272
    s_xor_b32 m0, s55, s49
    s_add_u32 s45, s45, 10240
    buffer_load_dwordx4 v11, s[28:31], s45 offen lds
    s_add_u32 s55, s41, 55296
    s_xor_b32 m0, s55, s49
    s_add_u32 s45, s45, 10240
    buffer_load_dwordx4 v10, s[28:31], s45 offen lds
    s_add_u32 s43, s43, 1
    s_cmp_eq_u32 s43, 10
    s_cselect_b32 s43, 0, s43
    s_waitcnt vmcnt(14)
    s_barrier
    s_lshl_b32 s45, s43, 7
    s_add_u32 s45, s45, s40
    s_add_u32 s55, s41, 90112
    s_xor_b32 m0, s55, s49
    s_nop 0
    buffer_load_dwordx4 v10, s[28:31], s45 offen lds
    s_add_u32 s55, s41, 91136
    s_xor_b32 m0, s55, s49
    s_add_u32 s45, s45, 10240
    buffer_load_dwordx4 v11, s[28:31], s45 offen lds
    s_add_u32 s55, s41, 92160
    s_xor_b32 m0, s55, s49
    s_add_u32 s45, s45, 10240
    buffer_load_dwordx4 v10, s[28:31], s45 offen lds
    s_add_u32 s55, s41, 93184
    s_xor_b32 m0, s55, s49
    s_add_u32 s45, s45, 10240
    buffer_load_dwordx4 v11, s[28:31], s45 offen lds
    s_add_u32 s55, s41, 94208
    s_xor_b32 m0, s55, s49
    s_add_u32 s45, s45, 10240
    buffer_load_dwordx4 v10, s[28:31], s45 offen lds
    s_add_u32 s55, s41, 95232
    s_xor_b32 m0, s55, s49
    s_add_u32 s45, s45, 10240
    buffer_load_dwordx4 v11, s[28:31], s45 offen lds
    s_add_u32 s55, s41, 96256
    s_xor_b32 m0, s55, s49
    s_add_u32 s45, s45, 10240
    buffer_load_dwordx4 v10, s[28:31], s45 offen lds
    s_add_u32 s55, s41, 97280
    s_xor_b32 m0, s55, s49
    s_add_u32 s45, s45, 10240
    buffer_load_dwordx4 v11, s[28:31], s45 offen lds
    s_add_u32 s55, s41, 98304
    s_xor_b32 m0, s55, s49
    s_add_u32 s45, s45, 10240
    buffer_load_dwordx4 v10, s[28:31], s45 offen lds
    s_add_u32 s55, s41, 99328
    s_xor_b32 m0, s55, s49
    s_add_u32 s45, s45, 10240
    buffer_load_dwordx4 v11, s[28:31], s45 offen lds
    s_add_u32 s55, s41, 100352
    s_xor_b32 m0, s55, s49
    s_add_u32 s45, s45, 10240
    buffer_load_dwordx4 v10, s[28:31], s45 offen lds
    s_add_u32 s43, s43, 1
    s_cmp_eq_u32 s43, 10
    s_cselect_b32 s43, 0, s43
    s_waitcnt vmcnt(11)
    s_barrier
    s_mul_i32 s48, s44, 245760
    s_add_u32 m0, s42, 0
    s_nop 0
    buffer_load_dwordx4 v12, s[32:35], s48 offen lds
    s_add_u32 m0, s42, 1024
    s_nop 0
    buffer_load_dwordx4 v13, s[32:35], s48 offen lds
    s_add_u32 m0, s42, 2048
    s_mov_b32 exec_hi, 0
    buffer_load_dwordx4 v14, s[32:35], s48 offen lds
    s_mov_b32 exec_hi, -1
    s_add_u32 s44, s44, 1
    s_cmp_eq_u32 s44, 10
    s_cselect_b32 s44, 0, s44
    s_cmp_lg_u32 s73, 0
    s_cbranch_scc1 L_ann_3
    s_mov_b64 exec, s[74:75]
        global_atomic_or v28, v29, s[66:67] sc1
    s_mov_b64 exec, -1
L_ann_3:
    s_lshl_b32 s45, s43, 7
    s_add_u32 s45, s45, s40
    s_add_u32 s55, s41, 0
    s_xor_b32 m0, s55, s49
    s_nop 0
    buffer_load_dwordx4 v10, s[28:31], s45 offen lds
    s_add_u32 s55, s41, 1024
    s_xor_b32 m0, s55, s49
    s_add_u32 s45, s45, 10240
    buffer_load_dwordx4 v11, s[28:31], s45 offen lds
    s_add_u32 s55, s41, 2048
    s_xor_b32 m0, s55, s49
    s_add_u32 s45, s45, 10240
    buffer_load_dwordx4 v10, s[28:31], s45 offen lds
    s_add_u32 s55, s41, 3072
    s_xor_b32 m0, s55, s49
    s_add_u32 s45, s45, 10240
    buffer_load_dwordx4 v11, s[28:31], s45 offen lds
    s_add_u32 s55, s41, 4096
    s_xor_b32 m0, s55, s49
    s_add_u32 s45, s45, 10240
    buffer_load_dwordx4 v10, s[28:31], s45 offen lds
    s_add_u32 s55, s41, 5120
    s_xor_b32 m0, s55, s49
    s_add_u32 s45, s45, 10240
    buffer_load_dwordx4 v11, s[28:31], s45 offen lds
    s_add_u32 s55, s41, 6144
    s_xor_b32 m0, s55, s49
    s_add_u32 s45, s45, 10240
    buffer_load_dwordx4 v10, s[28:31], s45 offen lds
    s_add_u32 s55, s41, 7168
    s_xor_b32 m0, s55, s49
    s_add_u32 s45, s45, 10240
    buffer_load_dwordx4 v11, s[28:31], s45 offen lds
    s_add_u32 s55, s41, 8192
    s_xor_b32 m0, s55, s49
    s_add_u32 s45, s45, 10240
    buffer_load_dwordx4 v10, s[28:31], s45 offen lds
    s_add_u32 s55, s41, 9216
    s_xor_b32 m0, s55, s49
    s_add_u32 s45, s45, 10240
    buffer_load_dwordx4 v11, s[28:31], s45 offen lds
    s_add_u32 s55, s41, 10240
    s_xor_b32 m0, s55, s49
    s_add_u32 s45, s45, 10240
    buffer_load_dwordx4 v10, s[28:31], s45 offen lds
    s_add_u32 s43, s43, 1
    s_cmp_eq_u32 s43, 10
    s_cselect_b32 s43, 0, s43
    s_cmp_lg_u32 s73, 1
    s_cbranch_scc1 L_ann_4
    s_mov_b64 exec, s[74:75]
        global_atomic_or v28, v29, s[66:67] sc1
    s_mov_b64 exec, -1
L_ann_4:
    s_waitcnt vmcnt(11)
    s_barrier
    s_mul_i32 s48, s44, 245760
    s_add_u32 m0, s42, 10240
    s_nop 0
    buffer_load_dwordx4 v12, s[32:35], s48 offen lds
    s_add_u32 m0, s42, 11264
    s_nop 0
    buffer_load_dwordx4 v13, s[32:35], s48 offen lds
    s_add_u32 m0, s42, 12288
    s_mov_b32 exec_hi, 0
    buffer_load_dwordx4 v14, s[32:35], s48 offen lds
    s_mov_b32 exec_hi, -1
    s_add_u32 s44, s44, 1
    s_cmp_eq_u32 s44, 10
    s_cselect_b32 s44, 0, s44
    s_cmp_lg_u32 s73, 2
    s_cbranch_scc1 L_ann_5
    s_mov_b64 exec, s[74:75]
        global_atomic_or v28, v29, s[66:67] sc1
    s_mov_b64 exec, -1
L_ann_5:
    s_lshl_b32 s45, s43, 7
    s_add_u32 s45, s45, s40
    s_add_u32 s55, s41, 45056
    s_xor_b32 m0, s55, s49
    s_nop 0
    buffer_load_dwordx4 v10, s[28:31], s45 offen lds
    s_add_u32 s55, s41, 46080
    s_xor_b32 m0, s55, s49
    s_add_u32 s45, s45, 10240
    buffer_load_dwordx4 v11, s[28:31], s45 offen lds
    s_add_u32 s55, s41, 47104
    s_xor_b32 m0, s55, s49
    s_add_u32 s45, s45, 10240
    buffer_load_dwordx4 v10, s[28:31], s45 offen lds
    s_add_u32 s55, s41, 48128
    s_xor_b32 m0, s55, s49
    s_add_u32 s45, s45, 10240
    buffer_load_dwordx4 v11, s[28:31], s45 offen lds
    s_add_u32 s55, s41, 49152
    s_xor_b32 m0, s55, s49
    s_add_u32 s45, s45, 10240
    buffer_load_dwordx4 v10, s[28:31], s45 offen lds
    s_add_u32 s55, s41, 50176
    s_xor_b32 m0, s55, s49
    s_add_u32 s45, s45, 10240
    buffer_load_dwordx4 v11, s[28:31], s45 offen lds
    s_add_u32 s55, s41, 51200
    s_xor_b32 m0, s55, s49
    s_add_u32 s45, s45, 10240
    buffer_load_dwordx4 v10, s[28:31], s45 offen lds
    s_add_u32 s55, s41, 52224
    s_xor_b32 m0, s55, s49
    s_add_u32 s45, s45, 10240
    buffer_load_dwordx4 v11, s[28:31], s45 offen lds
    s_add_u32 s55, s41, 53248
    s_xor_b32 m0, s55, s49
    s_add_u32 s45, s45, 10240
    buffer_load_dwordx4 v10, s[28:31], s45 offen lds
    s_add_u32 s55, s41, 54272
    s_xor_b32 m0, s55, s49
    s_add_u32 s45, s45, 10240
    buffer_load_dwordx4 v11, s[28:31], s45 offen lds
    s_add_u32 s55, s41, 55296
    s_xor_b32 m0, s55, s49
    s_add_u32 s45, s45, 10240
    buffer_load_dwordx4 v10, s[28:31], s45 offen lds
    s_add_u32 s43, s43, 1
    s_cmp_eq_u32 s43, 10
    s_cselect_b32 s43, 0, s43
    s_cmp_lg_u32 s73, 3
    s_cbranch_scc1 L_ann_6
    s_mov_b64 exec, s[74:75]
        global_atomic_or v28, v29, s[66:67] sc1
    s_mov_b64 exec, -1
L_ann_6:
    s_waitcnt vmcnt(11)
    s_barrier
    s_mul_i32 s48, s44, 245760
    s_add_u32 m0, s42, 0
    s_nop 0
    buffer_load_dwordx4 v12, s[32:35], s48 offen lds
    s_add_u32 m0, s42, 1024
    s_nop 0
    buffer_load_dwordx4 v13, s[32:35], s48 offen lds
    s_add_u32 m0, s42, 2048
    s_mov_b32 exec_hi, 0
    buffer_load_dwordx4 v14, s[32:35], s48 offen lds
    s_mov_b32 exec_hi, -1
    s_add_u32 s44, s44, 1
    s_cmp_eq_u32 s44, 10
    s_cselect_b32 s44, 0, s44
    s_lshl_b32 s45, s43, 7
    s_add_u32 s45, s45, s40
    s_add_u32 s55, s41, 90112
    s_xor_b32 m0, s55, s49
    s_nop 0
    buffer_load_dwordx4 v10, s[28:31], s45 offen lds
    s_add_u32 s55, s41, 91136
    s_xor_b32 m0, s55, s49
    s_add_u32 s45, s45, 10240
    buffer_load_dwordx4 v11, s[28:31], s45 offen lds
    s_add_u32 s55, s41, 92160
    s_xor_b32 m0, s55, s49
    s_add_u32 s45, s45, 10240
    buffer_load_dwordx4 v10, s[28:31], s45 offen lds
    s_add_u32 s55, s41, 93184
    s_xor_b32 m0, s55, s49
    s_branch L_over_q_0
L_warm_q:
    s_branch L_warm_q_1
L_over_q_0:
    s_add_u32 s45, s45, 10240
    buffer_load_dwordx4 v11, s[28:31], s45 offen lds
    s_add_u32 s55, s41, 94208
    s_xor_b32 m0, s55, s49
    s_add_u32 s45, s45, 10240
    buffer_load_dwordx4 v10, s[28:31], s45 offen lds
    s_add_u32 s55, s41, 95232
    s_xor_b32 m0, s55, s49
    s_add_u32 s45, s45, 10240
    buffer_load_dwordx4 v11, s[28:31], s45 offen lds
    s_add_u32 s55, s41, 96256
    s_xor_b32 m0, s55, s49
    s_add_u32 s45, s45, 10240
    buffer_load_dwordx4 v10, s[28:31], s45 offen lds
    s_add_u32 s55, s41, 97280
    s_xor_b32 m0, s55, s49
    s_add_u32 s45, s45, 10240
    buffer_load_dwordx4 v11, s[28:31], s45 offen lds
    s_add_u32 s55, s41, 98304
    s_xor_b32 m0, s55, s49
    s_add_u32 s45, s45, 10240
    buffer_load_dwordx4 v10, s[28:31], s45 offen lds
    s_add_u32 s55, s41, 99328
    s_xor_b32 m0, s55, s49
    s_add_u32 s45, s45, 10240
    buffer_load_dwordx4 v11, s[28:31], s45 offen lds
    s_add_u32 s55, s41, 100352
    s_xor_b32 m0, s55, s49
    s_add_u32 s45, s45, 10240
    buffer_load_dwordx4 v10, s[28:31], s45 offen lds
    s_add_u32 s43, s43, 1
    s_cmp_eq_u32 s43, 10
    s_cselect_b32 s43, 0, s43
    s_waitcnt vmcnt(11)
    s_barrier
    s_mul_i32 s48, s44, 245760
    s_add_u32 m0, s42, 10240
    s_nop 0
    buffer_load_dwordx4 v12, s[32:35], s48 offen lds
    s_add_u32 m0, s42, 11264
    s_nop 0
    buffer_load_dwordx4 v13, s[32:35], s48 offen lds
    s_add_u32 m0, s42, 12288
    s_mov_b32 exec_hi, 0
    buffer_load_dwordx4 v14, s[32:35], s48 offen lds
    s_mov_b32 exec_hi, -1
    s_add_u32 s44, s44, 1
    s_cmp_eq_u32 s44, 10
    s_cselect_b32 s44, 0, s44
    s_lshl_b32 s45, s43, 7
    s_add_u32 s45, s45, s40
    s_add_u32 s55, s41, 0
    s_xor_b32 m0, s55, s49
    s_nop 0
    buffer_load_dwordx4 v10, s[28:31], s45 offen lds
    s_add_u32 s55, s41, 1024
    s_xor_b32 m0, s55, s49
    s_add_u32 s45, s45, 10240
    buffer_load_dwordx4 v11, s[28:31], s45 offen lds
    s_add_u32 s55, s41, 2048
    s_xor_b32 m0, s55, s49
    s_add_u32 s45, s45, 10240
    buffer_load_dwordx4 v10, s[28:31], s45 offen lds
    s_add_u32 s55, s41, 3072
    s_xor_b32 m0, s55, s49
    s_add_u32 s45, s45, 10240
    buffer_load_dwordx4 v11, s[28:31], s45 offen lds
    s_add_u32 s55, s41, 4096
    s_xor_b32 m0, s55, s49
    s_add_u32 s45, s45, 10240
    buffer_load_dwordx4 v10, s[28:31], s45 offen lds
    s_add_u32 s55, s41, 5120
    s_xor_b32 m0, s55, s49
    s_add_u32 s45, s45, 10240
    buffer_load_dwordx4 v11, s[28:31], s45 offen lds
    s_add_u32 s55, s41, 6144
    s_xor_b32 m0, s55, s49
    s_add_u32 s45, s45, 10240
    buffer_load_dwordx4 v10, s[28:31], s45 offen lds
    s_add_u32 s55, s41, 7168
    s_xor_b32 m0, s55, s49
    s_add_u32 s45, s45, 10240
    buffer_load_dwordx4 v11, s[28:31], s45 offen lds
    s_add_u32 s55, s41, 8192
    s_xor_b32 m0, s55, s49
    s_add_u32 s45, s45, 10240
    buffer_load_dwordx4 v10, s[28:31], s45 offen lds
    s_add_u32 s55, s41, 9216
    s_xor_b32 m0, s55, s49
    s_add_u32 s45, s45, 10240
    buffer_load_dwordx4 v11, s[28:31], s45 offen lds
    s_add_u32 s55, s41, 10240
    s_xor_b32 m0, s55, s49
    s_add_u32 s45, s45, 10240
    buffer_load_dwordx4 v10, s[28:31], s45 offen lds
    s_add_u32 s43, s43, 1
    s_cmp_eq_u32 s43, 10
    s_cselect_b32 s43, 0, s43
    s_waitcnt vmcnt(11)
    s_barrier
    s_mul_i32 s48, s44, 245760
    s_add_u32 m0, s42, 0
    s_nop 0
    buffer_load_dwordx4 v12, s[32:35], s48 offen lds
    s_add_u32 m0, s42, 1024
    s_nop 0
    buffer_load_dwordx4 v13, s[32:35], s48 offen lds
    s_add_u32 m0, s42, 2048
    s_mov_b32 exec_hi, 0
    buffer_load_dwordx4 v14, s[32:35], s48 offen lds
    s_mov_b32 exec_hi, -1
    s_add_u32 s44, s44, 1
    s_cmp_eq_u32 s44, 10
    s_cselect_b32 s44, 0, s44
    s_lshl_b32 s45, s43, 7
    s_add_u32 s45, s45, s40
    s_add_u32 s55, s41, 45056
    s_xor_b32 m0, s55, s49
    s_nop 0
    buffer_load_dwordx4 v10, s[28:31], s45 offen lds
    s_add_u32 s55, s41, 46080
    s_xor_b32 m0, s55, s49
    s_add_u32 s45, s45, 10240
    buffer_load_dwordx4 v11, s[28:31], s45 offen lds
    s_add_u32 s55, s41, 47104
    s_xor_b32 m0, s55, s49
    s_add_u32 s45, s45, 10240
    buffer_load_dwordx4 v10, s[28:31], s45 offen lds
    s_add_u32 s55, s41, 48128
    s_xor_b32 m0, s55, s49
    s_add_u32 s45, s45, 10240
    buffer_load_dwordx4 v11, s[28:31], s45 offen lds
    s_add_u32 s55, s41, 49152
    s_xor_b32 m0, s55, s49
    s_add_u32 s45, s45, 10240
    buffer_load_dwordx4 v10, s[28:31], s45 offen lds
    s_add_u32 s55, s41, 50176
    s_xor_b32 m0, s55, s49
    s_add_u32 s45, s45, 10240
    buffer_load_dwordx4 v11, s[28:31], s45 offen lds
    s_add_u32 s55, s41, 51200
    s_xor_b32 m0, s55, s49
    s_add_u32 s45, s45, 10240
    buffer_load_dwordx4 v10, s[28:31], s45 offen lds
    s_add_u32 s55, s41, 52224
    s_xor_b32 m0, s55, s49
    s_add_u32 s45, s45, 10240
    buffer_load_dwordx4 v11, s[28:31], s45 offen lds
    s_add_u32 s55, s41, 53248
    s_xor_b32 m0, s55, s49
    s_add_u32 s45, s45, 10240
    buffer_load_dwordx4 v10, s[28:31], s45 offen lds
    s_add_u32 s55, s41, 54272
    s_xor_b32 m0, s55, s49
    s_add_u32 s45, s45, 10240
    buffer_load_dwordx4 v11, s[28:31], s45 offen lds
    s_add_u32 s55, s41, 55296
    s_xor_b32 m0, s55, s49
    s_add_u32 s45, s45, 10240
    buffer_load_dwordx4 v10, s[28:31], s45 offen lds
    s_add_u32 s43, s43, 1
    s_cmp_eq_u32 s43, 10
    s_cselect_b32 s43, 0, s43
    s_waitcnt vmcnt(11)
    s_barrier
    v_lshlrev_b32_e64 v30, 2, v1
    s_cmp_lg_u32 s24, 4
    s_cbranch_scc1 L_ma_7
        global_load_dword v31, v30, s[66:67] sc1
L_ma_7:
    s_mul_i32 s48, s44, 245760
    s_add_u32 m0, s42, 10240
    s_nop 0
    buffer_load_dwordx4 v12, s[32:35], s48 offen lds
    s_add_u32 m0, s42, 11264
    s_nop 0
    buffer_load_dwordx4 v13, s[32:35], s48 offen lds
    s_add_u32 m0, s42, 12288
    s_mov_b32 exec_hi, 0
    buffer_load_dwordx4 v14, s[32:35], s48 offen lds
    s_mov_b32 exec_hi, -1
    s_add_u32 s44, s44, 1
    s_cmp_eq_u32 s44, 10
    s_cselect_b32 s44, 0, s44
    s_lshl_b32 s45, s43, 7
    s_add_u32 s45, s45, s40
    s_add_u32 s55, s41, 90112
    s_xor_b32 m0, s55, s49
    s_nop 0
    buffer_load_dwordx4 v10, s[28:31], s45 offen lds
    s_add_u32 s55, s41, 91136
    s_xor_b32 m0, s55, s49
    s_add_u32 s45, s45, 10240
    buffer_load_dwordx4 v11, s[28:31], s45 offen lds
    s_add_u32 s55, s41, 92160
    s_xor_b32 m0, s55, s49
    s_add_u32 s45, s45, 10240
    buffer_load_dwordx4 v10, s[28:31], s45 offen lds
    s_add_u32 s55, s41, 93184
    s_xor_b32 m0, s55, s49
    s_add_u32 s45, s45, 10240
    buffer_load_dwordx4 v11, s[28:31], s45 offen lds
    s_add_u32 s55, s41, 94208
    s_xor_b32 m0, s55, s49
    s_add_u32 s45, s45, 10240
    buffer_load_dwordx4 v10, s[28:31], s45 offen lds
    s_add_u32 s55, s41, 95232
    s_xor_b32 m0, s55, s49
    s_add_u32 s45, s45, 10240
    buffer_load_dwordx4 v11, s[28:31], s45 offen lds
    s_add_u32 s55, s41, 96256
    s_xor_b32 m0, s55, s49
    s_add_u32 s45, s45, 10240
    buffer_load_dwordx4 v10, s[28:31], s45 offen lds
    s_add_u32 s55, s41, 97280
    s_xor_b32 m0, s55, s49
    s_add_u32 s45, s45, 10240
    buffer_load_dwordx4 v11, s[28:31], s45 offen lds
    s_add_u32 s55, s41, 98304
    s_xor_b32 m0, s55, s49
    s_add_u32 s45, s45, 10240
    buffer_load_dwordx4 v10, s[28:31], s45 offen lds
    s_add_u32 s55, s41, 99328
    s_xor_b32 m0, s55, s49
    s_add_u32 s45, s45, 10240
    buffer_load_dwordx4 v11, s[28:31], s45 offen lds
    s_add_u32 s55, s41, 100352
    s_xor_b32 m0, s55, s49
    s_add_u32 s45, s45, 10240
    buffer_load_dwordx4 v10, s[28:31], s45 offen lds
    s_add_u32 s43, s43, 1
    s_cmp_eq_u32 s43, 10
    s_cselect_b32 s43, 0, s43
    s_waitcnt vmcnt(11)
    s_barrier
    s_mul_i32 s48, s44, 245760
    s_add_u32 m0, s42, 0
    s_nop 0
    buffer_load_dwordx4 v12, s[32:35], s48 offen lds
    s_add_u32 m0, s42, 1024
    s_nop 0
    buffer_load_dwordx4 v13, s[32:35], s48 offen lds
    s_add_u32 m0, s42, 2048
    s_mov_b32 exec_hi, 0
    buffer_load_dwordx4 v14, s[32:35], s48 offen lds
    s_mov_b32 exec_hi, -1
    s_add_u32 s44, s44, 1
    s_cmp_eq_u32 s44, 10
    s_cselect_b32 s44, 0, s44
    s_cmp_lg_u32 s24, 4
    s_cbranch_scc1 L_mt_8
    s_setprio 3
        s_waitcnt vmcnt(17)
    v_and_b32 v32, 0x80808080, v31
    v_cmp_ne_u32 vcc, 0x80808080, v32
    s_nop 0
    s_cbranch_vccz L_ann_9
    s_mov_b32 s27, 0
L_poll_10:
    global_load_dword v31, v30, s[66:67] sc1
    s_waitcnt vmcnt(0)
    v_and_b32 v32, 0x80808080, v31
    v_cmp_ne_u32 vcc, 0x80808080, v32
    s_nop 0
    s_cbranch_vccz L_polled_11
    s_add_u32 s27, s27, 1
    s_cmp_lt_u32 s27, 262144
    s_cbranch_scc1 L_poll_10
L_polled_11:
L_ann_9:
    v_cmp_eq_u32_e64 vcc, s72, v31
    s_lshl_b32 s74, s22, 3
    s_lshr_b64 s[74:75], vcc, s74
    s_and_b32 s74, s74, 0xff
    s_cmp_eq_u32 s74, 0xff
    s_cselect_b32 s68, 1, 0
    v_mov_b32 v32, 157696
    v_mov_b32 v33, s68
    ds_write_b32 v32, v33
    s_setprio 0
L_mt_8:
    s_lshl_b32 s45, s43, 7
    s_add_u32 s45, s45, s40
    s_add_u32 s55, s41, 0
    s_xor_b32 m0, s55, s49
    s_nop 0
    buffer_load_dwordx4 v10, s[28:31], s45 offen lds
    s_add_u32 s55, s41, 1024
    s_xor_b32 m0, s55, s49
    s_add_u32 s45, s45, 10240
    buffer_load_dwordx4 v11, s[28:31], s45 offen lds
    s_add_u32 s55, s41, 2048
    s_xor_b32 m0, s55, s49
    s_add_u32 s45, s45, 10240
    buffer_load_dwordx4 v10, s[28:31], s45 offen lds
    s_add_u32 s55, s41, 3072
    s_xor_b32 m0, s55, s49
    s_add_u32 s45, s45, 10240
    buffer_load_dwordx4 v11, s[28:31], s45 offen lds
    s_add_u32 s55, s41, 4096
    s_xor_b32 m0, s55, s49
    s_add_u32 s45, s45, 10240
    buffer_load_dwordx4 v10, s[28:31], s45 offen lds
    s_add_u32 s55, s41, 5120
    s_xor_b32 m0, s55, s49
    s_add_u32 s45, s45, 10240
    buffer_load_dwordx4 v11, s[28:31], s45 offen lds
    s_add_u32 s55, s41, 6144
    s_xor_b32 m0, s55, s49
    s_add_u32 s45, s45, 10240
    buffer_load_dwordx4 v10, s[28:31], s45 offen lds
    s_add_u32 s55, s41, 7168
    s_xor_b32 m0, s55, s49
    s_add_u32 s45, s45, 10240
    buffer_load_dwordx4 v11, s[28:31], s45 offen lds
    s_add_u32 s55, s41, 8192
    s_xor_b32 m0, s55, s49
    s_add_u32 s45, s45, 10240
    buffer_load_dwordx4 v10, s[28:31], s45 offen lds
    s_add_u32 s55, s41, 9216
    s_xor_b32 m0, s55, s49
    s_add_u32 s45, s45, 10240
    buffer_load_dwordx4 v11, s[28:31], s45 offen lds
    s_add_u32 s55, s41, 10240
    s_xor_b32 m0, s55, s49
    s_add_u32 s45, s45, 10240
    buffer_load_dwordx4 v10, s[28:31], s45 offen lds
    s_add_u32 s43, s43, 1
    s_cmp_eq_u32 s43, 10
    s_cselect_b32 s43, 0, s43
    s_waitcnt vmcnt(11) lgkmcnt(0)
    s_barrier
    s_mul_i32 s48, s44, 245760
    s_add_u32 m0, s42, 10240
    s_nop 0
    buffer_load_dwordx4 v12, s[32:35], s48 offen lds
    s_add_u32 m0, s42, 11264
    s_nop 0
    buffer_load_dwordx4 v13, s[32:35], s48 offen lds
    s_add_u32 m0, s42, 12288
    s_mov_b32 exec_hi, 0
    buffer_load_dwordx4 v14, s[32:35], s48 offen lds
    s_mov_b32 exec_hi, -1
    s_add_u32 s44, s44, 1
    s_cmp_eq_u32 s44, 10
    s_cselect_b32 s44, 0, s44
    s_waitcnt vmcnt(0)
    s_barrier
    s_branch L_tail
L_qcons:
    s_load_dwordx16 s[4:19], s[0:1], 0
    s_load_dwordx8 s[56:63], s[0:1], 64
    s_load_dwordx4 s[64:67], s[0:1], 96
    s_load_dwordx2 s[20:21], s[0:1], 112
    s_lshr_b32 s24, s24, 6
    s_and_b32 s22, s2, 7
    s_lshr_b32 s23, s2, 3
    s_and_b32 s26, s24, 3
    s_mul_i32 s25, s23, 11
    s_sub_u32 s25, s25, 171
    s_lshr_b32 s25, s25, 3
    s_and_b32 s25, s25, 7
    s_and_b32 s73, s22, 7
    s_add_u32 s25, s25, s73
    s_and_b32 s25, s25, 7
    s_mul_i32 s25, s25, 5
    s_lshr_b32 s25, s25, 2
    s_sub_u32 s54, s23, 16
    s_mul_i32 s50, s54, 11
    s_cmp_eq_u32 s54, 5
    s_subb_u32 s50, s50, 0
    s_getreg_b32 s72, hwreg(HW_REG_XCC_ID, 0, 4)
    s_or_b32 s72, s72, 0x80
    s_mul_i32 s72, s72, 0x01010101
    s_lshl_b32 s69, s22, 2
    s_lshr_b32 s73, s23, 3
    s_add_u32 s69, s69, s73
    s_and_b32 s70, s23, 7
    s_add_u32 s73, s23, 1
    s_and_b32 s73, s73, 3
    s_mul_i32 s73, s73, 10240
    s_add_u32 s71, s73, 102400
    s_mul_i32 s51, s24, 3
    s_cmp_ge_u32 s54, 4
    s_cselect_b32 s52, 2, 3
    s_cmp_gt_u32 s24, s52
    s_subb_u32 s51, s51, 0
    s_add_u32 s53, s50, s51
    v_and_b32 v1, 63, v0
    v_and_b32 v2, 15, v0
    v_bfe_u32 v3, v0, 4, 2
    v_lshrrev_b32 v16, 1, v2
    v_xor_b32 v16, v16, v3
    v_lshlrev_b32_e64 v16, 4, v16
    v_lshl_add_u32 v16, v2, 7, v16
    s_lshl_b32 s40, s51, 12
    v_add_u32 v4, s40, v16
    v_xor_b32_e64 v5, 64, v4
    v_add_u32 v6, 45056, v4
    v_add_u32 v7, 45056, v5
    v_add_u32 v8, 90112, v4
    v_add_u32 v9, 90112, v5
    v_lshrrev_b32_e64 v16, 2, v2
    v_lshl_add_u32 v16, v3, 3, v16
    v_mul_u32_u24 v16, 160, v16
    v_and_b32_e64 v17, 1, v3
    v_mul_u32_u24 v17, 640, v17
    v_and_b32 v18, 3, v2
    v_mul_u32_u24 v19, 40, v18
    v_lshlrev_b32_e64 v18, 3, v18
    v_add_u32 v16, 135168, v16
    v_add_u32 v20, v16, v17
    v_sub_u32 v21, v16, v17
    v_add_u32 v21, 640, v21
    v_add_u32_e64 v10, v20, v18
    v_add3_u32 v12, v20, v19, 32
    v_add_u32_e64 v11, v21, v18
    v_add3_u32 v13, v21, v19, 32
    v_lshlrev_b32 v14, 2, v1
    s_lshl_b32 s40, s22, 9
    s_lshl_b32 s41, s54, 4
    s_add_u32 s40, s40, s41
    s_add_u32 s40, s40, 16318720
    v_and_b32_e64 v16, 3, v1
    v_lshl_add_u32 v16, v16, 2, s40
    v_lshrrev_b32 v17, 2, v1
    v_mul_u32_u24 v17, 0, v17
    v_add_u32 v16, v16, v17
    v_mov_b32 v17, 0
    s_lshl_b32 s41, s24, 2
    s_add_u32 s40, s40, s41
    v_mul_u32_u24 v15, 0, v1
    v_add_u32_e64 v15, s40, v15
    s_lshl_b32 s40, s50, 1
    s_sub_u32 s41, s22, s40
    s_and_b32 s41, s41, 7
    v_lshl_add_u32 v25, v3, 3, s41
    s_cmp_ge_u32 s54, 4
    s_cselect_b32 s42, 20, 22
    v_cmp_gt_u32 s[46:47], s42, v25
    v_add_u32 v25, s40, v25
    v_lshlrev_b32 v25, 6, v25
    v_lshl_add_u32 v25, v2, 2, v25
    v_add_u32 v25, 16252928, v25
    s_waitcnt lgkmcnt(0)
    s_cmp_lg_u32 s24, 0
    s_cbranch_scc1 L_q3_2
    s_mov_b64 exec, 15
    global_store_dword v16, v17, s[20:21] sc1
    s_mov_b64 exec, s[46:47]
    global_store_dword v25, v17, s[20:21] sc1
    s_mov_b64 exec, -1
L_q3_2:
    s_cmp_eq_u32 s24, 1
    s_cbranch_scc1 L_warm_q
L_warmed_q:
    s_cmp_ge_u32 s24, s52
    s_cbranch_scc1 L_q2_1
    s_lshl_b32 s40, s22, 6
    s_add_u32 s40, s40, s53
    s_mul_i32 s40, s40, 5120
    s_add_u32 s40, s40, 4196352
    v_lshl_add_u32 v18, v1, 4, s40
    v_mov_b32_e64 v19, 1
    v_mov_b32 v14, 157696
    s_barrier
    s_nop 0
    ds_read_b128 v[152:155], v4 offset:0
    ds_read_b64_tr_b16 v[168:169], v10 offset:0
    ds_read_b64_tr_b16 v[170:171], v11 offset:0
    ds_read_b64_tr_b16 v[172:173], v10 offset:40
    ds_read_b64_tr_b16 v[174:175], v11 offset:40
    ds_read_b64_tr_b16 v[176:177], v10 offset:80
    ds_read_b64_tr_b16 v[178:179], v11 offset:80
    ds_read_b64_tr_b16 v[180:181], v10 offset:120
    ds_read_b64_tr_b16 v[182:183], v11 offset:120
    ds_read_b64_tr_b16 v[184:185], v12 offset:0
    ds_read_b64_tr_b16 v[186:187], v13 offset:0
    ds_read_b128 v[156:159], v4 offset:2048
    s_waitcnt lgkmcnt(9)
    v_mfma_f32_16x16x32_bf16 v[32:35], v[168:171], v[152:155], 0
    ds_read_b128 v[160:163], v4 offset:4096
    s_waitcnt lgkmcnt(8)
    v_mfma_f32_16x16x32_bf16 v[36:39], v[172:175], v[152:155], 0
    ds_read_b64_tr_b16 v[188:189], v10 offset:5120
    s_waitcnt lgkmcnt(7)
    v_mfma_f32_16x16x32_bf16 v[40:43], v[176:179], v[152:155], 0
    ds_read_b64_tr_b16 v[190:191], v11 offset:5120
    s_waitcnt lgkmcnt(6)
    v_mfma_f32_16x16x32_bf16 v[44:47], v[180:183], v[152:155], 0
    s_waitcnt lgkmcnt(4)
    v_mfma_f32_16x16x32_bf16 v[48:51], v[184:187], v[152:155], 0
    s_waitcnt lgkmcnt(3)
    v_mfma_f32_16x16x32_bf16 v[52:55], v[168:171], v[156:159], 0
    ds_read_b128 v[164:167], v4 offset:6144
    v_mfma_f32_16x16x32_bf16 v[56:59], v[172:175], v[156:159], 0
    ds_read_b64_tr_b16 v[192:193], v10 offset:5160
    v_mfma_f32_16x16x32_bf16 v[60:63], v[176:179], v[156:159], 0
    ds_read_b64_tr_b16 v[194:195], v11 offset:5160
    v_mfma_f32_16x16x32_bf16 v[64:67], v[180:183], v[156:159], 0
    v_mfma_f32_16x16x32_bf16 v[68:71], v[184:187], v[156:159], 0
    s_waitcnt lgkmcnt(5)
    v_mfma_f32_16x16x32_bf16 v[72:75], v[168:171], v[160:163], 0
    ds_read_b128 v[152:155], v4 offset:8192
    v_mfma_f32_16x16x32_bf16 v[76:79], v[172:175], v[160:163], 0
    ds_read_b64_tr_b16 v[196:197], v10 offset:5200
    v_mfma_f32_16x16x32_bf16 v[80:83], v[176:179], v[160:163], 0
    ds_read_b64_tr_b16 v[198:199], v11 offset:5200
    v_mfma_f32_16x16x32_bf16 v[84:87], v[180:183], v[160:163], 0
    v_mfma_f32_16x16x32_bf16 v[88:91], v[184:187], v[160:163], 0
    s_waitcnt lgkmcnt(5)
    v_mfma_f32_16x16x32_bf16 v[92:95], v[168:171], v[164:167], 0
    ds_read_b128 v[156:159], v4 offset:10240
    v_mfma_f32_16x16x32_bf16 v[96:99], v[172:175], v[164:167], 0
    ds_read_b64_tr_b16 v[200:201], v10 offset:5240
    v_mfma_f32_16x16x32_bf16 v[100:103], v[176:179], v[164:167], 0
    ds_read_b64_tr_b16 v[202:203], v11 offset:5240
    v_mfma_f32_16x16x32_bf16 v[104:107], v[180:183], v[164:167], 0
    v_mfma_f32_16x16x32_bf16 v[108:111], v[184:187], v[164:167], 0
    s_waitcnt lgkmcnt(5)
    v_mfma_f32_16x16x32_bf16 v[112:115], v[168:171], v[152:155], 0
    ds_read_b128 v[160:163], v5 offset:0
    v_mfma_f32_16x16x32_bf16 v[116:119], v[172:175], v[152:155], 0
    ds_read_b64_tr_b16 v[204:205], v12 offset:5120
    v_mfma_f32_16x16x32_bf16 v[120:123], v[176:179], v[152:155], 0
    ds_read_b64_tr_b16 v[206:207], v13 offset:5120
    v_mfma_f32_16x16x32_bf16 v[124:127], v[180:183], v[152:155], 0
    v_mfma_f32_16x16x32_bf16 v[128:131], v[184:187], v[152:155], 0
    s_waitcnt lgkmcnt(5)
    v_mfma_f32_16x16x32_bf16 v[132:135], v[168:171], v[156:159], 0
    ds_read_b128 v[164:167], v5 offset:2048
    v_mfma_f32_16x16x32_bf16 v[136:139], v[172:175], v[156:159], 0
    v_mfma_f32_16x16x32_bf16 v[140:143], v[176:179], v[156:159], 0
    v_mfma_f32_16x16x32_bf16 v[144:147], v[180:183], v[156:159], 0
    v_mfma_f32_16x16x32_bf16 v[148:151], v[184:187], v[156:159], 0
    s_waitcnt lgkmcnt(3)
    v_mfma_f32_16x16x32_bf16 v[32:35], v[188:191], v[160:163], v[32:35]
    ds_read_b128 v[152:155], v5 offset:4096
    v_mfma_f32_16x16x32_bf16 v[36:39], v[192:195], v[160:163], v[36:39]
    v_mfma_f32_16x16x32_bf16 v[40:43], v[196:199], v[160:163], v[40:43]
    v_mfma_f32_16x16x32_bf16 v[44:47], v[200:203], v[160:163], v[44:47]
    s_waitcnt lgkmcnt(2)
    v_mfma_f32_16x16x32_bf16 v[48:51], v[204:207], v[160:163], v[48:51]
    s_waitcnt lgkmcnt(1)
    v_mfma_f32_16x16x32_bf16 v[52:55], v[188:191], v[164:167], v[52:55]
    ds_read_b128 v[156:159], v5 offset:6144
    v_mfma_f32_16x16x32_bf16 v[56:59], v[192:195], v[164:167], v[56:59]
    v_mfma_f32_16x16x32_bf16 v[60:63], v[196:199], v[164:167], v[60:63]
    v_mfma_f32_16x16x32_bf16 v[64:67], v[200:203], v[164:167], v[64:67]
    v_mfma_f32_16x16x32_bf16 v[68:71], v[204:207], v[164:167], v[68:71]
    s_waitcnt lgkmcnt(1)
    v_mfma_f32_16x16x32_bf16 v[72:75], v[188:191], v[152:155], v[72:75]
    ds_read_b128 v[160:163], v5 offset:8192
    v_mfma_f32_16x16x32_bf16 v[76:79], v[192:195], v[152:155], v[76:79]
    ds_read_b128 v[164:167], v5 offset:10240
    v_mfma_f32_16x16x32_bf16 v[80:83], v[196:199], v[152:155], v[80:83]
    v_mfma_f32_16x16x32_bf16 v[84:87], v[200:203], v[152:155], v[84:87]
    v_mfma_f32_16x16x32_bf16 v[88:91], v[204:207], v[152:155], v[88:91]
    s_waitcnt lgkmcnt(2)
    v_mfma_f32_16x16x32_bf16 v[92:95], v[188:191], v[156:159], v[92:95]
    v_mfma_f32_16x16x32_bf16 v[96:99], v[192:195], v[156:159], v[96:99]
    v_mfma_f32_16x16x32_bf16 v[100:103], v[196:199], v[156:159], v[100:103]
    v_mfma_f32_16x16x32_bf16 v[104:107], v[200:203], v[156:159], v[104:107]
    v_mfma_f32_16x16x32_bf16 v[108:111], v[204:207], v[156:159], v[108:111]
    s_waitcnt lgkmcnt(1)
    v_mfma_f32_16x16x32_bf16 v[112:115], v[188:191], v[160:163], v[112:115]
    s_waitcnt vmcnt(0) lgkmcnt(0)
    s_barrier
    ds_read_b128 v[152:155], v6 offset:0
    v_mfma_f32_16x16x32_bf16 v[116:119], v[192:195], v[160:163], v[116:119]
    ds_read_b64_tr_b16 v[168:169], v10 offset:10240
    ds_read_b64_tr_b16 v[170:171], v11 offset:10240
    v_mfma_f32_16x16x32_bf16 v[120:123], v[196:199], v[160:163], v[120:123]
    ds_read_b64_tr_b16 v[172:173], v10 offset:10280
    v_mfma_f32_16x16x32_bf16 v[124:127], v[200:203], v[160:163], v[124:127]
    ds_read_b64_tr_b16 v[174:175], v11 offset:10280
    v_mfma_f32_16x16x32_bf16 v[128:131], v[204:207], v[160:163], v[128:131]
    ds_read_b64_tr_b16 v[176:177], v10 offset:10320
    v_mfma_f32_16x16x32_bf16 v[132:135], v[188:191], v[164:167], v[132:135]
    ds_read_b64_tr_b16 v[178:179], v11 offset:10320
    ds_read_b64_tr_b16 v[180:181], v10 offset:10360
    v_mfma_f32_16x16x32_bf16 v[136:139], v[192:195], v[164:167], v[136:139]
    ds_read_b64_tr_b16 v[182:183], v11 offset:10360
    v_mfma_f32_16x16x32_bf16 v[140:143], v[196:199], v[164:167], v[140:143]
    ds_read_b64_tr_b16 v[184:185], v12 offset:10240
    v_mfma_f32_16x16x32_bf16 v[144:147], v[200:203], v[164:167], v[144:147]
    ds_read_b64_tr_b16 v[186:187], v13 offset:10240
    v_mfma_f32_16x16x32_bf16 v[148:151], v[204:207], v[164:167], v[148:151]
    ds_read_b128 v[156:159], v6 offset:2048
    s_waitcnt lgkmcnt(9)
    v_mfma_f32_16x16x32_bf16 v[32:35], v[168:171], v[152:155], v[32:35]
    ds_read_b128 v[160:163], v6 offset:4096
    s_waitcnt lgkmcnt(8)
    v_mfma_f32_16x16x32_bf16 v[36:39], v[172:175], v[152:155], v[36:39]
    ds_read_b64_tr_b16 v[188:189], v10 offset:15360
    s_waitcnt lgkmcnt(7)
    v_mfma_f32_16x16x32_bf16 v[40:43], v[176:179], v[152:155], v[40:43]
    ds_read_b64_tr_b16 v[190:191], v11 offset:15360
    s_waitcnt lgkmcnt(6)
    v_mfma_f32_16x16x32_bf16 v[44:47], v[180:183], v[152:155], v[44:47]
    s_waitcnt lgkmcnt(4)
    v_mfma_f32_16x16x32_bf16 v[48:51], v[184:187], v[152:155], v[48:51]
    s_waitcnt lgkmcnt(3)
    v_mfma_f32_16x16x32_bf16 v[52:55], v[168:171], v[156:159], v[52:55]
    ds_read_b128 v[164:167], v6 offset:6144
    v_mfma_f32_16x16x32_bf16 v[56:59], v[172:175], v[156:159], v[56:59]
    ds_read_b64_tr_b16 v[192:193], v10 offset:15400
    v_mfma_f32_16x16x32_bf16 v[60:63], v[176:179], v[156:159], v[60:63]
    ds_read_b64_tr_b16 v[194:195], v11 offset:15400
    v_mfma_f32_16x16x32_bf16 v[64:67], v[180:183], v[156:159], v[64:67]
    v_mfma_f32_16x16x32_bf16 v[68:71], v[184:187], v[156:159], v[68:71]
    s_waitcnt lgkmcnt(5)
    v_mfma_f32_16x16x32_bf16 v[72:75], v[168:171], v[160:163], v[72:75]
    ds_read_b128 v[152:155], v6 offset:8192
    v_mfma_f32_16x16x32_bf16 v[76:79], v[172:175], v[160:163], v[76:79]
    ds_read_b64_tr_b16 v[196:197], v10 offset:15440
    v_mfma_f32_16x16x32_bf16 v[80:83], v[176:179], v[160:163], v[80:83]
    ds_read_b64_tr_b16 v[198:199], v11 offset:15440
    v_mfma_f32_16x16x32_bf16 v[84:87], v[180:183], v[160:163], v[84:87]
    v_mfma_f32_16x16x32_bf16 v[88:91], v[184:187], v[160:163], v[88:91]
    s_waitcnt lgkmcnt(5)
    v_mfma_f32_16x16x32_bf16 v[92:95], v[168:171], v[164:167], v[92:95]
    ds_read_b128 v[156:159], v6 offset:10240
    v_mfma_f32_16x16x32_bf16 v[96:99], v[172:175], v[164:167], v[96:99]
    ds_read_b64_tr_b16 v[200:201], v10 offset:15480
    v_mfma_f32_16x16x32_bf16 v[100:103], v[176:179], v[164:167], v[100:103]
    ds_read_b64_tr_b16 v[202:203], v11 offset:15480
    v_mfma_f32_16x16x32_bf16 v[104:107], v[180:183], v[164:167], v[104:107]
    v_mfma_f32_16x16x32_bf16 v[108:111], v[184:187], v[164:167], v[108:111]
    s_waitcnt lgkmcnt(5)
    v_mfma_f32_16x16x32_bf16 v[112:115], v[168:171], v[152:155], v[112:115]
    ds_read_b128 v[160:163], v7 offset:0
    v_mfma_f32_16x16x32_bf16 v[116:119], v[172:175], v[152:155], v[116:119]
    ds_read_b64_tr_b16 v[204:205], v12 offset:15360
    v_mfma_f32_16x16x32_bf16 v[120:123], v[176:179], v[152:155], v[120:123]
    ds_read_b64_tr_b16 v[206:207], v13 offset:15360
    v_mfma_f32_16x16x32_bf16 v[124:127], v[180:183], v[152:155], v[124:127]
    v_mfma_f32_16x16x32_bf16 v[128:131], v[184:187], v[152:155], v[128:131]
    s_waitcnt lgkmcnt(5)
    v_mfma_f32_16x16x32_bf16 v[132:135], v[168:171], v[156:159], v[132:135]
    ds_read_b128 v[164:167], v7 offset:2048
    v_mfma_f32_16x16x32_bf16 v[136:139], v[172:175], v[156:159], v[136:139]
    v_mfma_f32_16x16x32_bf16 v[140:143], v[176:179], v[156:159], v[140:143]
    s_branch L_over_q_1
L_warm_q_1:
    s_branch L_warm_q_2
L_over_q_1:
    v_mfma_f32_16x16x32_bf16 v[144:147], v[180:183], v[156:159], v[144:147]
    v_mfma_f32_16x16x32_bf16 v[148:151], v[184:187], v[156:159], v[148:151]
    s_waitcnt lgkmcnt(3)
    v_mfma_f32_16x16x32_bf16 v[32:35], v[188:191], v[160:163], v[32:35]
    ds_read_b128 v[152:155], v7 offset:4096
    v_mfma_f32_16x16x32_bf16 v[36:39], v[192:195], v[160:163], v[36:39]
    v_mfma_f32_16x16x32_bf16 v[40:43], v[196:199], v[160:163], v[40:43]
    v_mfma_f32_16x16x32_bf16 v[44:47], v[200:203], v[160:163], v[44:47]
    s_waitcnt lgkmcnt(2)
    v_mfma_f32_16x16x32_bf16 v[48:51], v[204:207], v[160:163], v[48:51]
    s_waitcnt lgkmcnt(1)
    v_mfma_f32_16x16x32_bf16 v[52:55], v[188:191], v[164:167], v[52:55]
    ds_read_b128 v[156:159], v7 offset:6144
    v_mfma_f32_16x16x32_bf16 v[56:59], v[192:195], v[164:167], v[56:59]
    v_mfma_f32_16x16x32_bf16 v[60:63], v[196:199], v[164:167], v[60:63]
    v_mfma_f32_16x16x32_bf16 v[64:67], v[200:203], v[164:167], v[64:67]
    v_mfma_f32_16x16x32_bf16 v[68:71], v[204:207], v[164:167], v[68:71]
    s_waitcnt lgkmcnt(1)
    v_mfma_f32_16x16x32_bf16 v[72:75], v[188:191], v[152:155], v[72:75]
    ds_read_b128 v[160:163], v7 offset:8192
    v_mfma_f32_16x16x32_bf16 v[76:79], v[192:195], v[152:155], v[76:79]
    ds_read_b128 v[164:167], v7 offset:10240
    v_mfma_f32_16x16x32_bf16 v[80:83], v[196:199], v[152:155], v[80:83]
    v_mfma_f32_16x16x32_bf16 v[84:87], v[200:203], v[152:155], v[84:87]
    v_mfma_f32_16x16x32_bf16 v[88:91], v[204:207], v[152:155], v[88:91]
    s_waitcnt lgkmcnt(2)
    v_mfma_f32_16x16x32_bf16 v[92:95], v[188:191], v[156:159], v[92:95]
    v_mfma_f32_16x16x32_bf16 v[96:99], v[192:195], v[156:159], v[96:99]
    v_mfma_f32_16x16x32_bf16 v[100:103], v[196:199], v[156:159], v[100:103]
    v_mfma_f32_16x16x32_bf16 v[104:107], v[200:203], v[156:159], v[104:107]
    v_mfma_f32_16x16x32_bf16 v[108:111], v[204:207], v[156:159], v[108:111]
    s_waitcnt lgkmcnt(1)
    v_mfma_f32_16x16x32_bf16 v[112:115], v[188:191], v[160:163], v[112:115]
    s_waitcnt lgkmcnt(0)
    s_barrier
    ds_read_b128 v[152:155], v8 offset:0
    v_mfma_f32_16x16x32_bf16 v[116:119], v[192:195], v[160:163], v[116:119]
    ds_read_b64_tr_b16 v[168:169], v10 offset:0
    ds_read_b64_tr_b16 v[170:171], v11 offset:0
    v_mfma_f32_16x16x32_bf16 v[120:123], v[196:199], v[160:163], v[120:123]
    ds_read_b64_tr_b16 v[172:173], v10 offset:40
    v_mfma_f32_16x16x32_bf16 v[124:127], v[200:203], v[160:163], v[124:127]
    ds_read_b64_tr_b16 v[174:175], v11 offset:40
    v_mfma_f32_16x16x32_bf16 v[128:131], v[204:207], v[160:163], v[128:131]
    ds_read_b64_tr_b16 v[176:177], v10 offset:80
    v_mfma_f32_16x16x32_bf16 v[132:135], v[188:191], v[164:167], v[132:135]
    ds_read_b64_tr_b16 v[178:179], v11 offset:80
    ds_read_b64_tr_b16 v[180:181], v10 offset:120
    v_mfma_f32_16x16x32_bf16 v[136:139], v[192:195], v[164:167], v[136:139]
    ds_read_b64_tr_b16 v[182:183], v11 offset:120
    v_mfma_f32_16x16x32_bf16 v[140:143], v[196:199], v[164:167], v[140:143]
    ds_read_b64_tr_b16 v[184:185], v12 offset:0
    v_mfma_f32_16x16x32_bf16 v[144:147], v[200:203], v[164:167], v[144:147]
    ds_read_b64_tr_b16 v[186:187], v13 offset:0
    v_mfma_f32_16x16x32_bf16 v[148:151], v[204:207], v[164:167], v[148:151]
    ds_read_b128 v[156:159], v8 offset:2048
    s_waitcnt lgkmcnt(9)
    v_mfma_f32_16x16x32_bf16 v[32:35], v[168:171], v[152:155], v[32:35]
    ds_read_b128 v[160:163], v8 offset:4096
    s_waitcnt lgkmcnt(8)
    v_mfma_f32_16x16x32_bf16 v[36:39], v[172:175], v[152:155], v[36:39]
    ds_read_b64_tr_b16 v[188:189], v10 offset:5120
    s_waitcnt lgkmcnt(7)
    v_mfma_f32_16x16x32_bf16 v[40:43], v[176:179], v[152:155], v[40:43]
    ds_read_b64_tr_b16 v[190:191], v11 offset:5120
    s_waitcnt lgkmcnt(6)
    v_mfma_f32_16x16x32_bf16 v[44:47], v[180:183], v[152:155], v[44:47]
    s_waitcnt lgkmcnt(4)
    v_mfma_f32_16x16x32_bf16 v[48:51], v[184:187], v[152:155], v[48:51]
    s_waitcnt lgkmcnt(3)
    v_mfma_f32_16x16x32_bf16 v[52:55], v[168:171], v[156:159], v[52:55]
    ds_read_b128 v[164:167], v8 offset:6144
    v_mfma_f32_16x16x32_bf16 v[56:59], v[172:175], v[156:159], v[56:59]
    ds_read_b64_tr_b16 v[192:193], v10 offset:5160
    v_mfma_f32_16x16x32_bf16 v[60:63], v[176:179], v[156:159], v[60:63]
    ds_read_b64_tr_b16 v[194:195], v11 offset:5160
    v_mfma_f32_16x16x32_bf16 v[64:67], v[180:183], v[156:159], v[64:67]
    v_mfma_f32_16x16x32_bf16 v[68:71], v[184:187], v[156:159], v[68:71]
    s_waitcnt lgkmcnt(5)
    v_mfma_f32_16x16x32_bf16 v[72:75], v[168:171], v[160:163], v[72:75]
    ds_read_b128 v[152:155], v8 offset:8192
    v_mfma_f32_16x16x32_bf16 v[76:79], v[172:175], v[160:163], v[76:79]
    ds_read_b64_tr_b16 v[196:197], v10 offset:5200
    v_mfma_f32_16x16x32_bf16 v[80:83], v[176:179], v[160:163], v[80:83]
    ds_read_b64_tr_b16 v[198:199], v11 offset:5200
    v_mfma_f32_16x16x32_bf16 v[84:87], v[180:183], v[160:163], v[84:87]
    v_mfma_f32_16x16x32_bf16 v[88:91], v[184:187], v[160:163], v[88:91]
    s_waitcnt lgkmcnt(5)
    v_mfma_f32_16x16x32_bf16 v[92:95], v[168:171], v[164:167], v[92:95]
    ds_read_b128 v[156:159], v8 offset:10240
    v_mfma_f32_16x16x32_bf16 v[96:99], v[172:175], v[164:167], v[96:99]
    ds_read_b64_tr_b16 v[200:201], v10 offset:5240
    v_mfma_f32_16x16x32_bf16 v[100:103], v[176:179], v[164:167], v[100:103]
    ds_read_b64_tr_b16 v[202:203], v11 offset:5240
    v_mfma_f32_16x16x32_bf16 v[104:107], v[180:183], v[164:167], v[104:107]
    v_mfma_f32_16x16x32_bf16 v[108:111], v[184:187], v[164:167], v[108:111]
    s_waitcnt lgkmcnt(5)
    v_mfma_f32_16x16x32_bf16 v[112:115], v[168:171], v[152:155], v[112:115]
    ds_read_b128 v[160:163], v9 offset:0
    v_mfma_f32_16x16x32_bf16 v[116:119], v[172:175], v[152:155], v[116:119]
    ds_read_b64_tr_b16 v[204:205], v12 offset:5120
    v_mfma_f32_16x16x32_bf16 v[120:123], v[176:179], v[152:155], v[120:123]
    ds_read_b64_tr_b16 v[206:207], v13 offset:5120
    v_mfma_f32_16x16x32_bf16 v[124:127], v[180:183], v[152:155], v[124:127]
    v_mfma_f32_16x16x32_bf16 v[128:131], v[184:187], v[152:155], v[128:131]
    s_waitcnt lgkmcnt(5)
    v_mfma_f32_16x16x32_bf16 v[132:135], v[168:171], v[156:159], v[132:135]
    ds_read_b128 v[164:167], v9 offset:2048
    v_mfma_f32_16x16x32_bf16 v[136:139], v[172:175], v[156:159], v[136:139]
    v_mfma_f32_16x16x32_bf16 v[140:143], v[176:179], v[156:159], v[140:143]
    v_mfma_f32_16x16x32_bf16 v[144:147], v[180:183], v[156:159], v[144:147]
    v_mfma_f32_16x16x32_bf16 v[148:151], v[184:187], v[156:159], v[148:151]
    s_waitcnt lgkmcnt(3)
    v_mfma_f32_16x16x32_bf16 v[32:35], v[188:191], v[160:163], v[32:35]
    ds_read_b128 v[152:155], v9 offset:4096
    v_mfma_f32_16x16x32_bf16 v[36:39], v[192:195], v[160:163], v[36:39]
    v_mfma_f32_16x16x32_bf16 v[40:43], v[196:199], v[160:163], v[40:43]
    v_mfma_f32_16x16x32_bf16 v[44:47], v[200:203], v[160:163], v[44:47]
    s_waitcnt lgkmcnt(2)
    v_mfma_f32_16x16x32_bf16 v[48:51], v[204:207], v[160:163], v[48:51]
    s_waitcnt lgkmcnt(1)
    v_mfma_f32_16x16x32_bf16 v[52:55], v[188:191], v[164:167], v[52:55]
    ds_read_b128 v[156:159], v9 offset:6144
    v_mfma_f32_16x16x32_bf16 v[56:59], v[192:195], v[164:167], v[56:59]
    v_mfma_f32_16x16x32_bf16 v[60:63], v[196:199], v[164:167], v[60:63]
    v_mfma_f32_16x16x32_bf16 v[64:67], v[200:203], v[164:167], v[64:67]
    v_mfma_f32_16x16x32_bf16 v[68:71], v[204:207], v[164:167], v[68:71]
    s_waitcnt lgkmcnt(1)
    v_mfma_f32_16x16x32_bf16 v[72:75], v[188:191], v[152:155], v[72:75]
    ds_read_b128 v[160:163], v9 offset:8192
    v_mfma_f32_16x16x32_bf16 v[76:79], v[192:195], v[152:155], v[76:79]
    ds_read_b128 v[164:167], v9 offset:10240
    v_mfma_f32_16x16x32_bf16 v[80:83], v[196:199], v[152:155], v[80:83]
    v_mfma_f32_16x16x32_bf16 v[84:87], v[200:203], v[152:155], v[84:87]
    v_mfma_f32_16x16x32_bf16 v[88:91], v[204:207], v[152:155], v[88:91]
    s_waitcnt lgkmcnt(2)
    v_mfma_f32_16x16x32_bf16 v[92:95], v[188:191], v[156:159], v[92:95]
    v_mfma_f32_16x16x32_bf16 v[96:99], v[192:195], v[156:159], v[96:99]
    v_mfma_f32_16x16x32_bf16 v[100:103], v[196:199], v[156:159], v[100:103]
    v_mfma_f32_16x16x32_bf16 v[104:107], v[200:203], v[156:159], v[104:107]
    v_mfma_f32_16x16x32_bf16 v[108:111], v[204:207], v[156:159], v[108:111]
    s_waitcnt lgkmcnt(1)
    v_mfma_f32_16x16x32_bf16 v[112:115], v[188:191], v[160:163], v[112:115]
    s_waitcnt lgkmcnt(0)
    s_barrier
    ds_read_b128 v[152:155], v4 offset:0
    v_mfma_f32_16x16x32_bf16 v[116:119], v[192:195], v[160:163], v[116:119]
    ds_read_b64_tr_b16 v[168:169], v10 offset:10240
    ds_read_b64_tr_b16 v[170:171], v11 offset:10240
    v_mfma_f32_16x16x32_bf16 v[120:123], v[196:199], v[160:163], v[120:123]
    ds_read_b64_tr_b16 v[172:173], v10 offset:10280
    v_mfma_f32_16x16x32_bf16 v[124:127], v[200:203], v[160:163], v[124:127]
    ds_read_b64_tr_b16 v[174:175], v11 offset:10280
    v_mfma_f32_16x16x32_bf16 v[128:131], v[204:207], v[160:163], v[128:131]
    ds_read_b64_tr_b16 v[176:177], v10 offset:10320
    v_mfma_f32_16x16x32_bf16 v[132:135], v[188:191], v[164:167], v[132:135]
    ds_read_b64_tr_b16 v[178:179], v11 offset:10320
    ds_read_b64_tr_b16 v[180:181], v10 offset:10360
    v_mfma_f32_16x16x32_bf16 v[136:139], v[192:195], v[164:167], v[136:139]
    ds_read_b64_tr_b16 v[182:183], v11 offset:10360
    v_mfma_f32_16x16x32_bf16 v[140:143], v[196:199], v[164:167], v[140:143]
    ds_read_b64_tr_b16 v[184:185], v12 offset:10240
    v_mfma_f32_16x16x32_bf16 v[144:147], v[200:203], v[164:167], v[144:147]
    ds_read_b64_tr_b16 v[186:187], v13 offset:10240
    v_mfma_f32_16x16x32_bf16 v[148:151], v[204:207], v[164:167], v[148:151]
    ds_read_b128 v[156:159], v4 offset:2048
    s_waitcnt lgkmcnt(9)
    v_mfma_f32_16x16x32_bf16 v[32:35], v[168:171], v[152:155], v[32:35]
    ds_read_b128 v[160:163], v4 offset:4096
    s_waitcnt lgkmcnt(8)
    v_mfma_f32_16x16x32_bf16 v[36:39], v[172:175], v[152:155], v[36:39]
    ds_read_b64_tr_b16 v[188:189], v10 offset:15360
    s_waitcnt lgkmcnt(7)
    v_mfma_f32_16x16x32_bf16 v[40:43], v[176:179], v[152:155], v[40:43]
    ds_read_b64_tr_b16 v[190:191], v11 offset:15360
    s_waitcnt lgkmcnt(6)
    v_mfma_f32_16x16x32_bf16 v[44:47], v[180:183], v[152:155], v[44:47]
    s_waitcnt lgkmcnt(4)
    v_mfma_f32_16x16x32_bf16 v[48:51], v[184:187], v[152:155], v[48:51]
    s_waitcnt lgkmcnt(3)
    v_mfma_f32_16x16x32_bf16 v[52:55], v[168:171], v[156:159], v[52:55]
    ds_read_b128 v[164:167], v4 offset:6144
    v_mfma_f32_16x16x32_bf16 v[56:59], v[172:175], v[156:159], v[56:59]
    ds_read_b64_tr_b16 v[192:193], v10 offset:15400
    v_mfma_f32_16x16x32_bf16 v[60:63], v[176:179], v[156:159], v[60:63]
    ds_read_b64_tr_b16 v[194:195], v11 offset:15400
    v_mfma_f32_16x16x32_bf16 v[64:67], v[180:183], v[156:159], v[64:67]
    v_mfma_f32_16x16x32_bf16 v[68:71], v[184:187], v[156:159], v[68:71]
    s_waitcnt lgkmcnt(5)
    v_mfma_f32_16x16x32_bf16 v[72:75], v[168:171], v[160:163], v[72:75]
    ds_read_b128 v[152:155], v4 offset:8192
    v_mfma_f32_16x16x32_bf16 v[76:79], v[172:175], v[160:163], v[76:79]
    ds_read_b64_tr_b16 v[196:197], v10 offset:15440
    v_mfma_f32_16x16x32_bf16 v[80:83], v[176:179], v[160:163], v[80:83]
    ds_read_b64_tr_b16 v[198:199], v11 offset:15440
    v_mfma_f32_16x16x32_bf16 v[84:87], v[180:183], v[160:163], v[84:87]
    v_mfma_f32_16x16x32_bf16 v[88:91], v[184:187], v[160:163], v[88:91]
    s_waitcnt lgkmcnt(5)
    v_mfma_f32_16x16x32_bf16 v[92:95], v[168:171], v[164:167], v[92:95]
    ds_read_b128 v[156:159], v4 offset:10240
    v_mfma_f32_16x16x32_bf16 v[96:99], v[172:175], v[164:167], v[96:99]
    ds_read_b64_tr_b16 v[200:201], v10 offset:15480
    v_mfma_f32_16x16x32_bf16 v[100:103], v[176:179], v[164:167], v[100:103]
    ds_read_b64_tr_b16 v[202:203], v11 offset:15480
    v_mfma_f32_16x16x32_bf16 v[104:107], v[180:183], v[164:167], v[104:107]
    v_mfma_f32_16x16x32_bf16 v[108:111], v[184:187], v[164:167], v[108:111]
    s_waitcnt lgkmcnt(5)
    v_mfma_f32_16x16x32_bf16 v[112:115], v[168:171], v[152:155], v[112:115]
    ds_read_b128 v[160:163], v5 offset:0
    v_mfma_f32_16x16x32_bf16 v[116:119], v[172:175], v[152:155], v[116:119]
    ds_read_b64_tr_b16 v[204:205], v12 offset:15360
    v_mfma_f32_16x16x32_bf16 v[120:123], v[176:179], v[152:155], v[120:123]
    ds_read_b64_tr_b16 v[206:207], v13 offset:15360
    v_mfma_f32_16x16x32_bf16 v[124:127], v[180:183], v[152:155], v[124:127]
    v_mfma_f32_16x16x32_bf16 v[128:131], v[184:187], v[152:155], v[128:131]
    s_waitcnt lgkmcnt(5)
    v_mfma_f32_16x16x32_bf16 v[132:135], v[168:171], v[156:159], v[132:135]
    ds_read_b128 v[164:167], v5 offset:2048
    v_mfma_f32_16x16x32_bf16 v[136:139], v[172:175], v[156:159], v[136:139]
    v_mfma_f32_16x16x32_bf16 v[140:143], v[176:179], v[156:159], v[140:143]
    v_mfma_f32_16x16x32_bf16 v[144:147], v[180:183], v[156:159], v[144:147]
    v_mfma_f32_16x16x32_bf16 v[148:151], v[184:187], v[156:159], v[148:151]
    s_waitcnt lgkmcnt(3)
    v_mfma_f32_16x16x32_bf16 v[32:35], v[188:191], v[160:163], v[32:35]
    ds_read_b128 v[152:155], v5 offset:4096
    v_mfma_f32_16x16x32_bf16 v[36:39], v[192:195], v[160:163], v[36:39]
    v_mfma_f32_16x16x32_bf16 v[40:43], v[196:199], v[160:163], v[40:43]
    v_mfma_f32_16x16x32_bf16 v[44:47], v[200:203], v[160:163], v[44:47]
    s_waitcnt lgkmcnt(2)
    v_mfma_f32_16x16x32_bf16 v[48:51], v[204:207], v[160:163], v[48:51]
    s_waitcnt lgkmcnt(1)
    v_mfma_f32_16x16x32_bf16 v[52:55], v[188:191], v[164:167], v[52:55]
    ds_read_b128 v[156:159], v5 offset:6144
    v_mfma_f32_16x16x32_bf16 v[56:59], v[192:195], v[164:167], v[56:59]
    v_mfma_f32_16x16x32_bf16 v[60:63], v[196:199], v[164:167], v[60:63]
    v_mfma_f32_16x16x32_bf16 v[64:67], v[200:203], v[164:167], v[64:67]
    v_mfma_f32_16x16x32_bf16 v[68:71], v[204:207], v[164:167], v[68:71]
    s_waitcnt lgkmcnt(1)
    v_mfma_f32_16x16x32_bf16 v[72:75], v[188:191], v[152:155], v[72:75]
    ds_read_b128 v[160:163], v5 offset:8192
    v_mfma_f32_16x16x32_bf16 v[76:79], v[192:195], v[152:155], v[76:79]
    ds_read_b128 v[164:167], v5 offset:10240
    v_mfma_f32_16x16x32_bf16 v[80:83], v[196:199], v[152:155], v[80:83]
    v_mfma_f32_16x16x32_bf16 v[84:87], v[200:203], v[152:155], v[84:87]
    v_mfma_f32_16x16x32_bf16 v[88:91], v[204:207], v[152:155], v[88:91]
    s_waitcnt lgkmcnt(2)
    v_mfma_f32_16x16x32_bf16 v[92:95], v[188:191], v[156:159], v[92:95]
    v_mfma_f32_16x16x32_bf16 v[96:99], v[192:195], v[156:159], v[96:99]
    v_mfma_f32_16x16x32_bf16 v[100:103], v[196:199], v[156:159], v[100:103]
    v_mfma_f32_16x16x32_bf16 v[104:107], v[200:203], v[156:159], v[104:107]
    v_mfma_f32_16x16x32_bf16 v[108:111], v[204:207], v[156:159], v[108:111]
    s_waitcnt lgkmcnt(1)
    v_mfma_f32_16x16x32_bf16 v[112:115], v[188:191], v[160:163], v[112:115]
    s_waitcnt lgkmcnt(0)
    s_barrier
    ds_read_b128 v[152:155], v6 offset:0
    v_mfma_f32_16x16x32_bf16 v[116:119], v[192:195], v[160:163], v[116:119]
    ds_read_b64_tr_b16 v[168:169], v10 offset:0
    ds_read_b64_tr_b16 v[170:171], v11 offset:0
    v_mfma_f32_16x16x32_bf16 v[120:123], v[196:199], v[160:163], v[120:123]
    ds_read_b64_tr_b16 v[172:173], v10 offset:40
    v_mfma_f32_16x16x32_bf16 v[124:127], v[200:203], v[160:163], v[124:127]
    ds_read_b64_tr_b16 v[174:175], v11 offset:40
    v_mfma_f32_16x16x32_bf16 v[128:131], v[204:207], v[160:163], v[128:131]
    ds_read_b64_tr_b16 v[176:177], v10 offset:80
    v_mfma_f32_16x16x32_bf16 v[132:135], v[188:191], v[164:167], v[132:135]
    ds_read_b64_tr_b16 v[178:179], v11 offset:80
    ds_read_b64_tr_b16 v[180:181], v10 offset:120
    v_mfma_f32_16x16x32_bf16 v[136:139], v[192:195], v[164:167], v[136:139]
    ds_read_b64_tr_b16 v[182:183], v11 offset:120
    v_mfma_f32_16x16x32_bf16 v[140:143], v[196:199], v[164:167], v[140:143]
    ds_read_b64_tr_b16 v[184:185], v12 offset:0
    v_mfma_f32_16x16x32_bf16 v[144:147], v[200:203], v[164:167], v[144:147]
    ds_read_b64_tr_b16 v[186:187], v13 offset:0
    v_mfma_f32_16x16x32_bf16 v[148:151], v[204:207], v[164:167], v[148:151]
    ds_read_b128 v[156:159], v6 offset:2048
    s_waitcnt lgkmcnt(9)
    v_mfma_f32_16x16x32_bf16 v[32:35], v[168:171], v[152:155], v[32:35]
    ds_read_b128 v[160:163], v6 offset:4096
    s_waitcnt lgkmcnt(8)
    v_mfma_f32_16x16x32_bf16 v[36:39], v[172:175], v[152:155], v[36:39]
    ds_read_b64_tr_b16 v[188:189], v10 offset:5120
    s_waitcnt lgkmcnt(7)
    v_mfma_f32_16x16x32_bf16 v[40:43], v[176:179], v[152:155], v[40:43]
    ds_read_b64_tr_b16 v[190:191], v11 offset:5120
    s_waitcnt lgkmcnt(6)
    v_mfma_f32_16x16x32_bf16 v[44:47], v[180:183], v[152:155], v[44:47]
    s_waitcnt lgkmcnt(4)
    v_mfma_f32_16x16x32_bf16 v[48:51], v[184:187], v[152:155], v[48:51]
    s_waitcnt lgkmcnt(3)
    v_mfma_f32_16x16x32_bf16 v[52:55], v[168:171], v[156:159], v[52:55]
    ds_read_b128 v[164:167], v6 offset:6144
    v_mfma_f32_16x16x32_bf16 v[56:59], v[172:175], v[156:159], v[56:59]
    ds_read_b64_tr_b16 v[192:193], v10 offset:5160
    v_mfma_f32_16x16x32_bf16 v[60:63], v[176:179], v[156:159], v[60:63]
    ds_read_b64_tr_b16 v[194:195], v11 offset:5160
    v_mfma_f32_16x16x32_bf16 v[64:67], v[180:183], v[156:159], v[64:67]
    v_mfma_f32_16x16x32_bf16 v[68:71], v[184:187], v[156:159], v[68:71]
    s_waitcnt lgkmcnt(5)
    v_mfma_f32_16x16x32_bf16 v[72:75], v[168:171], v[160:163], v[72:75]
    ds_read_b128 v[152:155], v6 offset:8192
    v_mfma_f32_16x16x32_bf16 v[76:79], v[172:175], v[160:163], v[76:79]
    ds_read_b64_tr_b16 v[196:197], v10 offset:5200
    v_mfma_f32_16x16x32_bf16 v[80:83], v[176:179], v[160:163], v[80:83]
    ds_read_b64_tr_b16 v[198:199], v11 offset:5200
    v_mfma_f32_16x16x32_bf16 v[84:87], v[180:183], v[160:163], v[84:87]
    v_mfma_f32_16x16x32_bf16 v[88:91], v[184:187], v[160:163], v[88:91]
    s_waitcnt lgkmcnt(5)
    v_mfma_f32_16x16x32_bf16 v[92:95], v[168:171], v[164:167], v[92:95]
    ds_read_b128 v[156:159], v6 offset:10240
    v_mfma_f32_16x16x32_bf16 v[96:99], v[172:175], v[164:167], v[96:99]
    ds_read_b64_tr_b16 v[200:201], v10 offset:5240
    v_mfma_f32_16x16x32_bf16 v[100:103], v[176:179], v[164:167], v[100:103]
    ds_read_b64_tr_b16 v[202:203], v11 offset:5240
    v_mfma_f32_16x16x32_bf16 v[104:107], v[180:183], v[164:167], v[104:107]
    v_mfma_f32_16x16x32_bf16 v[108:111], v[184:187], v[164:167], v[108:111]
    s_waitcnt lgkmcnt(5)
    v_mfma_f32_16x16x32_bf16 v[112:115], v[168:171], v[152:155], v[112:115]
    ds_read_b128 v[160:163], v7 offset:0
    v_mfma_f32_16x16x32_bf16 v[116:119], v[172:175], v[152:155], v[116:119]
    ds_read_b64_tr_b16 v[204:205], v12 offset:5120
    v_mfma_f32_16x16x32_bf16 v[120:123], v[176:179], v[152:155], v[120:123]
    ds_read_b64_tr_b16 v[206:207], v13 offset:5120
    v_mfma_f32_16x16x32_bf16 v[124:127], v[180:183], v[152:155], v[124:127]
    v_mfma_f32_16x16x32_bf16 v[128:131], v[184:187], v[152:155], v[128:131]
    s_waitcnt lgkmcnt(5)
    v_mfma_f32_16x16x32_bf16 v[132:135], v[168:171], v[156:159], v[132:135]
    ds_read_b128 v[164:167], v7 offset:2048
    v_mfma_f32_16x16x32_bf16 v[136:139], v[172:175], v[156:159], v[136:139]
    v_mfma_f32_16x16x32_bf16 v[140:143], v[176:179], v[156:159], v[140:143]
    v_mfma_f32_16x16x32_bf16 v[144:147], v[180:183], v[156:159], v[144:147]
    v_mfma_f32_16x16x32_bf16 v[148:151], v[184:187], v[156:159], v[148:151]
    s_waitcnt lgkmcnt(3)
    v_mfma_f32_16x16x32_bf16 v[32:35], v[188:191], v[160:163], v[32:35]
    ds_read_b128 v[152:155], v7 offset:4096
    v_mfma_f32_16x16x32_bf16 v[36:39], v[192:195], v[160:163], v[36:39]
    v_mfma_f32_16x16x32_bf16 v[40:43], v[196:199], v[160:163], v[40:43]
    v_mfma_f32_16x16x32_bf16 v[44:47], v[200:203], v[160:163], v[44:47]
    s_waitcnt lgkmcnt(2)
    v_mfma_f32_16x16x32_bf16 v[48:51], v[204:207], v[160:163], v[48:51]
    s_waitcnt lgkmcnt(1)
    v_mfma_f32_16x16x32_bf16 v[52:55], v[188:191], v[164:167], v[52:55]
    ds_read_b128 v[156:159], v7 offset:6144
    v_mfma_f32_16x16x32_bf16 v[56:59], v[192:195], v[164:167], v[56:59]
    v_mfma_f32_16x16x32_bf16 v[60:63], v[196:199], v[164:167], v[60:63]
    v_mfma_f32_16x16x32_bf16 v[64:67], v[200:203], v[164:167], v[64:67]
    v_mfma_f32_16x16x32_bf16 v[68:71], v[204:207], v[164:167], v[68:71]
    s_waitcnt lgkmcnt(1)
    v_mfma_f32_16x16x32_bf16 v[72:75], v[188:191], v[152:155], v[72:75]
    ds_read_b128 v[160:163], v7 offset:8192
    v_mfma_f32_16x16x32_bf16 v[76:79], v[192:195], v[152:155], v[76:79]
    ds_read_b128 v[164:167], v7 offset:10240
    v_mfma_f32_16x16x32_bf16 v[80:83], v[196:199], v[152:155], v[80:83]
    v_mfma_f32_16x16x32_bf16 v[84:87], v[200:203], v[152:155], v[84:87]
    v_mfma_f32_16x16x32_bf16 v[88:91], v[204:207], v[152:155], v[88:91]
    s_waitcnt lgkmcnt(2)
    v_mfma_f32_16x16x32_bf16 v[92:95], v[188:191], v[156:159], v[92:95]
    v_mfma_f32_16x16x32_bf16 v[96:99], v[192:195], v[156:159], v[96:99]
    v_mfma_f32_16x16x32_bf16 v[100:103], v[196:199], v[156:159], v[100:103]
    v_mfma_f32_16x16x32_bf16 v[104:107], v[200:203], v[156:159], v[104:107]
    v_mfma_f32_16x16x32_bf16 v[108:111], v[204:207], v[156:159], v[108:111]
    s_waitcnt lgkmcnt(1)
    v_mfma_f32_16x16x32_bf16 v[112:115], v[188:191], v[160:163], v[112:115]
    s_waitcnt lgkmcnt(0)
    s_barrier
    ds_read_b128 v[152:155], v8 offset:0
    v_mfma_f32_16x16x32_bf16 v[116:119], v[192:195], v[160:163], v[116:119]
    ds_read_b64_tr_b16 v[168:169], v10 offset:10240
    ds_read_b64_tr_b16 v[170:171], v11 offset:10240
    v_mfma_f32_16x16x32_bf16 v[120:123], v[196:199], v[160:163], v[120:123]
    ds_read_b64_tr_b16 v[172:173], v10 offset:10280
    v_mfma_f32_16x16x32_bf16 v[124:127], v[200:203], v[160:163], v[124:127]
    ds_read_b64_tr_b16 v[174:175], v11 offset:10280
    v_mfma_f32_16x16x32_bf16 v[128:131], v[204:207], v[160:163], v[128:131]
    ds_read_b64_tr_b16 v[176:177], v10 offset:10320
    v_mfma_f32_16x16x32_bf16 v[132:135], v[188:191], v[164:167], v[132:135]
    ds_read_b64_tr_b16 v[178:179], v11 offset:10320
    ds_read_b64_tr_b16 v[180:181], v10 offset:10360
    v_mfma_f32_16x16x32_bf16 v[136:139], v[192:195], v[164:167], v[136:139]
    ds_read_b64_tr_b16 v[182:183], v11 offset:10360
    v_mfma_f32_16x16x32_bf16 v[140:143], v[196:199], v[164:167], v[140:143]
    ds_read_b64_tr_b16 v[184:185], v12 offset:10240
    v_mfma_f32_16x16x32_bf16 v[144:147], v[200:203], v[164:167], v[144:147]
    ds_read_b64_tr_b16 v[186:187], v13 offset:10240
    v_mfma_f32_16x16x32_bf16 v[148:151], v[204:207], v[164:167], v[148:151]
    ds_read_b128 v[156:159], v8 offset:2048
    s_waitcnt lgkmcnt(9)
    v_mfma_f32_16x16x32_bf16 v[32:35], v[168:171], v[152:155], v[32:35]
    ds_read_b128 v[160:163], v8 offset:4096
    s_waitcnt lgkmcnt(8)
    v_mfma_f32_16x16x32_bf16 v[36:39], v[172:175], v[152:155], v[36:39]
    ds_read_b64_tr_b16 v[188:189], v10 offset:15360
    s_waitcnt lgkmcnt(7)
    v_mfma_f32_16x16x32_bf16 v[40:43], v[176:179], v[152:155], v[40:43]
    ds_read_b64_tr_b16 v[190:191], v11 offset:15360
    s_waitcnt lgkmcnt(6)
    v_mfma_f32_16x16x32_bf16 v[44:47], v[180:183], v[152:155], v[44:47]
    s_waitcnt lgkmcnt(4)
    v_mfma_f32_16x16x32_bf16 v[48:51], v[184:187], v[152:155], v[48:51]
    s_waitcnt lgkmcnt(3)
    v_mfma_f32_16x16x32_bf16 v[52:55], v[168:171], v[156:159], v[52:55]
    ds_read_b128 v[164:167], v8 offset:6144
    v_mfma_f32_16x16x32_bf16 v[56:59], v[172:175], v[156:159], v[56:59]
    ds_read_b64_tr_b16 v[192:193], v10 offset:15400
    v_mfma_f32_16x16x32_bf16 v[60:63], v[176:179], v[156:159], v[60:63]
    ds_read_b64_tr_b16 v[194:195], v11 offset:15400
    v_mfma_f32_16x16x32_bf16 v[64:67], v[180:183], v[156:159], v[64:67]
    v_mfma_f32_16x16x32_bf16 v[68:71], v[184:187], v[156:159], v[68:71]
    s_waitcnt lgkmcnt(5)
    v_mfma_f32_16x16x32_bf16 v[72:75], v[168:171], v[160:163], v[72:75]
    ds_read_b128 v[152:155], v8 offset:8192
    v_mfma_f32_16x16x32_bf16 v[76:79], v[172:175], v[160:163], v[76:79]
    ds_read_b64_tr_b16 v[196:197], v10 offset:15440
    v_mfma_f32_16x16x32_bf16 v[80:83], v[176:179], v[160:163], v[80:83]
    ds_read_b64_tr_b16 v[198:199], v11 offset:15440
    v_mfma_f32_16x16x32_bf16 v[84:87], v[180:183], v[160:163], v[84:87]
    v_mfma_f32_16x16x32_bf16 v[88:91], v[184:187], v[160:163], v[88:91]
    s_waitcnt lgkmcnt(5)
    v_mfma_f32_16x16x32_bf16 v[92:95], v[168:171], v[164:167], v[92:95]
    ds_read_b128 v[156:159], v8 offset:10240
    v_mfma_f32_16x16x32_bf16 v[96:99], v[172:175], v[164:167], v[96:99]
    ds_read_b64_tr_b16 v[200:201], v10 offset:15480
    v_mfma_f32_16x16x32_bf16 v[100:103], v[176:179], v[164:167], v[100:103]
    ds_read_b64_tr_b16 v[202:203], v11 offset:15480
    v_mfma_f32_16x16x32_bf16 v[104:107], v[180:183], v[164:167], v[104:107]
    v_mfma_f32_16x16x32_bf16 v[108:111], v[184:187], v[164:167], v[108:111]
    s_waitcnt lgkmcnt(5)
    v_mfma_f32_16x16x32_bf16 v[112:115], v[168:171], v[152:155], v[112:115]
    ds_read_b128 v[160:163], v9 offset:0
    v_mfma_f32_16x16x32_bf16 v[116:119], v[172:175], v[152:155], v[116:119]
    ds_read_b64_tr_b16 v[204:205], v12 offset:15360
    v_mfma_f32_16x16x32_bf16 v[120:123], v[176:179], v[152:155], v[120:123]
    ds_read_b64_tr_b16 v[206:207], v13 offset:15360
    v_mfma_f32_16x16x32_bf16 v[124:127], v[180:183], v[152:155], v[124:127]
    v_mfma_f32_16x16x32_bf16 v[128:131], v[184:187], v[152:155], v[128:131]
    s_waitcnt lgkmcnt(5)
    v_mfma_f32_16x16x32_bf16 v[132:135], v[168:171], v[156:159], v[132:135]
    ds_read_b128 v[164:167], v9 offset:2048
    v_mfma_f32_16x16x32_bf16 v[136:139], v[172:175], v[156:159], v[136:139]
    v_mfma_f32_16x16x32_bf16 v[140:143], v[176:179], v[156:159], v[140:143]
    v_mfma_f32_16x16x32_bf16 v[144:147], v[180:183], v[156:159], v[144:147]
    v_mfma_f32_16x16x32_bf16 v[148:151], v[184:187], v[156:159], v[148:151]
    s_waitcnt lgkmcnt(3)
    v_mfma_f32_16x16x32_bf16 v[32:35], v[188:191], v[160:163], v[32:35]
    ds_read_b128 v[152:155], v9 offset:4096
    v_mfma_f32_16x16x32_bf16 v[36:39], v[192:195], v[160:163], v[36:39]
    v_mfma_f32_16x16x32_bf16 v[40:43], v[196:199], v[160:163], v[40:43]
    v_mfma_f32_16x16x32_bf16 v[44:47], v[200:203], v[160:163], v[44:47]
    s_waitcnt lgkmcnt(2)
    v_mfma_f32_16x16x32_bf16 v[48:51], v[204:207], v[160:163], v[48:51]
    s_waitcnt lgkmcnt(1)
    v_mfma_f32_16x16x32_bf16 v[52:55], v[188:191], v[164:167], v[52:55]
    ds_read_b128 v[156:159], v9 offset:6144
    v_mfma_f32_16x16x32_bf16 v[56:59], v[192:195], v[164:167], v[56:59]
    v_mfma_f32_16x16x32_bf16 v[60:63], v[196:199], v[164:167], v[60:63]
    v_mfma_f32_16x16x32_bf16 v[64:67], v[200:203], v[164:167], v[64:67]
    v_mfma_f32_16x16x32_bf16 v[68:71], v[204:207], v[164:167], v[68:71]
    s_waitcnt lgkmcnt(1)
    v_mfma_f32_16x16x32_bf16 v[72:75], v[188:191], v[152:155], v[72:75]
    ds_read_b128 v[160:163], v9 offset:8192
    v_mfma_f32_16x16x32_bf16 v[76:79], v[192:195], v[152:155], v[76:79]
    ds_read_b128 v[164:167], v9 offset:10240
    v_mfma_f32_16x16x32_bf16 v[80:83], v[196:199], v[152:155], v[80:83]
    v_mfma_f32_16x16x32_bf16 v[84:87], v[200:203], v[152:155], v[84:87]
    v_mfma_f32_16x16x32_bf16 v[88:91], v[204:207], v[152:155], v[88:91]
    s_waitcnt lgkmcnt(2)
    v_mfma_f32_16x16x32_bf16 v[92:95], v[188:191], v[156:159], v[92:95]
    v_mfma_f32_16x16x32_bf16 v[96:99], v[192:195], v[156:159], v[96:99]
    v_mfma_f32_16x16x32_bf16 v[100:103], v[196:199], v[156:159], v[100:103]
    v_mfma_f32_16x16x32_bf16 v[104:107], v[200:203], v[156:159], v[104:107]
    v_mfma_f32_16x16x32_bf16 v[108:111], v[204:207], v[156:159], v[108:111]
    s_waitcnt lgkmcnt(1)
    v_mfma_f32_16x16x32_bf16 v[112:115], v[188:191], v[160:163], v[112:115]
    s_waitcnt lgkmcnt(0)
    s_barrier
    ds_read_b128 v[152:155], v4 offset:0
    v_mfma_f32_16x16x32_bf16 v[116:119], v[192:195], v[160:163], v[116:119]
    ds_read_b64_tr_b16 v[168:169], v10 offset:0
    ds_read_b64_tr_b16 v[170:171], v11 offset:0
    v_mfma_f32_16x16x32_bf16 v[120:123], v[196:199], v[160:163], v[120:123]
    ds_read_b64_tr_b16 v[172:173], v10 offset:40
    v_mfma_f32_16x16x32_bf16 v[124:127], v[200:203], v[160:163], v[124:127]
    ds_read_b64_tr_b16 v[174:175], v11 offset:40
    v_mfma_f32_16x16x32_bf16 v[128:131], v[204:207], v[160:163], v[128:131]
    ds_read_b64_tr_b16 v[176:177], v10 offset:80
    v_mfma_f32_16x16x32_bf16 v[132:135], v[188:191], v[164:167], v[132:135]
    ds_read_b64_tr_b16 v[178:179], v11 offset:80
    ds_read_b64_tr_b16 v[180:181], v10 offset:120
    v_mfma_f32_16x16x32_bf16 v[136:139], v[192:195], v[164:167], v[136:139]
    ds_read_b64_tr_b16 v[182:183], v11 offset:120
    v_mfma_f32_16x16x32_bf16 v[140:143], v[196:199], v[164:167], v[140:143]
    ds_read_b64_tr_b16 v[184:185], v12 offset:0
    v_mfma_f32_16x16x32_bf16 v[144:147], v[200:203], v[164:167], v[144:147]
    ds_read_b64_tr_b16 v[186:187], v13 offset:0
    v_mfma_f32_16x16x32_bf16 v[148:151], v[204:207], v[164:167], v[148:151]
    ds_read_b128 v[156:159], v4 offset:2048
    s_waitcnt lgkmcnt(9)
    v_mfma_f32_16x16x32_bf16 v[32:35], v[168:171], v[152:155], v[32:35]
    ds_read_b128 v[160:163], v4 offset:4096
    s_waitcnt lgkmcnt(8)
    v_mfma_f32_16x16x32_bf16 v[36:39], v[172:175], v[152:155], v[36:39]
    ds_read_b64_tr_b16 v[188:189], v10 offset:5120
    s_waitcnt lgkmcnt(7)
    v_mfma_f32_16x16x32_bf16 v[40:43], v[176:179], v[152:155], v[40:43]
    ds_read_b64_tr_b16 v[190:191], v11 offset:5120
    s_waitcnt lgkmcnt(6)
    v_mfma_f32_16x16x32_bf16 v[44:47], v[180:183], v[152:155], v[44:47]
    s_waitcnt lgkmcnt(4)
    v_mfma_f32_16x16x32_bf16 v[48:51], v[184:187], v[152:155], v[48:51]
    s_waitcnt lgkmcnt(3)
    v_mfma_f32_16x16x32_bf16 v[52:55], v[168:171], v[156:159], v[52:55]
    ds_read_b128 v[164:167], v4 offset:6144
    v_mfma_f32_16x16x32_bf16 v[56:59], v[172:175], v[156:159], v[56:59]
    ds_read_b64_tr_b16 v[192:193], v10 offset:5160
    v_mfma_f32_16x16x32_bf16 v[60:63], v[176:179], v[156:159], v[60:63]
    ds_read_b64_tr_b16 v[194:195], v11 offset:5160
    v_mfma_f32_16x16x32_bf16 v[64:67], v[180:183], v[156:159], v[64:67]
    v_mfma_f32_16x16x32_bf16 v[68:71], v[184:187], v[156:159], v[68:71]
    s_waitcnt lgkmcnt(5)
    v_mfma_f32_16x16x32_bf16 v[72:75], v[168:171], v[160:163], v[72:75]
    ds_read_b128 v[152:155], v4 offset:8192
    v_mfma_f32_16x16x32_bf16 v[76:79], v[172:175], v[160:163], v[76:79]
    ds_read_b64_tr_b16 v[196:197], v10 offset:5200
    v_mfma_f32_16x16x32_bf16 v[80:83], v[176:179], v[160:163], v[80:83]
    ds_read_b64_tr_b16 v[198:199], v11 offset:5200
    v_mfma_f32_16x16x32_bf16 v[84:87], v[180:183], v[160:163], v[84:87]
    v_mfma_f32_16x16x32_bf16 v[88:91], v[184:187], v[160:163], v[88:91]
    s_waitcnt lgkmcnt(5)
    v_mfma_f32_16x16x32_bf16 v[92:95], v[168:171], v[164:167], v[92:95]
    ds_read_b128 v[156:159], v4 offset:10240
    v_mfma_f32_16x16x32_bf16 v[96:99], v[172:175], v[164:167], v[96:99]
    ds_read_b64_tr_b16 v[200:201], v10 offset:5240
    v_mfma_f32_16x16x32_bf16 v[100:103], v[176:179], v[164:167], v[100:103]
    ds_read_b64_tr_b16 v[202:203], v11 offset:5240
    v_mfma_f32_16x16x32_bf16 v[104:107], v[180:183], v[164:167], v[104:107]
    v_mfma_f32_16x16x32_bf16 v[108:111], v[184:187], v[164:167], v[108:111]
    s_waitcnt lgkmcnt(5)
    v_mfma_f32_16x16x32_bf16 v[112:115], v[168:171], v[152:155], v[112:115]
    ds_read_b128 v[160:163], v5 offset:0
    v_mfma_f32_16x16x32_bf16 v[116:119], v[172:175], v[152:155], v[116:119]
    ds_read_b64_tr_b16 v[204:205], v12 offset:5120
    v_mfma_f32_16x16x32_bf16 v[120:123], v[176:179], v[152:155], v[120:123]
    ds_read_b64_tr_b16 v[206:207], v13 offset:5120
    v_mfma_f32_16x16x32_bf16 v[124:127], v[180:183], v[152:155], v[124:127]
    v_mfma_f32_16x16x32_bf16 v[128:131], v[184:187], v[152:155], v[128:131]
    s_waitcnt lgkmcnt(5)
    v_mfma_f32_16x16x32_bf16 v[132:135], v[168:171], v[156:159], v[132:135]
    ds_read_b128 v[164:167], v5 offset:2048
    v_mfma_f32_16x16x32_bf16 v[136:139], v[172:175], v[156:159], v[136:139]
    v_mfma_f32_16x16x32_bf16 v[140:143], v[176:179], v[156:159], v[140:143]
    v_mfma_f32_16x16x32_bf16 v[144:147], v[180:183], v[156:159], v[144:147]
    v_mfma_f32_16x16x32_bf16 v[148:151], v[184:187], v[156:159], v[148:151]
    s_waitcnt lgkmcnt(3)
    v_mfma_f32_16x16x32_bf16 v[32:35], v[188:191], v[160:163], v[32:35]
    ds_read_b128 v[152:155], v5 offset:4096
    v_mfma_f32_16x16x32_bf16 v[36:39], v[192:195], v[160:163], v[36:39]
    v_mfma_f32_16x16x32_bf16 v[40:43], v[196:199], v[160:163], v[40:43]
    s_branch L_over_q_2
L_warm_q_2:
    s_branch L_warm_q_3
L_over_q_2:
    v_mfma_f32_16x16x32_bf16 v[44:47], v[200:203], v[160:163], v[44:47]
    s_waitcnt lgkmcnt(2)
    v_mfma_f32_16x16x32_bf16 v[48:51], v[204:207], v[160:163], v[48:51]
    s_waitcnt lgkmcnt(1)
    v_mfma_f32_16x16x32_bf16 v[52:55], v[188:191], v[164:167], v[52:55]
    ds_read_b128 v[156:159], v5 offset:6144
    v_mfma_f32_16x16x32_bf16 v[56:59], v[192:195], v[164:167], v[56:59]
    v_mfma_f32_16x16x32_bf16 v[60:63], v[196:199], v[164:167], v[60:63]
    v_mfma_f32_16x16x32_bf16 v[64:67], v[200:203], v[164:167], v[64:67]
    v_mfma_f32_16x16x32_bf16 v[68:71], v[204:207], v[164:167], v[68:71]
    s_waitcnt lgkmcnt(1)
    v_mfma_f32_16x16x32_bf16 v[72:75], v[188:191], v[152:155], v[72:75]
    ds_read_b128 v[160:163], v5 offset:8192
    v_mfma_f32_16x16x32_bf16 v[76:79], v[192:195], v[152:155], v[76:79]
    ds_read_b128 v[164:167], v5 offset:10240
    v_mfma_f32_16x16x32_bf16 v[80:83], v[196:199], v[152:155], v[80:83]
    v_mfma_f32_16x16x32_bf16 v[84:87], v[200:203], v[152:155], v[84:87]
    v_mfma_f32_16x16x32_bf16 v[88:91], v[204:207], v[152:155], v[88:91]
    s_waitcnt lgkmcnt(2)
    v_mfma_f32_16x16x32_bf16 v[92:95], v[188:191], v[156:159], v[92:95]
    v_mfma_f32_16x16x32_bf16 v[96:99], v[192:195], v[156:159], v[96:99]
    v_mfma_f32_16x16x32_bf16 v[100:103], v[196:199], v[156:159], v[100:103]
    v_mfma_f32_16x16x32_bf16 v[104:107], v[200:203], v[156:159], v[104:107]
    v_mfma_f32_16x16x32_bf16 v[108:111], v[204:207], v[156:159], v[108:111]
    s_waitcnt lgkmcnt(1)
    v_mfma_f32_16x16x32_bf16 v[112:115], v[188:191], v[160:163], v[112:115]
    s_waitcnt lgkmcnt(0)
    s_barrier
    ds_read_b128 v[152:155], v6 offset:0
    v_mfma_f32_16x16x32_bf16 v[116:119], v[192:195], v[160:163], v[116:119]
    ds_read_b64_tr_b16 v[168:169], v10 offset:10240
    ds_read_b64_tr_b16 v[170:171], v11 offset:10240
    v_mfma_f32_16x16x32_bf16 v[120:123], v[196:199], v[160:163], v[120:123]
    ds_read_b64_tr_b16 v[172:173], v10 offset:10280
    v_mfma_f32_16x16x32_bf16 v[124:127], v[200:203], v[160:163], v[124:127]
    ds_read_b64_tr_b16 v[174:175], v11 offset:10280
    v_mfma_f32_16x16x32_bf16 v[128:131], v[204:207], v[160:163], v[128:131]
    ds_read_b64_tr_b16 v[176:177], v10 offset:10320
    v_mfma_f32_16x16x32_bf16 v[132:135], v[188:191], v[164:167], v[132:135]
    ds_read_b64_tr_b16 v[178:179], v11 offset:10320
    ds_read_b64_tr_b16 v[180:181], v10 offset:10360
    v_mfma_f32_16x16x32_bf16 v[136:139], v[192:195], v[164:167], v[136:139]
    ds_read_b64_tr_b16 v[182:183], v11 offset:10360
    v_mfma_f32_16x16x32_bf16 v[140:143], v[196:199], v[164:167], v[140:143]
    ds_read_b64_tr_b16 v[184:185], v12 offset:10240
    v_mfma_f32_16x16x32_bf16 v[144:147], v[200:203], v[164:167], v[144:147]
    ds_read_b64_tr_b16 v[186:187], v13 offset:10240
    v_mfma_f32_16x16x32_bf16 v[148:151], v[204:207], v[164:167], v[148:151]
    ds_read_b128 v[156:159], v6 offset:2048
    s_waitcnt lgkmcnt(9)
    v_mfma_f32_16x16x32_bf16 v[32:35], v[168:171], v[152:155], v[32:35]
    ds_read_b128 v[160:163], v6 offset:4096
    s_waitcnt lgkmcnt(8)
    v_mfma_f32_16x16x32_bf16 v[36:39], v[172:175], v[152:155], v[36:39]
    ds_read_b64_tr_b16 v[188:189], v10 offset:15360
    s_waitcnt lgkmcnt(7)
    v_mfma_f32_16x16x32_bf16 v[40:43], v[176:179], v[152:155], v[40:43]
    ds_read_b64_tr_b16 v[190:191], v11 offset:15360
    s_waitcnt lgkmcnt(6)
    v_mfma_f32_16x16x32_bf16 v[44:47], v[180:183], v[152:155], v[44:47]
    s_waitcnt lgkmcnt(4)
    v_mfma_f32_16x16x32_bf16 v[48:51], v[184:187], v[152:155], v[48:51]
    s_waitcnt lgkmcnt(3)
    v_mfma_f32_16x16x32_bf16 v[52:55], v[168:171], v[156:159], v[52:55]
    ds_read_b128 v[164:167], v6 offset:6144
    v_mfma_f32_16x16x32_bf16 v[56:59], v[172:175], v[156:159], v[56:59]
    ds_read_b64_tr_b16 v[192:193], v10 offset:15400
    v_mfma_f32_16x16x32_bf16 v[60:63], v[176:179], v[156:159], v[60:63]
    ds_read_b64_tr_b16 v[194:195], v11 offset:15400
    v_mfma_f32_16x16x32_bf16 v[64:67], v[180:183], v[156:159], v[64:67]
    v_mfma_f32_16x16x32_bf16 v[68:71], v[184:187], v[156:159], v[68:71]
    s_waitcnt lgkmcnt(5)
    v_mfma_f32_16x16x32_bf16 v[72:75], v[168:171], v[160:163], v[72:75]
    ds_read_b128 v[152:155], v6 offset:8192
    v_mfma_f32_16x16x32_bf16 v[76:79], v[172:175], v[160:163], v[76:79]
    ds_read_b64_tr_b16 v[196:197], v10 offset:15440
    v_mfma_f32_16x16x32_bf16 v[80:83], v[176:179], v[160:163], v[80:83]
    ds_read_b64_tr_b16 v[198:199], v11 offset:15440
    v_mfma_f32_16x16x32_bf16 v[84:87], v[180:183], v[160:163], v[84:87]
    v_mfma_f32_16x16x32_bf16 v[88:91], v[184:187], v[160:163], v[88:91]
    s_waitcnt lgkmcnt(5)
    v_mfma_f32_16x16x32_bf16 v[92:95], v[168:171], v[164:167], v[92:95]
    ds_read_b128 v[156:159], v6 offset:10240
    v_mfma_f32_16x16x32_bf16 v[96:99], v[172:175], v[164:167], v[96:99]
    ds_read_b64_tr_b16 v[200:201], v10 offset:15480
    v_mfma_f32_16x16x32_bf16 v[100:103], v[176:179], v[164:167], v[100:103]
    ds_read_b64_tr_b16 v[202:203], v11 offset:15480
    v_mfma_f32_16x16x32_bf16 v[104:107], v[180:183], v[164:167], v[104:107]
    v_mfma_f32_16x16x32_bf16 v[108:111], v[184:187], v[164:167], v[108:111]
    s_waitcnt lgkmcnt(5)
    v_mfma_f32_16x16x32_bf16 v[112:115], v[168:171], v[152:155], v[112:115]
    ds_read_b128 v[160:163], v7 offset:0
    v_mfma_f32_16x16x32_bf16 v[116:119], v[172:175], v[152:155], v[116:119]
    ds_read_b64_tr_b16 v[204:205], v12 offset:15360
    v_mfma_f32_16x16x32_bf16 v[120:123], v[176:179], v[152:155], v[120:123]
    ds_read_b64_tr_b16 v[206:207], v13 offset:15360
    v_mfma_f32_16x16x32_bf16 v[124:127], v[180:183], v[152:155], v[124:127]
    v_mfma_f32_16x16x32_bf16 v[128:131], v[184:187], v[152:155], v[128:131]
    s_waitcnt lgkmcnt(5)
    v_mfma_f32_16x16x32_bf16 v[132:135], v[168:171], v[156:159], v[132:135]
    ds_read_b128 v[164:167], v7 offset:2048
    v_mfma_f32_16x16x32_bf16 v[136:139], v[172:175], v[156:159], v[136:139]
    v_mfma_f32_16x16x32_bf16 v[140:143], v[176:179], v[156:159], v[140:143]
    v_mfma_f32_16x16x32_bf16 v[144:147], v[180:183], v[156:159], v[144:147]
    v_mfma_f32_16x16x32_bf16 v[148:151], v[184:187], v[156:159], v[148:151]
    s_waitcnt lgkmcnt(3)
    v_mfma_f32_16x16x32_bf16 v[32:35], v[188:191], v[160:163], v[32:35]
    ds_read_b128 v[152:155], v7 offset:4096
    v_mfma_f32_16x16x32_bf16 v[36:39], v[192:195], v[160:163], v[36:39]
    v_mfma_f32_16x16x32_bf16 v[40:43], v[196:199], v[160:163], v[40:43]
    v_mfma_f32_16x16x32_bf16 v[44:47], v[200:203], v[160:163], v[44:47]
    s_waitcnt lgkmcnt(2)
    v_mfma_f32_16x16x32_bf16 v[48:51], v[204:207], v[160:163], v[48:51]
    s_waitcnt lgkmcnt(1)
    v_mfma_f32_16x16x32_bf16 v[52:55], v[188:191], v[164:167], v[52:55]
    ds_read_b128 v[156:159], v7 offset:6144
    v_mfma_f32_16x16x32_bf16 v[56:59], v[192:195], v[164:167], v[56:59]
    v_mfma_f32_16x16x32_bf16 v[60:63], v[196:199], v[164:167], v[60:63]
    v_mfma_f32_16x16x32_bf16 v[64:67], v[200:203], v[164:167], v[64:67]
    v_mfma_f32_16x16x32_bf16 v[68:71], v[204:207], v[164:167], v[68:71]
    s_waitcnt lgkmcnt(1)
    v_mfma_f32_16x16x32_bf16 v[72:75], v[188:191], v[152:155], v[72:75]
    ds_read_b128 v[160:163], v7 offset:8192
    v_mfma_f32_16x16x32_bf16 v[76:79], v[192:195], v[152:155], v[76:79]
    ds_read_b128 v[164:167], v7 offset:10240
    v_mfma_f32_16x16x32_bf16 v[80:83], v[196:199], v[152:155], v[80:83]
    v_mfma_f32_16x16x32_bf16 v[84:87], v[200:203], v[152:155], v[84:87]
    v_mfma_f32_16x16x32_bf16 v[88:91], v[204:207], v[152:155], v[88:91]
    s_waitcnt lgkmcnt(2)
    v_mfma_f32_16x16x32_bf16 v[92:95], v[188:191], v[156:159], v[92:95]
    v_mfma_f32_16x16x32_bf16 v[96:99], v[192:195], v[156:159], v[96:99]
    v_mfma_f32_16x16x32_bf16 v[100:103], v[196:199], v[156:159], v[100:103]
    v_mfma_f32_16x16x32_bf16 v[104:107], v[200:203], v[156:159], v[104:107]
    v_mfma_f32_16x16x32_bf16 v[108:111], v[204:207], v[156:159], v[108:111]
    s_waitcnt lgkmcnt(1)
    v_mfma_f32_16x16x32_bf16 v[112:115], v[188:191], v[160:163], v[112:115]
    s_waitcnt lgkmcnt(0)
    s_barrier
    ds_read_b128 v[152:155], v8 offset:0
    v_mfma_f32_16x16x32_bf16 v[116:119], v[192:195], v[160:163], v[116:119]
    ds_read_b64_tr_b16 v[168:169], v10 offset:0
    ds_read_b64_tr_b16 v[170:171], v11 offset:0
    v_mfma_f32_16x16x32_bf16 v[120:123], v[196:199], v[160:163], v[120:123]
    ds_read_b64_tr_b16 v[172:173], v10 offset:40
    v_mfma_f32_16x16x32_bf16 v[124:127], v[200:203], v[160:163], v[124:127]
    ds_read_b64_tr_b16 v[174:175], v11 offset:40
    v_mfma_f32_16x16x32_bf16 v[128:131], v[204:207], v[160:163], v[128:131]
    ds_read_b64_tr_b16 v[176:177], v10 offset:80
    v_mfma_f32_16x16x32_bf16 v[132:135], v[188:191], v[164:167], v[132:135]
    ds_read_b64_tr_b16 v[178:179], v11 offset:80
    ds_read_b64_tr_b16 v[180:181], v10 offset:120
    v_mfma_f32_16x16x32_bf16 v[136:139], v[192:195], v[164:167], v[136:139]
    ds_read_b64_tr_b16 v[182:183], v11 offset:120
    v_mfma_f32_16x16x32_bf16 v[140:143], v[196:199], v[164:167], v[140:143]
    ds_read_b64_tr_b16 v[184:185], v12 offset:0
    v_mfma_f32_16x16x32_bf16 v[144:147], v[200:203], v[164:167], v[144:147]
    ds_read_b64_tr_b16 v[186:187], v13 offset:0
    v_mfma_f32_16x16x32_bf16 v[148:151], v[204:207], v[164:167], v[148:151]
    ds_read_b128 v[156:159], v8 offset:2048
    s_waitcnt lgkmcnt(9)
    v_mfma_f32_16x16x32_bf16 v[32:35], v[168:171], v[152:155], v[32:35]
    ds_read_b128 v[160:163], v8 offset:4096
    s_waitcnt lgkmcnt(8)
    v_mfma_f32_16x16x32_bf16 v[36:39], v[172:175], v[152:155], v[36:39]
    ds_read_b64_tr_b16 v[188:189], v10 offset:5120
    s_waitcnt lgkmcnt(7)
    v_mfma_f32_16x16x32_bf16 v[40:43], v[176:179], v[152:155], v[40:43]
    ds_read_b64_tr_b16 v[190:191], v11 offset:5120
    s_waitcnt lgkmcnt(6)
    v_mfma_f32_16x16x32_bf16 v[44:47], v[180:183], v[152:155], v[44:47]
    s_waitcnt lgkmcnt(4)
    v_mfma_f32_16x16x32_bf16 v[48:51], v[184:187], v[152:155], v[48:51]
    s_waitcnt lgkmcnt(3)
    v_mfma_f32_16x16x32_bf16 v[52:55], v[168:171], v[156:159], v[52:55]
    ds_read_b128 v[164:167], v8 offset:6144
    v_mfma_f32_16x16x32_bf16 v[56:59], v[172:175], v[156:159], v[56:59]
    ds_read_b64_tr_b16 v[192:193], v10 offset:5160
    v_mfma_f32_16x16x32_bf16 v[60:63], v[176:179], v[156:159], v[60:63]
    ds_read_b64_tr_b16 v[194:195], v11 offset:5160
    v_mfma_f32_16x16x32_bf16 v[64:67], v[180:183], v[156:159], v[64:67]
    v_mfma_f32_16x16x32_bf16 v[68:71], v[184:187], v[156:159], v[68:71]
    s_waitcnt lgkmcnt(5)
    v_mfma_f32_16x16x32_bf16 v[72:75], v[168:171], v[160:163], v[72:75]
    ds_read_b128 v[152:155], v8 offset:8192
    v_mfma_f32_16x16x32_bf16 v[76:79], v[172:175], v[160:163], v[76:79]
    ds_read_b64_tr_b16 v[196:197], v10 offset:5200
    v_mfma_f32_16x16x32_bf16 v[80:83], v[176:179], v[160:163], v[80:83]
    ds_read_b64_tr_b16 v[198:199], v11 offset:5200
    v_mfma_f32_16x16x32_bf16 v[84:87], v[180:183], v[160:163], v[84:87]
    v_mfma_f32_16x16x32_bf16 v[88:91], v[184:187], v[160:163], v[88:91]
    s_waitcnt lgkmcnt(5)
    v_mfma_f32_16x16x32_bf16 v[92:95], v[168:171], v[164:167], v[92:95]
    ds_read_b128 v[156:159], v8 offset:10240
    v_mfma_f32_16x16x32_bf16 v[96:99], v[172:175], v[164:167], v[96:99]
    ds_read_b64_tr_b16 v[200:201], v10 offset:5240
    v_mfma_f32_16x16x32_bf16 v[100:103], v[176:179], v[164:167], v[100:103]
    ds_read_b64_tr_b16 v[202:203], v11 offset:5240
    v_mfma_f32_16x16x32_bf16 v[104:107], v[180:183], v[164:167], v[104:107]
    v_mfma_f32_16x16x32_bf16 v[108:111], v[184:187], v[164:167], v[108:111]
    s_waitcnt lgkmcnt(5)
    v_mfma_f32_16x16x32_bf16 v[112:115], v[168:171], v[152:155], v[112:115]
    ds_read_b128 v[160:163], v9 offset:0
    v_mfma_f32_16x16x32_bf16 v[116:119], v[172:175], v[152:155], v[116:119]
    ds_read_b64_tr_b16 v[204:205], v12 offset:5120
    v_mfma_f32_16x16x32_bf16 v[120:123], v[176:179], v[152:155], v[120:123]
    ds_read_b64_tr_b16 v[206:207], v13 offset:5120
    v_mfma_f32_16x16x32_bf16 v[124:127], v[180:183], v[152:155], v[124:127]
    v_mfma_f32_16x16x32_bf16 v[128:131], v[184:187], v[152:155], v[128:131]
    s_waitcnt lgkmcnt(5)
    v_mfma_f32_16x16x32_bf16 v[132:135], v[168:171], v[156:159], v[132:135]
    ds_read_b128 v[164:167], v9 offset:2048
    v_mfma_f32_16x16x32_bf16 v[136:139], v[172:175], v[156:159], v[136:139]
    ds_read_b32 v14, v14
    v_mfma_f32_16x16x32_bf16 v[140:143], v[176:179], v[156:159], v[140:143]
    v_mfma_f32_16x16x32_bf16 v[144:147], v[180:183], v[156:159], v[144:147]
    v_mfma_f32_16x16x32_bf16 v[148:151], v[184:187], v[156:159], v[148:151]
    s_waitcnt lgkmcnt(4)
    v_mfma_f32_16x16x32_bf16 v[32:35], v[188:191], v[160:163], v[32:35]
    ds_read_b128 v[152:155], v9 offset:4096
    v_mfma_f32_16x16x32_bf16 v[36:39], v[192:195], v[160:163], v[36:39]
    v_mfma_f32_16x16x32_bf16 v[40:43], v[196:199], v[160:163], v[40:43]
    v_mfma_f32_16x16x32_bf16 v[44:47], v[200:203], v[160:163], v[44:47]
    s_waitcnt lgkmcnt(3)
    v_mfma_f32_16x16x32_bf16 v[48:51], v[204:207], v[160:163], v[48:51]
    s_waitcnt lgkmcnt(2)
    v_mfma_f32_16x16x32_bf16 v[52:55], v[188:191], v[164:167], v[52:55]
    ds_read_b128 v[156:159], v9 offset:6144
    v_mfma_f32_16x16x32_bf16 v[56:59], v[192:195], v[164:167], v[56:59]
    s_waitcnt lgkmcnt(2)
    v_readfirstlane_b32 s68, v14
    v_mfma_f32_16x16x32_bf16 v[60:63], v[196:199], v[164:167], v[60:63]
    v_mfma_f32_16x16x32_bf16 v[64:67], v[200:203], v[164:167], v[64:67]
    v_mfma_f32_16x16x32_bf16 v[68:71], v[204:207], v[164:167], v[68:71]
    s_waitcnt lgkmcnt(1)
    v_mfma_f32_16x16x32_bf16 v[72:75], v[188:191], v[152:155], v[72:75]
    ds_read_b128 v[160:163], v9 offset:8192
    v_mfma_f32_16x16x32_bf16 v[76:79], v[192:195], v[152:155], v[76:79]
    ds_read_b128 v[164:167], v9 offset:10240
    v_mfma_f32_16x16x32_bf16 v[80:83], v[196:199], v[152:155], v[80:83]
    v_mfma_f32_16x16x32_bf16 v[84:87], v[200:203], v[152:155], v[84:87]
    v_mfma_f32_16x16x32_bf16 v[88:91], v[204:207], v[152:155], v[88:91]
    s_waitcnt lgkmcnt(2)
    v_mfma_f32_16x16x32_bf16 v[92:95], v[188:191], v[156:159], v[92:95]
    v_mfma_f32_16x16x32_bf16 v[96:99], v[192:195], v[156:159], v[96:99]
    v_mfma_f32_16x16x32_bf16 v[100:103], v[196:199], v[156:159], v[100:103]
    v_mfma_f32_16x16x32_bf16 v[104:107], v[200:203], v[156:159], v[104:107]
    v_mfma_f32_16x16x32_bf16 v[108:111], v[204:207], v[156:159], v[108:111]
    s_waitcnt lgkmcnt(1)
    v_mfma_f32_16x16x32_bf16 v[112:115], v[188:191], v[160:163], v[112:115]
    s_waitcnt lgkmcnt(0)
    s_barrier
    ds_read_b128 v[152:155], v4 offset:0
    v_mfma_f32_16x16x32_bf16 v[116:119], v[192:195], v[160:163], v[116:119]
    ds_read_b64_tr_b16 v[168:169], v10 offset:10240
    ds_read_b64_tr_b16 v[170:171], v11 offset:10240
    v_mfma_f32_16x16x32_bf16 v[120:123], v[196:199], v[160:163], v[120:123]
    ds_read_b64_tr_b16 v[172:173], v10 offset:10280
    v_mfma_f32_16x16x32_bf16 v[124:127], v[200:203], v[160:163], v[124:127]
    ds_read_b64_tr_b16 v[174:175], v11 offset:10280
    v_mfma_f32_16x16x32_bf16 v[128:131], v[204:207], v[160:163], v[128:131]
    ds_read_b64_tr_b16 v[176:177], v10 offset:10320
    v_mfma_f32_16x16x32_bf16 v[132:135], v[188:191], v[164:167], v[132:135]
    ds_read_b64_tr_b16 v[178:179], v11 offset:10320
    ds_read_b64_tr_b16 v[180:181], v10 offset:10360
    v_mfma_f32_16x16x32_bf16 v[136:139], v[192:195], v[164:167], v[136:139]
    ds_read_b64_tr_b16 v[182:183], v11 offset:10360
    v_mfma_f32_16x16x32_bf16 v[140:143], v[196:199], v[164:167], v[140:143]
    ds_read_b64_tr_b16 v[184:185], v12 offset:10240
    v_mfma_f32_16x16x32_bf16 v[144:147], v[200:203], v[164:167], v[144:147]
    ds_read_b64_tr_b16 v[186:187], v13 offset:10240
    v_mfma_f32_16x16x32_bf16 v[148:151], v[204:207], v[164:167], v[148:151]
    ds_read_b128 v[156:159], v4 offset:2048
    s_cmp_eq_u32 s68, 0
    s_cbranch_scc1 L_qglob_12
    s_waitcnt lgkmcnt(9)
    v_mfma_f32_16x16x32_bf16 v[32:35], v[168:171], v[152:155], v[32:35]
    ds_read_b128 v[160:163], v5 offset:0
    ds_read_b64_tr_b16 v[188:189], v10 offset:15360
    s_waitcnt lgkmcnt(9)
    v_mfma_f32_16x16x32_bf16 v[36:39], v[172:175], v[152:155], v[36:39]
    ds_read_b64_tr_b16 v[190:191], v11 offset:15360
    ds_read_b128 v[164:167], v5 offset:2048
    s_waitcnt lgkmcnt(9)
    v_mfma_f32_16x16x32_bf16 v[40:43], v[176:179], v[152:155], v[40:43]
    ds_read_b64_tr_b16 v[192:193], v10 offset:15400
    s_waitcnt lgkmcnt(8)
    v_mfma_f32_16x16x32_bf16 v[44:47], v[180:183], v[152:155], v[44:47]
    ds_read_b64_tr_b16 v[194:195], v11 offset:15400
    s_waitcnt lgkmcnt(7)
    v_mfma_f32_16x16x32_bf16 v[48:51], v[184:187], v[152:155], v[48:51]
    ds_read_b64_tr_b16 v[196:197], v10 offset:15440
    s_waitcnt lgkmcnt(7)
    v_mfma_f32_16x16x32_bf16 v[52:55], v[168:171], v[156:159], v[52:55]
    ds_read_b64_tr_b16 v[198:199], v11 offset:15440
    v_mfma_f32_16x16x32_bf16 v[56:59], v[172:175], v[156:159], v[56:59]
    ds_read_b64_tr_b16 v[200:201], v10 offset:15480
    v_mfma_f32_16x16x32_bf16 v[60:63], v[176:179], v[156:159], v[60:63]
    ds_read_b64_tr_b16 v[202:203], v11 offset:15480
    v_mfma_f32_16x16x32_bf16 v[64:67], v[180:183], v[156:159], v[64:67]
    ds_read_b64_tr_b16 v[204:205], v12 offset:15360
    v_mfma_f32_16x16x32_bf16 v[68:71], v[184:187], v[156:159], v[68:71]
    ds_read_b64_tr_b16 v[206:207], v13 offset:15360
    s_waitcnt lgkmcnt(9)
    v_mfma_f32_16x16x32_bf16 v[32:35], v[188:191], v[160:163], v[32:35]
    ds_read_b128 v[224:227], v4 offset:4096
    s_waitcnt lgkmcnt(9)
    v_mfma_f32_16x16x32_bf16 v[52:55], v[188:191], v[164:167], v[52:55]
    ds_read_b128 v[232:235], v5 offset:4096
    s_waitcnt lgkmcnt(8)
    v_mfma_f32_16x16x32_bf16 v[36:39], v[192:195], v[160:163], v[36:39]
    ds_read_b128 v[236:239], v5 offset:6144
    v_mfma_f32_16x16x32_bf16 v[56:59], v[192:195], v[164:167], v[56:59]
    ds_read_b128 v[228:231], v4 offset:6144
    s_waitcnt lgkmcnt(8)
    v_mfma_f32_16x16x32_bf16 v[40:43], v[196:199], v[160:163], v[40:43]
    v_mfma_f32_16x16x32_bf16 v[60:63], v[196:199], v[164:167], v[60:63]
    v_cvt_pk_bf16_f32 v208, v32, v33
    v_cvt_pk_bf16_f32 v209, v34, v35
    s_waitcnt lgkmcnt(6)
    v_mfma_f32_16x16x32_bf16 v[44:47], v[200:203], v[160:163], v[44:47]
    v_cvt_pk_bf16_f32 v210, v52, v53
    v_cvt_pk_bf16_f32 v211, v54, v55
    v_mfma_f32_16x16x32_bf16 v[64:67], v[200:203], v[164:167], v[64:67]
    global_store_dwordx4 v18, v[208:211], s[20:21] offset:-2048 nt
    s_waitcnt lgkmcnt(4)
    v_mfma_f32_16x16x32_bf16 v[48:51], v[204:207], v[160:163], v[48:51]
    v_cvt_pk_bf16_f32 v212, v36, v37
    v_cvt_pk_bf16_f32 v213, v38, v39
    v_mfma_f32_16x16x32_bf16 v[68:71], v[204:207], v[164:167], v[68:71]
    v_cvt_pk_bf16_f32 v214, v56, v57
    v_cvt_pk_bf16_f32 v215, v58, v59
    s_waitcnt lgkmcnt(3)
    v_mfma_f32_16x16x32_bf16 v[72:75], v[168:171], v[224:227], v[72:75]
    global_store_dwordx4 v18, v[212:215], s[20:21] offset:-1024 nt
    s_waitcnt lgkmcnt(2)
    v_mfma_f32_16x16x32_bf16 v[72:75], v[188:191], v[232:235], v[72:75]
    v_cvt_pk_bf16_f32 v216, v40, v41
    v_cvt_pk_bf16_f32 v217, v42, v43
    s_waitcnt lgkmcnt(1)
    v_mfma_f32_16x16x32_bf16 v[92:95], v[188:191], v[236:239], v[92:95]
    v_cvt_pk_bf16_f32 v218, v60, v61
    v_cvt_pk_bf16_f32 v219, v62, v63
    s_waitcnt lgkmcnt(0)
    v_mfma_f32_16x16x32_bf16 v[92:95], v[168:171], v[228:231], v[92:95]
    global_store_dwordx4 v18, v[216:219], s[20:21] offset:0 nt
    v_mfma_f32_16x16x32_bf16 v[76:79], v[172:175], v[224:227], v[76:79]
    v_cvt_pk_bf16_f32 v220, v44, v45
    v_cvt_pk_bf16_f32 v221, v46, v47
    v_mfma_f32_16x16x32_bf16 v[76:79], v[192:195], v[232:235], v[76:79]
    v_cvt_pk_bf16_f32 v222, v64, v65
    v_cvt_pk_bf16_f32 v223, v66, v67
    v_mfma_f32_16x16x32_bf16 v[96:99], v[192:195], v[236:239], v[96:99]
    global_store_dwordx4 v18, v[220:223], s[20:21] offset:1024 nt
    v_mfma_f32_16x16x32_bf16 v[96:99], v[172:175], v[228:231], v[96:99]
    v_cvt_pk_bf16_f32 v208, v48, v49
    v_cvt_pk_bf16_f32 v209, v50, v51
    v_mfma_f32_16x16x32_bf16 v[80:83], v[176:179], v[224:227], v[80:83]
    v_cvt_pk_bf16_f32 v210, v68, v69
    v_cvt_pk_bf16_f32 v211, v70, v71
    v_mfma_f32_16x16x32_bf16 v[80:83], v[196:199], v[232:235], v[80:83]
    global_store_dwordx4 v18, v[208:211], s[20:21] offset:2048 nt
    v_mfma_f32_16x16x32_bf16 v[100:103], v[196:199], v[236:239], v[100:103]
    ds_read_b128 v[152:155], v4 offset:8192
    v_add_u32 v18, 5120, v18
    v_cvt_pk_bf16_f32 v212, v72, v73
    v_mfma_f32_16x16x32_bf16 v[100:103], v[176:179], v[228:231], v[100:103]
    ds_read_b128 v[160:163], v5 offset:8192
    v_cvt_pk_bf16_f32 v213, v74, v75
    v_cvt_pk_bf16_f32 v214, v92, v93
    v_mfma_f32_16x16x32_bf16 v[84:87], v[180:183], v[224:227], v[84:87]
    ds_read_b128 v[164:167], v5 offset:10240
    v_cvt_pk_bf16_f32 v215, v94, v95
    global_store_dwordx4 v18, v[212:215], s[20:21] offset:-2048 nt
    v_mfma_f32_16x16x32_bf16 v[84:87], v[200:203], v[232:235], v[84:87]
    ds_read_b128 v[156:159], v4 offset:10240
    v_cvt_pk_bf16_f32 v216, v76, v77
    v_cvt_pk_bf16_f32 v217, v78, v79
    v_mfma_f32_16x16x32_bf16 v[104:107], v[200:203], v[236:239], v[104:107]
    v_cvt_pk_bf16_f32 v218, v96, v97
    v_cvt_pk_bf16_f32 v219, v98, v99
    v_mfma_f32_16x16x32_bf16 v[104:107], v[180:183], v[228:231], v[104:107]
    global_store_dwordx4 v18, v[216:219], s[20:21] offset:-1024 nt
    v_mfma_f32_16x16x32_bf16 v[88:91], v[184:187], v[224:227], v[88:91]
    v_cvt_pk_bf16_f32 v220, v80, v81
    v_cvt_pk_bf16_f32 v221, v82, v83
    v_mfma_f32_16x16x32_bf16 v[88:91], v[204:207], v[232:235], v[88:91]
    v_cvt_pk_bf16_f32 v222, v100, v101
    v_cvt_pk_bf16_f32 v223, v102, v103
    v_mfma_f32_16x16x32_bf16 v[108:111], v[204:207], v[236:239], v[108:111]
    global_store_dwordx4 v18, v[220:223], s[20:21] offset:0 nt
    v_mfma_f32_16x16x32_bf16 v[108:111], v[184:187], v[228:231], v[108:111]
    v_cvt_pk_bf16_f32 v208, v84, v85
    v_cvt_pk_bf16_f32 v209, v86, v87
    s_waitcnt lgkmcnt(3)
    v_mfma_f32_16x16x32_bf16 v[112:115], v[168:171], v[152:155], v[112:115]
    v_cvt_pk_bf16_f32 v210, v104, v105
    v_cvt_pk_bf16_f32 v211, v106, v107
    s_waitcnt lgkmcnt(2)
    v_mfma_f32_16x16x32_bf16 v[112:115], v[188:191], v[160:163], v[112:115]
    global_store_dwordx4 v18, v[208:211], s[20:21] offset:1024 nt
    s_waitcnt lgkmcnt(1)
    v_mfma_f32_16x16x32_bf16 v[132:135], v[188:191], v[164:167], v[132:135]
    s_waitcnt lgkmcnt(0)
    v_mfma_f32_16x16x32_bf16 v[132:135], v[168:171], v[156:159], v[132:135]
    v_cvt_pk_bf16_f32 v212, v88, v89
    v_cvt_pk_bf16_f32 v213, v90, v91
    v_mfma_f32_16x16x32_bf16 v[116:119], v[172:175], v[152:155], v[116:119]
    v_cvt_pk_bf16_f32 v214, v108, v109
    v_cvt_pk_bf16_f32 v215, v110, v111
    v_mfma_f32_16x16x32_bf16 v[116:119], v[192:195], v[160:163], v[116:119]
    global_store_dwordx4 v18, v[212:215], s[20:21] offset:2048 nt
    v_mfma_f32_16x16x32_bf16 v[136:139], v[192:195], v[164:167], v[136:139]
    v_mfma_f32_16x16x32_bf16 v[136:139], v[172:175], v[156:159], v[136:139]
    v_add_u32 v18, 5120, v18
    v_cvt_pk_bf16_f32 v216, v112, v113
    v_mfma_f32_16x16x32_bf16 v[120:123], v[176:179], v[152:155], v[120:123]
    v_cvt_pk_bf16_f32 v217, v114, v115
    v_cvt_pk_bf16_f32 v218, v132, v133
    v_mfma_f32_16x16x32_bf16 v[120:123], v[196:199], v[160:163], v[120:123]
    v_cvt_pk_bf16_f32 v219, v134, v135
    global_store_dwordx4 v18, v[216:219], s[20:21] offset:-2048 nt
    v_mfma_f32_16x16x32_bf16 v[140:143], v[196:199], v[164:167], v[140:143]
    v_mfma_f32_16x16x32_bf16 v[140:143], v[176:179], v[156:159], v[140:143]
    v_cvt_pk_bf16_f32 v220, v116, v117
    v_cvt_pk_bf16_f32 v221, v118, v119
    v_mfma_f32_16x16x32_bf16 v[124:127], v[180:183], v[152:155], v[124:127]
    v_cvt_pk_bf16_f32 v222, v136, v137
    v_cvt_pk_bf16_f32 v223, v138, v139
    v_mfma_f32_16x16x32_bf16 v[124:127], v[200:203], v[160:163], v[124:127]
    global_store_dwordx4 v18, v[220:223], s[20:21] offset:-1024 nt
    v_mfma_f32_16x16x32_bf16 v[144:147], v[200:203], v[164:167], v[144:147]
    v_mfma_f32_16x16x32_bf16 v[144:147], v[180:183], v[156:159], v[144:147]
    v_cvt_pk_bf16_f32 v208, v120, v121
    v_cvt_pk_bf16_f32 v209, v122, v123
    v_mfma_f32_16x16x32_bf16 v[128:131], v[184:187], v[152:155], v[128:131]
    v_cvt_pk_bf16_f32 v210, v140, v141
    v_cvt_pk_bf16_f32 v211, v142, v143
    v_mfma_f32_16x16x32_bf16 v[128:131], v[204:207], v[160:163], v[128:131]
    global_store_dwordx4 v18, v[208:211], s[20:21] offset:0 nt
    v_mfma_f32_16x16x32_bf16 v[148:151], v[204:207], v[164:167], v[148:151]
    v_mfma_f32_16x16x32_bf16 v[148:151], v[184:187], v[156:159], v[148:151]
    v_cvt_pk_bf16_f32 v212, v124, v125
    v_cvt_pk_bf16_f32 v213, v126, v127
    v_cvt_pk_bf16_f32 v214, v144, v145
    v_cvt_pk_bf16_f32 v215, v146, v147
    global_store_dwordx4 v18, v[212:215], s[20:21] offset:1024 nt
    v_cvt_pk_bf16_f32 v216, v128, v129
    v_cvt_pk_bf16_f32 v217, v130, v131
    s_nop 0
    v_cvt_pk_bf16_f32 v218, v148, v149
    v_cvt_pk_bf16_f32 v219, v150, v151
    global_store_dwordx4 v18, v[216:219], s[20:21] offset:2048 nt
    s_mov_b64 exec, 1
    s_waitcnt vmcnt(0)
    global_store_dword v15, v19, s[20:21] nt
    s_mov_b64 exec, -1
L_qjoin_13:
    s_barrier
    s_branch L_fcompute
L_q2_1:
    s_lshl_b32 s42, s51, 12
    v_subrev_u32 v24, s42, v4
    s_add_u32 s42, s41, 0
    s_min_u32 s43, s42, 21
    s_lshr_b32 s45, s22, 2
    s_xor_b32 s43, s43, s45
    s_lshl_b32 s43, s43, 11
    v_add_u32 v20, s43, v24
    s_add_u32 s42, s41, 8
    s_min_u32 s43, s42, 21
    s_lshr_b32 s45, s22, 2
    s_xor_b32 s43, s43, s45
    s_lshl_b32 s43, s43, 11
    v_add_u32 v21, s43, v24
    s_add_u32 s42, s41, 16
    s_min_u32 s43, s42, 21
    s_lshr_b32 s45, s22, 2
    s_xor_b32 s43, s43, s45
    s_lshl_b32 s43, s43, 11
    v_add_u32 v22, s43, v24
    v_lshlrev_b32_e64 v23, 4, v3
    v_add_u32 v23, 155648, v23
    s_mov_b32 s44, s25
    s_lshl_b32 s40, s22, 6
    s_add_u32 s40, s40, s53
    s_mul_i32 s40, s40, 5120
    s_add_u32 s40, s40, 4196352
    v_lshl_add_u32 v18, v1, 4, s40
    v_mov_b32 v19, 1
    v_mov_b32 v14, 157696
    s_barrier
    s_nop 0
    ds_read_b128 v[152:155], v4 offset:0
    ds_read_b64_tr_b16 v[168:169], v10 offset:0
    ds_read_b64_tr_b16 v[170:171], v11 offset:0
    ds_read_b64_tr_b16 v[172:173], v10 offset:40
    ds_read_b64_tr_b16 v[174:175], v11 offset:40
    ds_read_b64_tr_b16 v[176:177], v10 offset:80
    ds_read_b64_tr_b16 v[178:179], v11 offset:80
    ds_read_b64_tr_b16 v[180:181], v10 offset:120
    ds_read_b64_tr_b16 v[182:183], v11 offset:120
    ds_read_b64_tr_b16 v[184:185], v12 offset:0
    ds_read_b64_tr_b16 v[186:187], v13 offset:0
    ds_read_b128 v[156:159], v4 offset:2048
    s_waitcnt lgkmcnt(9)
    v_mfma_f32_16x16x32_bf16 v[32:35], v[168:171], v[152:155], 0
    ds_read_b128 v[160:163], v4 offset:4096
    ds_read_b64_tr_b16 v[188:189], v10 offset:5120
    ds_read_b64_tr_b16 v[190:191], v11 offset:5120
    s_waitcnt lgkmcnt(10)
    v_mfma_f32_16x16x32_bf16 v[36:39], v[172:175], v[152:155], 0
    ds_read_b64_tr_b16 v[192:193], v10 offset:5160
    ds_read_b64_tr_b16 v[194:195], v11 offset:5160
    s_lshl_b32 s45, s44, 7
    s_waitcnt lgkmcnt(10)
    v_mfma_f32_16x16x32_bf16 v[40:43], v[176:179], v[152:155], 0
    v_add_u32_e64 v26, s45, v23
    ds_read_b128 v[136:139], v26 offset:0
    ds_read_b128 v[124:127], v20
    s_waitcnt lgkmcnt(10)
    v_mfma_f32_16x16x32_bf16 v[44:47], v[180:183], v[152:155], 0
    v_xor_b32 v20, 64, v20
    ds_read_b128 v[128:131], v21
    v_xor_b32 v21, 64, v21
    s_waitcnt lgkmcnt(9)
    v_mfma_f32_16x16x32_bf16 v[48:51], v[184:187], v[152:155], 0
    ds_read_b128 v[132:135], v22
    v_xor_b32 v22, 64, v22
    s_waitcnt lgkmcnt(9)
    v_mfma_f32_16x16x32_bf16 v[52:55], v[168:171], v[156:159], 0
    ds_read_b128 v[164:167], v4 offset:6144
    v_mfma_f32_16x16x32_bf16 v[56:59], v[172:175], v[156:159], 0
    ds_read_b64_tr_b16 v[196:197], v10 offset:5200
    v_mfma_f32_16x16x32_bf16 v[60:63], v[176:179], v[156:159], 0
    ds_read_b64_tr_b16 v[198:199], v11 offset:5200
    v_mfma_f32_16x16x32_bf16 v[64:67], v[180:183], v[156:159], 0
    ds_read_b64_tr_b16 v[200:201], v10 offset:5240
    v_mfma_f32_16x16x32_bf16 v[68:71], v[184:187], v[156:159], 0
    ds_read_b64_tr_b16 v[202:203], v11 offset:5240
    s_waitcnt lgkmcnt(7)
    v_mfma_f32_16x16x32_bf16 v[112:115], v[136:139], v[124:127], 0
    s_waitcnt lgkmcnt(6)
    v_mfma_f32_16x16x32_bf16 v[116:119], v[136:139], v[128:131], 0
    s_waitcnt lgkmcnt(5)
    v_mfma_f32_16x16x32_bf16 v[120:123], v[136:139], v[132:135], 0
    v_mfma_f32_16x16x32_bf16 v[72:75], v[168:171], v[160:163], 0
    ds_read_b128 v[152:155], v5 offset:0
    v_mfma_f32_16x16x32_bf16 v[76:79], v[172:175], v[160:163], 0
    ds_read_b64_tr_b16 v[204:205], v12 offset:5120
    v_mfma_f32_16x16x32_bf16 v[80:83], v[176:179], v[160:163], 0
    ds_read_b64_tr_b16 v[206:207], v13 offset:5120
    v_mfma_f32_16x16x32_bf16 v[84:87], v[180:183], v[160:163], 0
    v_mfma_f32_16x16x32_bf16 v[88:91], v[184:187], v[160:163], 0
    s_waitcnt lgkmcnt(7)
    v_mfma_f32_16x16x32_bf16 v[92:95], v[168:171], v[164:167], 0
    ds_read_b128 v[156:159], v5 offset:2048
    v_mfma_f32_16x16x32_bf16 v[96:99], v[172:175], v[164:167], 0
    v_mfma_f32_16x16x32_bf16 v[100:103], v[176:179], v[164:167], 0
    v_mfma_f32_16x16x32_bf16 v[104:107], v[180:183], v[164:167], 0
    v_mfma_f32_16x16x32_bf16 v[108:111], v[184:187], v[164:167], 0
    s_waitcnt lgkmcnt(3)
    v_mfma_f32_16x16x32_bf16 v[32:35], v[188:191], v[152:155], v[32:35]
    ds_read_b128 v[160:163], v5 offset:4096
    ds_read_b128 v[164:167], v5 offset:6144
    s_add_u32 s44, s44, 1
    v_mfma_f32_16x16x32_bf16 v[36:39], v[192:195], v[152:155], v[36:39]
    s_cmp_eq_u32 s44, 10
    s_cselect_b32 s44, 0, s44
    ds_read_b128 v[136:139], v26 offset:64
    v_mfma_f32_16x16x32_bf16 v[40:43], v[196:199], v[152:155], v[40:43]
    ds_read_b128 v[124:127], v20
    s_branch L_over_q_3
L_warm_q_3:
    s_branch L_warm_q_4
L_over_q_3:
    v_xor_b32_e64 v20, 64, v20
    v_add_u32 v20, 45056, v20
    v_mfma_f32_16x16x32_bf16 v[44:47], v[200:203], v[152:155], v[44:47]
    ds_read_b128 v[128:131], v21
    v_xor_b32_e64 v21, 64, v21
    v_add_u32 v21, 45056, v21
    s_waitcnt lgkmcnt(6)
    v_mfma_f32_16x16x32_bf16 v[48:51], v[204:207], v[152:155], v[48:51]
    ds_read_b128 v[132:135], v22
    v_xor_b32 v22, 64, v22
    v_add_u32 v22, 45056, v22
    s_waitcnt lgkmcnt(6)
    v_mfma_f32_16x16x32_bf16 v[52:55], v[188:191], v[156:159], v[52:55]
    v_mfma_f32_16x16x32_bf16 v[56:59], v[192:195], v[156:159], v[56:59]
    v_mfma_f32_16x16x32_bf16 v[60:63], v[196:199], v[156:159], v[60:63]
    v_mfma_f32_16x16x32_bf16 v[64:67], v[200:203], v[156:159], v[64:67]
    v_mfma_f32_16x16x32_bf16 v[68:71], v[204:207], v[156:159], v[68:71]
    s_waitcnt lgkmcnt(2)
    v_mfma_f32_16x16x32_bf16 v[112:115], v[136:139], v[124:127], v[112:115]
    s_waitcnt lgkmcnt(1)
    v_mfma_f32_16x16x32_bf16 v[116:119], v[136:139], v[128:131], v[116:119]
    s_waitcnt lgkmcnt(0)
    v_mfma_f32_16x16x32_bf16 v[120:123], v[136:139], v[132:135], v[120:123]
    v_mfma_f32_16x16x32_bf16 v[72:75], v[188:191], v[160:163], v[72:75]
    s_waitcnt vmcnt(0) lgkmcnt(0)
    s_barrier
    ds_read_b128 v[152:155], v6 offset:0
    v_mfma_f32_16x16x32_bf16 v[76:79], v[192:195], v[160:163], v[76:79]
    ds_read_b64_tr_b16 v[168:169], v10 offset:10240
    ds_read_b64_tr_b16 v[170:171], v11 offset:10240
    v_mfma_f32_16x16x32_bf16 v[80:83], v[196:199], v[160:163], v[80:83]
    ds_read_b64_tr_b16 v[172:173], v10 offset:10280
    v_mfma_f32_16x16x32_bf16 v[84:87], v[200:203], v[160:163], v[84:87]
    ds_read_b64_tr_b16 v[174:175], v11 offset:10280
    v_mfma_f32_16x16x32_bf16 v[88:91], v[204:207], v[160:163], v[88:91]
    ds_read_b64_tr_b16 v[176:177], v10 offset:10320
    v_mfma_f32_16x16x32_bf16 v[92:95], v[188:191], v[164:167], v[92:95]
    ds_read_b64_tr_b16 v[178:179], v11 offset:10320
    ds_read_b64_tr_b16 v[180:181], v10 offset:10360
    v_mfma_f32_16x16x32_bf16 v[96:99], v[192:195], v[164:167], v[96:99]
    ds_read_b64_tr_b16 v[182:183], v11 offset:10360
    v_mfma_f32_16x16x32_bf16 v[100:103], v[196:199], v[164:167], v[100:103]
    ds_read_b64_tr_b16 v[184:185], v12 offset:10240
    v_mfma_f32_16x16x32_bf16 v[104:107], v[200:203], v[164:167], v[104:107]
    ds_read_b64_tr_b16 v[186:187], v13 offset:10240
    v_mfma_f32_16x16x32_bf16 v[108:111], v[204:207], v[164:167], v[108:111]
    ds_read_b128 v[156:159], v6 offset:2048
    s_waitcnt lgkmcnt(9)
    v_mfma_f32_16x16x32_bf16 v[32:35], v[168:171], v[152:155], v[32:35]
    ds_read_b128 v[160:163], v6 offset:4096
    ds_read_b64_tr_b16 v[188:189], v10 offset:15360
    ds_read_b64_tr_b16 v[190:191], v11 offset:15360
    s_waitcnt lgkmcnt(10)
    v_mfma_f32_16x16x32_bf16 v[36:39], v[172:175], v[152:155], v[36:39]
    ds_read_b64_tr_b16 v[192:193], v10 offset:15400
    ds_read_b64_tr_b16 v[194:195], v11 offset:15400
    s_lshl_b32 s45, s44, 7
    s_waitcnt lgkmcnt(10)
    v_mfma_f32_16x16x32_bf16 v[40:43], v[176:179], v[152:155], v[40:43]
    v_add_u32_e64 v26, s45, v23
    ds_read_b128 v[136:139], v26 offset:0
    ds_read_b128 v[124:127], v20
    s_waitcnt lgkmcnt(10)
    v_mfma_f32_16x16x32_bf16 v[44:47], v[180:183], v[152:155], v[44:47]
    v_xor_b32 v20, 64, v20
    ds_read_b128 v[128:131], v21
    v_xor_b32 v21, 64, v21
    s_waitcnt lgkmcnt(9)
    v_mfma_f32_16x16x32_bf16 v[48:51], v[184:187], v[152:155], v[48:51]
    ds_read_b128 v[132:135], v22
    v_xor_b32 v22, 64, v22
    s_waitcnt lgkmcnt(9)
    v_mfma_f32_16x16x32_bf16 v[52:55], v[168:171], v[156:159], v[52:55]
    ds_read_b128 v[164:167], v6 offset:6144
    v_mfma_f32_16x16x32_bf16 v[56:59], v[172:175], v[156:159], v[56:59]
    ds_read_b64_tr_b16 v[196:197], v10 offset:15440
    v_mfma_f32_16x16x32_bf16 v[60:63], v[176:179], v[156:159], v[60:63]
    ds_read_b64_tr_b16 v[198:199], v11 offset:15440
    v_mfma_f32_16x16x32_bf16 v[64:67], v[180:183], v[156:159], v[64:67]
    ds_read_b64_tr_b16 v[200:201], v10 offset:15480
    v_mfma_f32_16x16x32_bf16 v[68:71], v[184:187], v[156:159], v[68:71]
    ds_read_b64_tr_b16 v[202:203], v11 offset:15480
    s_waitcnt lgkmcnt(7)
    v_mfma_f32_16x16x32_bf16 v[112:115], v[136:139], v[124:127], v[112:115]
    s_waitcnt lgkmcnt(6)
    v_mfma_f32_16x16x32_bf16 v[116:119], v[136:139], v[128:131], v[116:119]
    s_waitcnt lgkmcnt(5)
    v_mfma_f32_16x16x32_bf16 v[120:123], v[136:139], v[132:135], v[120:123]
    v_mfma_f32_16x16x32_bf16 v[72:75], v[168:171], v[160:163], v[72:75]
    ds_read_b128 v[152:155], v7 offset:0
    v_mfma_f32_16x16x32_bf16 v[76:79], v[172:175], v[160:163], v[76:79]
    ds_read_b64_tr_b16 v[204:205], v12 offset:15360
    v_mfma_f32_16x16x32_bf16 v[80:83], v[176:179], v[160:163], v[80:83]
    ds_read_b64_tr_b16 v[206:207], v13 offset:15360
    v_mfma_f32_16x16x32_bf16 v[84:87], v[180:183], v[160:163], v[84:87]
    v_mfma_f32_16x16x32_bf16 v[88:91], v[184:187], v[160:163], v[88:91]
    s_waitcnt lgkmcnt(7)
    v_mfma_f32_16x16x32_bf16 v[92:95], v[168:171], v[164:167], v[92:95]
    ds_read_b128 v[156:159], v7 offset:2048
    v_mfma_f32_16x16x32_bf16 v[96:99], v[172:175], v[164:167], v[96:99]
    v_mfma_f32_16x16x32_bf16 v[100:103], v[176:179], v[164:167], v[100:103]
    v_mfma_f32_16x16x32_bf16 v[104:107], v[180:183], v[164:167], v[104:107]
    v_mfma_f32_16x16x32_bf16 v[108:111], v[184:187], v[164:167], v[108:111]
    s_waitcnt lgkmcnt(3)
    v_mfma_f32_16x16x32_bf16 v[32:35], v[188:191], v[152:155], v[32:35]
    ds_read_b128 v[160:163], v7 offset:4096
    ds_read_b128 v[164:167], v7 offset:6144
    s_add_u32 s44, s44, 1
    v_mfma_f32_16x16x32_bf16 v[36:39], v[192:195], v[152:155], v[36:39]
    s_cmp_eq_u32 s44, 10
    s_cselect_b32 s44, 0, s44
    ds_read_b128 v[136:139], v26 offset:64
    v_mfma_f32_16x16x32_bf16 v[40:43], v[196:199], v[152:155], v[40:43]
    ds_read_b128 v[124:127], v20
    v_xor_b32_e64 v20, 64, v20
    v_add_u32 v20, 45056, v20
    v_mfma_f32_16x16x32_bf16 v[44:47], v[200:203], v[152:155], v[44:47]
    ds_read_b128 v[128:131], v21
    v_xor_b32_e64 v21, 64, v21
    v_add_u32 v21, 45056, v21
    s_waitcnt lgkmcnt(6)
    v_mfma_f32_16x16x32_bf16 v[48:51], v[204:207], v[152:155], v[48:51]
    ds_read_b128 v[132:135], v22
    v_xor_b32 v22, 64, v22
    v_add_u32 v22, 45056, v22
    s_waitcnt lgkmcnt(6)
    v_mfma_f32_16x16x32_bf16 v[52:55], v[188:191], v[156:159], v[52:55]
    v_mfma_f32_16x16x32_bf16 v[56:59], v[192:195], v[156:159], v[56:59]
    v_mfma_f32_16x16x32_bf16 v[60:63], v[196:199], v[156:159], v[60:63]
    v_mfma_f32_16x16x32_bf16 v[64:67], v[200:203], v[156:159], v[64:67]
    v_mfma_f32_16x16x32_bf16 v[68:71], v[204:207], v[156:159], v[68:71]
    s_waitcnt lgkmcnt(2)
    v_mfma_f32_16x16x32_bf16 v[112:115], v[136:139], v[124:127], v[112:115]
    s_waitcnt lgkmcnt(1)
    v_mfma_f32_16x16x32_bf16 v[116:119], v[136:139], v[128:131], v[116:119]
    s_waitcnt lgkmcnt(0)
    v_mfma_f32_16x16x32_bf16 v[120:123], v[136:139], v[132:135], v[120:123]
    v_mfma_f32_16x16x32_bf16 v[72:75], v[188:191], v[160:163], v[72:75]
    s_waitcnt lgkmcnt(0)
    s_barrier
    ds_read_b128 v[152:155], v8 offset:0
    v_mfma_f32_16x16x32_bf16 v[76:79], v[192:195], v[160:163], v[76:79]
    ds_read_b64_tr_b16 v[168:169], v10 offset:0
    ds_read_b64_tr_b16 v[170:171], v11 offset:0
    v_mfma_f32_16x16x32_bf16 v[80:83], v[196:199], v[160:163], v[80:83]
    ds_read_b64_tr_b16 v[172:173], v10 offset:40
    v_mfma_f32_16x16x32_bf16 v[84:87], v[200:203], v[160:163], v[84:87]
    ds_read_b64_tr_b16 v[174:175], v11 offset:40
    v_mfma_f32_16x16x32_bf16 v[88:91], v[204:207], v[160:163], v[88:91]
    ds_read_b64_tr_b16 v[176:177], v10 offset:80
    v_mfma_f32_16x16x32_bf16 v[92:95], v[188:191], v[164:167], v[92:95]
    ds_read_b64_tr_b16 v[178:179], v11 offset:80
    ds_read_b64_tr_b16 v[180:181], v10 offset:120
    v_mfma_f32_16x16x32_bf16 v[96:99], v[192:195], v[164:167], v[96:99]
    ds_read_b64_tr_b16 v[182:183], v11 offset:120
    v_mfma_f32_16x16x32_bf16 v[100:103], v[196:199], v[164:167], v[100:103]
    ds_read_b64_tr_b16 v[184:185], v12 offset:0
    v_mfma_f32_16x16x32_bf16 v[104:107], v[200:203], v[164:167], v[104:107]
    ds_read_b64_tr_b16 v[186:187], v13 offset:0
    v_mfma_f32_16x16x32_bf16 v[108:111], v[204:207], v[164:167], v[108:111]
    ds_read_b128 v[156:159], v8 offset:2048
    s_waitcnt lgkmcnt(9)
    v_mfma_f32_16x16x32_bf16 v[32:35], v[168:171], v[152:155], v[32:35]
    ds_read_b128 v[160:163], v8 offset:4096
    ds_read_b64_tr_b16 v[188:189], v10 offset:5120
    ds_read_b64_tr_b16 v[190:191], v11 offset:5120
    s_waitcnt lgkmcnt(10)
    v_mfma_f32_16x16x32_bf16 v[36:39], v[172:175], v[152:155], v[36:39]
    ds_read_b64_tr_b16 v[192:193], v10 offset:5160
    ds_read_b64_tr_b16 v[194:195], v11 offset:5160
    s_lshl_b32 s45, s44, 7
    s_waitcnt lgkmcnt(10)
    v_mfma_f32_16x16x32_bf16 v[40:43], v[176:179], v[152:155], v[40:43]
    v_add_u32_e64 v26, s45, v23
    ds_read_b128 v[136:139], v26 offset:0
    ds_read_b128 v[124:127], v20
    s_waitcnt lgkmcnt(10)
    v_mfma_f32_16x16x32_bf16 v[44:47], v[180:183], v[152:155], v[44:47]
    v_xor_b32 v20, 64, v20
    ds_read_b128 v[128:131], v21
    v_xor_b32 v21, 64, v21
    s_waitcnt lgkmcnt(9)
    v_mfma_f32_16x16x32_bf16 v[48:51], v[184:187], v[152:155], v[48:51]
    ds_read_b128 v[132:135], v22
    v_xor_b32 v22, 64, v22
    s_waitcnt lgkmcnt(9)
    v_mfma_f32_16x16x32_bf16 v[52:55], v[168:171], v[156:159], v[52:55]
    ds_read_b128 v[164:167], v8 offset:6144
    v_mfma_f32_16x16x32_bf16 v[56:59], v[172:175], v[156:159], v[56:59]
    ds_read_b64_tr_b16 v[196:197], v10 offset:5200
    v_mfma_f32_16x16x32_bf16 v[60:63], v[176:179], v[156:159], v[60:63]
    ds_read_b64_tr_b16 v[198:199], v11 offset:5200
    v_mfma_f32_16x16x32_bf16 v[64:67], v[180:183], v[156:159], v[64:67]
    ds_read_b64_tr_b16 v[200:201], v10 offset:5240
    v_mfma_f32_16x16x32_bf16 v[68:71], v[184:187], v[156:159], v[68:71]
    ds_read_b64_tr_b16 v[202:203], v11 offset:5240
    s_waitcnt lgkmcnt(7)
    v_mfma_f32_16x16x32_bf16 v[112:115], v[136:139], v[124:127], v[112:115]
    s_waitcnt lgkmcnt(6)
    v_mfma_f32_16x16x32_bf16 v[116:119], v[136:139], v[128:131], v[116:119]
    s_waitcnt lgkmcnt(5)
    v_mfma_f32_16x16x32_bf16 v[120:123], v[136:139], v[132:135], v[120:123]
    v_mfma_f32_16x16x32_bf16 v[72:75], v[168:171], v[160:163], v[72:75]
    ds_read_b128 v[152:155], v9 offset:0
    v_mfma_f32_16x16x32_bf16 v[76:79], v[172:175], v[160:163], v[76:79]
    ds_read_b64_tr_b16 v[204:205], v12 offset:5120
    v_mfma_f32_16x16x32_bf16 v[80:83], v[176:179], v[160:163], v[80:83]
    ds_read_b64_tr_b16 v[206:207], v13 offset:5120
    v_mfma_f32_16x16x32_bf16 v[84:87], v[180:183], v[160:163], v[84:87]
    v_mfma_f32_16x16x32_bf16 v[88:91], v[184:187], v[160:163], v[88:91]
    s_waitcnt lgkmcnt(7)
    v_mfma_f32_16x16x32_bf16 v[92:95], v[168:171], v[164:167], v[92:95]
    ds_read_b128 v[156:159], v9 offset:2048
    v_mfma_f32_16x16x32_bf16 v[96:99], v[172:175], v[164:167], v[96:99]
    v_mfma_f32_16x16x32_bf16 v[100:103], v[176:179], v[164:167], v[100:103]
    v_mfma_f32_16x16x32_bf16 v[104:107], v[180:183], v[164:167], v[104:107]
    v_mfma_f32_16x16x32_bf16 v[108:111], v[184:187], v[164:167], v[108:111]
    s_waitcnt lgkmcnt(3)
    v_mfma_f32_16x16x32_bf16 v[32:35], v[188:191], v[152:155], v[32:35]
    ds_read_b128 v[160:163], v9 offset:4096
    ds_read_b128 v[164:167], v9 offset:6144
    s_add_u32 s44, s44, 1
    v_mfma_f32_16x16x32_bf16 v[36:39], v[192:195], v[152:155], v[36:39]
    s_cmp_eq_u32 s44, 10
    s_cselect_b32 s44, 0, s44
    ds_read_b128 v[136:139], v26 offset:64
    v_mfma_f32_16x16x32_bf16 v[40:43], v[196:199], v[152:155], v[40:43]
    ds_read_b128 v[124:127], v20
    v_xor_b32_e64 v20, 64, v20
    v_add_u32 v20, -90112, v20
    v_mfma_f32_16x16x32_bf16 v[44:47], v[200:203], v[152:155], v[44:47]
    ds_read_b128 v[128:131], v21
    v_xor_b32_e64 v21, 64, v21
    v_add_u32 v21, -90112, v21
    s_waitcnt lgkmcnt(6)
    v_mfma_f32_16x16x32_bf16 v[48:51], v[204:207], v[152:155], v[48:51]
    ds_read_b128 v[132:135], v22
    v_xor_b32 v22, 64, v22
    v_add_u32 v22, -90112, v22
    s_waitcnt lgkmcnt(6)
    v_mfma_f32_16x16x32_bf16 v[52:55], v[188:191], v[156:159], v[52:55]
    v_mfma_f32_16x16x32_bf16 v[56:59], v[192:195], v[156:159], v[56:59]
    v_mfma_f32_16x16x32_bf16 v[60:63], v[196:199], v[156:159], v[60:63]
    v_mfma_f32_16x16x32_bf16 v[64:67], v[200:203], v[156:159], v[64:67]
    v_mfma_f32_16x16x32_bf16 v[68:71], v[204:207], v[156:159], v[68:71]
    s_waitcnt lgkmcnt(2)
    v_mfma_f32_16x16x32_bf16 v[112:115], v[136:139], v[124:127], v[112:115]
    s_waitcnt lgkmcnt(1)
    v_mfma_f32_16x16x32_bf16 v[116:119], v[136:139], v[128:131], v[116:119]
    s_waitcnt lgkmcnt(0)
    v_mfma_f32_16x16x32_bf16 v[120:123], v[136:139], v[132:135], v[120:123]
    v_mfma_f32_16x16x32_bf16 v[72:75], v[188:191], v[160:163], v[72:75]
    s_waitcnt lgkmcnt(0)
    s_barrier
    ds_read_b128 v[152:155], v4 offset:0
    v_mfma_f32_16x16x32_bf16 v[76:79], v[192:195], v[160:163], v[76:79]
    ds_read_b64_tr_b16 v[168:169], v10 offset:10240
    ds_read_b64_tr_b16 v[170:171], v11 offset:10240
    v_mfma_f32_16x16x32_bf16 v[80:83], v[196:199], v[160:163], v[80:83]
    ds_read_b64_tr_b16 v[172:173], v10 offset:10280
    v_mfma_f32_16x16x32_bf16 v[84:87], v[200:203], v[160:163], v[84:87]
    ds_read_b64_tr_b16 v[174:175], v11 offset:10280
    v_mfma_f32_16x16x32_bf16 v[88:91], v[204:207], v[160:163], v[88:91]
    ds_read_b64_tr_b16 v[176:177], v10 offset:10320
    v_mfma_f32_16x16x32_bf16 v[92:95], v[188:191], v[164:167], v[92:95]
    ds_read_b64_tr_b16 v[178:179], v11 offset:10320
    ds_read_b64_tr_b16 v[180:181], v10 offset:10360
    v_mfma_f32_16x16x32_bf16 v[96:99], v[192:195], v[164:167], v[96:99]
    ds_read_b64_tr_b16 v[182:183], v11 offset:10360
    v_mfma_f32_16x16x32_bf16 v[100:103], v[196:199], v[164:167], v[100:103]
    ds_read_b64_tr_b16 v[184:185], v12 offset:10240
    v_mfma_f32_16x16x32_bf16 v[104:107], v[200:203], v[164:167], v[104:107]
    ds_read_b64_tr_b16 v[186:187], v13 offset:10240
    v_mfma_f32_16x16x32_bf16 v[108:111], v[204:207], v[164:167], v[108:111]
    ds_read_b128 v[156:159], v4 offset:2048
    s_waitcnt lgkmcnt(9)
    v_mfma_f32_16x16x32_bf16 v[32:35], v[168:171], v[152:155], v[32:35]
    ds_read_b128 v[160:163], v4 offset:4096
    ds_read_b64_tr_b16 v[188:189], v10 offset:15360
    ds_read_b64_tr_b16 v[190:191], v11 offset:15360
    s_waitcnt lgkmcnt(10)
    v_mfma_f32_16x16x32_bf16 v[36:39], v[172:175], v[152:155], v[36:39]
    ds_read_b64_tr_b16 v[192:193], v10 offset:15400
    ds_read_b64_tr_b16 v[194:195], v11 offset:15400
    s_lshl_b32 s45, s44, 7
    s_waitcnt lgkmcnt(10)
    v_mfma_f32_16x16x32_bf16 v[40:43], v[176:179], v[152:155], v[40:43]
    v_add_u32_e64 v26, s45, v23
    ds_read_b128 v[136:139], v26 offset:0
    ds_read_b128 v[124:127], v20
    s_waitcnt lgkmcnt(10)
    v_mfma_f32_16x16x32_bf16 v[44:47], v[180:183], v[152:155], v[44:47]
    v_xor_b32 v20, 64, v20
    ds_read_b128 v[128:131], v21
    v_xor_b32 v21, 64, v21
    s_waitcnt lgkmcnt(9)
    v_mfma_f32_16x16x32_bf16 v[48:51], v[184:187], v[152:155], v[48:51]
    ds_read_b128 v[132:135], v22
    v_xor_b32 v22, 64, v22
    s_waitcnt lgkmcnt(9)
    v_mfma_f32_16x16x32_bf16 v[52:55], v[168:171], v[156:159], v[52:55]
    ds_read_b128 v[164:167], v4 offset:6144
    v_mfma_f32_16x16x32_bf16 v[56:59], v[172:175], v[156:159], v[56:59]
    ds_read_b64_tr_b16 v[196:197], v10 offset:15440
    v_mfma_f32_16x16x32_bf16 v[60:63], v[176:179], v[156:159], v[60:63]
    ds_read_b64_tr_b16 v[198:199], v11 offset:15440
    v_mfma_f32_16x16x32_bf16 v[64:67], v[180:183], v[156:159], v[64:67]
    ds_read_b64_tr_b16 v[200:201], v10 offset:15480
    v_mfma_f32_16x16x32_bf16 v[68:71], v[184:187], v[156:159], v[68:71]
    ds_read_b64_tr_b16 v[202:203], v11 offset:15480
    s_waitcnt lgkmcnt(7)
    v_mfma_f32_16x16x32_bf16 v[112:115], v[136:139], v[124:127], v[112:115]
    s_waitcnt lgkmcnt(6)
    v_mfma_f32_16x16x32_bf16 v[116:119], v[136:139], v[128:131], v[116:119]
    s_waitcnt lgkmcnt(5)
    v_mfma_f32_16x16x32_bf16 v[120:123], v[136:139], v[132:135], v[120:123]
    v_mfma_f32_16x16x32_bf16 v[72:75], v[168:171], v[160:163], v[72:75]
    ds_read_b128 v[152:155], v5 offset:0
    v_mfma_f32_16x16x32_bf16 v[76:79], v[172:175], v[160:163], v[76:79]
    ds_read_b64_tr_b16 v[204:205], v12 offset:15360
    v_mfma_f32_16x16x32_bf16 v[80:83], v[176:179], v[160:163], v[80:83]
    ds_read_b64_tr_b16 v[206:207], v13 offset:15360
    v_mfma_f32_16x16x32_bf16 v[84:87], v[180:183], v[160:163], v[84:87]
    v_mfma_f32_16x16x32_bf16 v[88:91], v[184:187], v[160:163], v[88:91]
    s_waitcnt lgkmcnt(7)
    v_mfma_f32_16x16x32_bf16 v[92:95], v[168:171], v[164:167], v[92:95]
    ds_read_b128 v[156:159], v5 offset:2048
    v_mfma_f32_16x16x32_bf16 v[96:99], v[172:175], v[164:167], v[96:99]
    v_mfma_f32_16x16x32_bf16 v[100:103], v[176:179], v[164:167], v[100:103]
    v_mfma_f32_16x16x32_bf16 v[104:107], v[180:183], v[164:167], v[104:107]
    v_mfma_f32_16x16x32_bf16 v[108:111], v[184:187], v[164:167], v[108:111]
    s_waitcnt lgkmcnt(3)
    v_mfma_f32_16x16x32_bf16 v[32:35], v[188:191], v[152:155], v[32:35]
    ds_read_b128 v[160:163], v5 offset:4096
    ds_read_b128 v[164:167], v5 offset:6144
    s_add_u32 s44, s44, 1
    v_mfma_f32_16x16x32_bf16 v[36:39], v[192:195], v[152:155], v[36:39]
    s_cmp_eq_u32 s44, 10
    s_cselect_b32 s44, 0, s44
    ds_read_b128 v[136:139], v26 offset:64
    v_mfma_f32_16x16x32_bf16 v[40:43], v[196:199], v[152:155], v[40:43]
    ds_read_b128 v[124:127], v20
    v_xor_b32_e64 v20, 64, v20
    v_add_u32 v20, 45056, v20
    v_mfma_f32_16x16x32_bf16 v[44:47], v[200:203], v[152:155], v[44:47]
    ds_read_b128 v[128:131], v21
    v_xor_b32_e64 v21, 64, v21
    v_add_u32 v21, 45056, v21
    s_waitcnt lgkmcnt(6)
    v_mfma_f32_16x16x32_bf16 v[48:51], v[204:207], v[152:155], v[48:51]
    ds_read_b128 v[132:135], v22
    v_xor_b32 v22, 64, v22
    v_add_u32 v22, 45056, v22
    s_waitcnt lgkmcnt(6)
    v_mfma_f32_16x16x32_bf16 v[52:55], v[188:191], v[156:159], v[52:55]
    v_mfma_f32_16x16x32_bf16 v[56:59], v[192:195], v[156:159], v[56:59]
    v_mfma_f32_16x16x32_bf16 v[60:63], v[196:199], v[156:159], v[60:63]
    v_mfma_f32_16x16x32_bf16 v[64:67], v[200:203], v[156:159], v[64:67]
    v_mfma_f32_16x16x32_bf16 v[68:71], v[204:207], v[156:159], v[68:71]
    s_waitcnt lgkmcnt(2)
    v_mfma_f32_16x16x32_bf16 v[112:115], v[136:139], v[124:127], v[112:115]
    s_waitcnt lgkmcnt(1)
    v_mfma_f32_16x16x32_bf16 v[116:119], v[136:139], v[128:131], v[116:119]
    s_waitcnt lgkmcnt(0)
    v_mfma_f32_16x16x32_bf16 v[120:123], v[136:139], v[132:135], v[120:123]
    v_mfma_f32_16x16x32_bf16 v[72:75], v[188:191], v[160:163], v[72:75]
    s_waitcnt lgkmcnt(0)
    s_barrier
    ds_read_b128 v[152:155], v6 offset:0
    v_mfma_f32_16x16x32_bf16 v[76:79], v[192:195], v[160:163], v[76:79]
    ds_read_b64_tr_b16 v[168:169], v10 offset:0
    ds_read_b64_tr_b16 v[170:171], v11 offset:0
    v_mfma_f32_16x16x32_bf16 v[80:83], v[196:199], v[160:163], v[80:83]
    ds_read_b64_tr_b16 v[172:173], v10 offset:40
    v_mfma_f32_16x16x32_bf16 v[84:87], v[200:203], v[160:163], v[84:87]
    ds_read_b64_tr_b16 v[174:175], v11 offset:40
    v_mfma_f32_16x16x32_bf16 v[88:91], v[204:207], v[160:163], v[88:91]
    ds_read_b64_tr_b16 v[176:177], v10 offset:80
    v_mfma_f32_16x16x32_bf16 v[92:95], v[188:191], v[164:167], v[92:95]
    ds_read_b64_tr_b16 v[178:179], v11 offset:80
    ds_read_b64_tr_b16 v[180:181], v10 offset:120
    v_mfma_f32_16x16x32_bf16 v[96:99], v[192:195], v[164:167], v[96:99]
    ds_read_b64_tr_b16 v[182:183], v11 offset:120
    v_mfma_f32_16x16x32_bf16 v[100:103], v[196:199], v[164:167], v[100:103]
    ds_read_b64_tr_b16 v[184:185], v12 offset:0
    v_mfma_f32_16x16x32_bf16 v[104:107], v[200:203], v[164:167], v[104:107]
    ds_read_b64_tr_b16 v[186:187], v13 offset:0
    v_mfma_f32_16x16x32_bf16 v[108:111], v[204:207], v[164:167], v[108:111]
    ds_read_b128 v[156:159], v6 offset:2048
    s_waitcnt lgkmcnt(9)
    v_mfma_f32_16x16x32_bf16 v[32:35], v[168:171], v[152:155], v[32:35]
    ds_read_b128 v[160:163], v6 offset:4096
    ds_read_b64_tr_b16 v[188:189], v10 offset:5120
    ds_read_b64_tr_b16 v[190:191], v11 offset:5120
    s_waitcnt lgkmcnt(10)
    v_mfma_f32_16x16x32_bf16 v[36:39], v[172:175], v[152:155], v[36:39]
    ds_read_b64_tr_b16 v[192:193], v10 offset:5160
    ds_read_b64_tr_b16 v[194:195], v11 offset:5160
    s_lshl_b32 s45, s44, 7
    s_waitcnt lgkmcnt(10)
    v_mfma_f32_16x16x32_bf16 v[40:43], v[176:179], v[152:155], v[40:43]
    v_add_u32_e64 v26, s45, v23
    ds_read_b128 v[136:139], v26 offset:0
    ds_read_b128 v[124:127], v20
    s_waitcnt lgkmcnt(10)
    v_mfma_f32_16x16x32_bf16 v[44:47], v[180:183], v[152:155], v[44:47]
    v_xor_b32 v20, 64, v20
    ds_read_b128 v[128:131], v21
    v_xor_b32 v21, 64, v21
    s_waitcnt lgkmcnt(9)
    v_mfma_f32_16x16x32_bf16 v[48:51], v[184:187], v[152:155], v[48:51]
    ds_read_b128 v[132:135], v22
    v_xor_b32 v22, 64, v22
    s_waitcnt lgkmcnt(9)
    v_mfma_f32_16x16x32_bf16 v[52:55], v[168:171], v[156:159], v[52:55]
    ds_read_b128 v[164:167], v6 offset:6144
    v_mfma_f32_16x16x32_bf16 v[56:59], v[172:175], v[156:159], v[56:59]
    ds_read_b64_tr_b16 v[196:197], v10 offset:5200
    v_mfma_f32_16x16x32_bf16 v[60:63], v[176:179], v[156:159], v[60:63]
    ds_read_b64_tr_b16 v[198:199], v11 offset:5200
    v_mfma_f32_16x16x32_bf16 v[64:67], v[180:183], v[156:159], v[64:67]
    ds_read_b64_tr_b16 v[200:201], v10 offset:5240
    v_mfma_f32_16x16x32_bf16 v[68:71], v[184:187], v[156:159], v[68:71]
    ds_read_b64_tr_b16 v[202:203], v11 offset:5240
    s_waitcnt lgkmcnt(7)
    v_mfma_f32_16x16x32_bf16 v[112:115], v[136:139], v[124:127], v[112:115]
    s_waitcnt lgkmcnt(6)
    v_mfma_f32_16x16x32_bf16 v[116:119], v[136:139], v[128:131], v[116:119]
    s_waitcnt lgkmcnt(5)
    v_mfma_f32_16x16x32_bf16 v[120:123], v[136:139], v[132:135], v[120:123]
    v_mfma_f32_16x16x32_bf16 v[72:75], v[168:171], v[160:163], v[72:75]
    ds_read_b128 v[152:155], v7 offset:0
    v_mfma_f32_16x16x32_bf16 v[76:79], v[172:175], v[160:163], v[76:79]
    ds_read_b64_tr_b16 v[204:205], v12 offset:5120
    v_mfma_f32_16x16x32_bf16 v[80:83], v[176:179], v[160:163], v[80:83]
    ds_read_b64_tr_b16 v[206:207], v13 offset:5120
    v_mfma_f32_16x16x32_bf16 v[84:87], v[180:183], v[160:163], v[84:87]
    v_mfma_f32_16x16x32_bf16 v[88:91], v[184:187], v[160:163], v[88:91]
    s_waitcnt lgkmcnt(7)
    v_mfma_f32_16x16x32_bf16 v[92:95], v[168:171], v[164:167], v[92:95]
    ds_read_b128 v[156:159], v7 offset:2048
    v_mfma_f32_16x16x32_bf16 v[96:99], v[172:175], v[164:167], v[96:99]
    v_mfma_f32_16x16x32_bf16 v[100:103], v[176:179], v[164:167], v[100:103]
    v_mfma_f32_16x16x32_bf16 v[104:107], v[180:183], v[164:167], v[104:107]
    v_mfma_f32_16x16x32_bf16 v[108:111], v[184:187], v[164:167], v[108:111]
    s_waitcnt lgkmcnt(3)
    v_mfma_f32_16x16x32_bf16 v[32:35], v[188:191], v[152:155], v[32:35]
    ds_read_b128 v[160:163], v7 offset:4096
    ds_read_b128 v[164:167], v7 offset:6144
    s_add_u32 s44, s44, 1
    v_mfma_f32_16x16x32_bf16 v[36:39], v[192:195], v[152:155], v[36:39]
    s_cmp_eq_u32 s44, 10
    s_cselect_b32 s44, 0, s44
    ds_read_b128 v[136:139], v26 offset:64
    v_mfma_f32_16x16x32_bf16 v[40:43], v[196:199], v[152:155], v[40:43]
    ds_read_b128 v[124:127], v20
    v_xor_b32_e64 v20, 64, v20
    v_add_u32 v20, 45056, v20
    v_mfma_f32_16x16x32_bf16 v[44:47], v[200:203], v[152:155], v[44:47]
    ds_read_b128 v[128:131], v21
    v_xor_b32_e64 v21, 64, v21
    v_add_u32 v21, 45056, v21
    s_waitcnt lgkmcnt(6)
    v_mfma_f32_16x16x32_bf16 v[48:51], v[204:207], v[152:155], v[48:51]
    ds_read_b128 v[132:135], v22
    v_xor_b32 v22, 64, v22
    v_add_u32 v22, 45056, v22
    s_waitcnt lgkmcnt(6)
    v_mfma_f32_16x16x32_bf16 v[52:55], v[188:191], v[156:159], v[52:55]
    v_mfma_f32_16x16x32_bf16 v[56:59], v[192:195], v[156:159], v[56:59]
    v_mfma_f32_16x16x32_bf16 v[60:63], v[196:199], v[156:159], v[60:63]
    v_mfma_f32_16x16x32_bf16 v[64:67], v[200:203], v[156:159], v[64:67]
    v_mfma_f32_16x16x32_bf16 v[68:71], v[204:207], v[156:159], v[68:71]
    s_waitcnt lgkmcnt(2)
    v_mfma_f32_16x16x32_bf16 v[112:115], v[136:139], v[124:127], v[112:115]
    s_waitcnt lgkmcnt(1)
    v_mfma_f32_16x16x32_bf16 v[116:119], v[136:139], v[128:131], v[116:119]
    s_waitcnt lgkmcnt(0)
    v_mfma_f32_16x16x32_bf16 v[120:123], v[136:139], v[132:135], v[120:123]
    v_mfma_f32_16x16x32_bf16 v[72:75], v[188:191], v[160:163], v[72:75]
    s_waitcnt lgkmcnt(0)
    s_barrier
    ds_read_b128 v[152:155], v8 offset:0
    v_mfma_f32_16x16x32_bf16 v[76:79], v[192:195], v[160:163], v[76:79]
    ds_read_b64_tr_b16 v[168:169], v10 offset:10240
    ds_read_b64_tr_b16 v[170:171], v11 offset:10240
    v_mfma_f32_16x16x32_bf16 v[80:83], v[196:199], v[160:163], v[80:83]
    ds_read_b64_tr_b16 v[172:173], v10 offset:10280
    v_mfma_f32_16x16x32_bf16 v[84:87], v[200:203], v[160:163], v[84:87]
    ds_read_b64_tr_b16 v[174:175], v11 offset:10280
    v_mfma_f32_16x16x32_bf16 v[88:91], v[204:207], v[160:163], v[88:91]
    ds_read_b64_tr_b16 v[176:177], v10 offset:10320
    v_mfma_f32_16x16x32_bf16 v[92:95], v[188:191], v[164:167], v[92:95]
    ds_read_b64_tr_b16 v[178:179], v11 offset:10320
    ds_read_b64_tr_b16 v[180:181], v10 offset:10360
    v_mfma_f32_16x16x32_bf16 v[96:99], v[192:195], v[164:167], v[96:99]
    ds_read_b64_tr_b16 v[182:183], v11 offset:10360
    v_mfma_f32_16x16x32_bf16 v[100:103], v[196:199], v[164:167], v[100:103]
    ds_read_b64_tr_b16 v[184:185], v12 offset:10240
    v_mfma_f32_16x16x32_bf16 v[104:107], v[200:203], v[164:167], v[104:107]
    ds_read_b64_tr_b16 v[186:187], v13 offset:10240
    v_mfma_f32_16x16x32_bf16 v[108:111], v[204:207], v[164:167], v[108:111]
    ds_read_b128 v[156:159], v8 offset:2048
    s_waitcnt lgkmcnt(9)
    v_mfma_f32_16x16x32_bf16 v[32:35], v[168:171], v[152:155], v[32:35]
    ds_read_b128 v[160:163], v8 offset:4096
    ds_read_b64_tr_b16 v[188:189], v10 offset:15360
    ds_read_b64_tr_b16 v[190:191], v11 offset:15360
    s_waitcnt lgkmcnt(10)
    v_mfma_f32_16x16x32_bf16 v[36:39], v[172:175], v[152:155], v[36:39]
    ds_read_b64_tr_b16 v[192:193], v10 offset:15400
    ds_read_b64_tr_b16 v[194:195], v11 offset:15400
    s_lshl_b32 s45, s44, 7
    s_waitcnt lgkmcnt(10)
    v_mfma_f32_16x16x32_bf16 v[40:43], v[176:179], v[152:155], v[40:43]
    v_add_u32_e64 v26, s45, v23
    ds_read_b128 v[136:139], v26 offset:0
    ds_read_b128 v[124:127], v20
    s_waitcnt lgkmcnt(10)
    v_mfma_f32_16x16x32_bf16 v[44:47], v[180:183], v[152:155], v[44:47]
    v_xor_b32 v20, 64, v20
    ds_read_b128 v[128:131], v21
    v_xor_b32 v21, 64, v21
    s_waitcnt lgkmcnt(9)
    v_mfma_f32_16x16x32_bf16 v[48:51], v[184:187], v[152:155], v[48:51]
    ds_read_b128 v[132:135], v22
    v_xor_b32 v22, 64, v22
    s_waitcnt lgkmcnt(9)
    v_mfma_f32_16x16x32_bf16 v[52:55], v[168:171], v[156:159], v[52:55]
    ds_read_b128 v[164:167], v8 offset:6144
    v_mfma_f32_16x16x32_bf16 v[56:59], v[172:175], v[156:159], v[56:59]
    ds_read_b64_tr_b16 v[196:197], v10 offset:15440
    v_mfma_f32_16x16x32_bf16 v[60:63], v[176:179], v[156:159], v[60:63]
    ds_read_b64_tr_b16 v[198:199], v11 offset:15440
    v_mfma_f32_16x16x32_bf16 v[64:67], v[180:183], v[156:159], v[64:67]
    ds_read_b64_tr_b16 v[200:201], v10 offset:15480
    v_mfma_f32_16x16x32_bf16 v[68:71], v[184:187], v[156:159], v[68:71]
    ds_read_b64_tr_b16 v[202:203], v11 offset:15480
    s_waitcnt lgkmcnt(7)
    v_mfma_f32_16x16x32_bf16 v[112:115], v[136:139], v[124:127], v[112:115]
    s_waitcnt lgkmcnt(6)
    v_mfma_f32_16x16x32_bf16 v[116:119], v[136:139], v[128:131], v[116:119]
    s_waitcnt lgkmcnt(5)
    v_mfma_f32_16x16x32_bf16 v[120:123], v[136:139], v[132:135], v[120:123]
    v_mfma_f32_16x16x32_bf16 v[72:75], v[168:171], v[160:163], v[72:75]
    ds_read_b128 v[152:155], v9 offset:0
    v_mfma_f32_16x16x32_bf16 v[76:79], v[172:175], v[160:163], v[76:79]
    ds_read_b64_tr_b16 v[204:205], v12 offset:15360
    v_mfma_f32_16x16x32_bf16 v[80:83], v[176:179], v[160:163], v[80:83]
    ds_read_b64_tr_b16 v[206:207], v13 offset:15360
    v_mfma_f32_16x16x32_bf16 v[84:87], v[180:183], v[160:163], v[84:87]
    v_mfma_f32_16x16x32_bf16 v[88:91], v[184:187], v[160:163], v[88:91]
    s_waitcnt lgkmcnt(7)
    v_mfma_f32_16x16x32_bf16 v[92:95], v[168:171], v[164:167], v[92:95]
    ds_read_b128 v[156:159], v9 offset:2048
    v_mfma_f32_16x16x32_bf16 v[96:99], v[172:175], v[164:167], v[96:99]
    v_mfma_f32_16x16x32_bf16 v[100:103], v[176:179], v[164:167], v[100:103]
    v_mfma_f32_16x16x32_bf16 v[104:107], v[180:183], v[164:167], v[104:107]
    v_mfma_f32_16x16x32_bf16 v[108:111], v[184:187], v[164:167], v[108:111]
    s_waitcnt lgkmcnt(3)
    v_mfma_f32_16x16x32_bf16 v[32:35], v[188:191], v[152:155], v[32:35]
    ds_read_b128 v[160:163], v9 offset:4096
    ds_read_b128 v[164:167], v9 offset:6144
    s_add_u32 s44, s44, 1
    v_mfma_f32_16x16x32_bf16 v[36:39], v[192:195], v[152:155], v[36:39]
    s_cmp_eq_u32 s44, 10
    s_cselect_b32 s44, 0, s44
    ds_read_b128 v[136:139], v26 offset:64
    v_mfma_f32_16x16x32_bf16 v[40:43], v[196:199], v[152:155], v[40:43]
    ds_read_b128 v[124:127], v20
    v_xor_b32_e64 v20, 64, v20
    v_add_u32 v20, -90112, v20
    v_mfma_f32_16x16x32_bf16 v[44:47], v[200:203], v[152:155], v[44:47]
    ds_read_b128 v[128:131], v21
    v_xor_b32_e64 v21, 64, v21
    v_add_u32 v21, -90112, v21
    s_branch L_over_q_4
L_warm_q_4:
    s_branch L_warmed_q
L_over_q_4:
    s_waitcnt lgkmcnt(6)
    v_mfma_f32_16x16x32_bf16 v[48:51], v[204:207], v[152:155], v[48:51]
    ds_read_b128 v[132:135], v22
    v_xor_b32 v22, 64, v22
    v_add_u32 v22, -90112, v22
    s_waitcnt lgkmcnt(6)
    v_mfma_f32_16x16x32_bf16 v[52:55], v[188:191], v[156:159], v[52:55]
    v_mfma_f32_16x16x32_bf16 v[56:59], v[192:195], v[156:159], v[56:59]
    v_mfma_f32_16x16x32_bf16 v[60:63], v[196:199], v[156:159], v[60:63]
    v_mfma_f32_16x16x32_bf16 v[64:67], v[200:203], v[156:159], v[64:67]
    v_mfma_f32_16x16x32_bf16 v[68:71], v[204:207], v[156:159], v[68:71]
    s_waitcnt lgkmcnt(2)
    v_mfma_f32_16x16x32_bf16 v[112:115], v[136:139], v[124:127], v[112:115]
    s_waitcnt lgkmcnt(1)
    v_mfma_f32_16x16x32_bf16 v[116:119], v[136:139], v[128:131], v[116:119]
    s_waitcnt lgkmcnt(0)
    v_mfma_f32_16x16x32_bf16 v[120:123], v[136:139], v[132:135], v[120:123]
    v_mfma_f32_16x16x32_bf16 v[72:75], v[188:191], v[160:163], v[72:75]
    s_waitcnt lgkmcnt(0)
    s_barrier
    ds_read_b128 v[152:155], v4 offset:0
    v_mfma_f32_16x16x32_bf16 v[76:79], v[192:195], v[160:163], v[76:79]
    ds_read_b64_tr_b16 v[168:169], v10 offset:0
    ds_read_b64_tr_b16 v[170:171], v11 offset:0
    v_mfma_f32_16x16x32_bf16 v[80:83], v[196:199], v[160:163], v[80:83]
    ds_read_b64_tr_b16 v[172:173], v10 offset:40
    v_mfma_f32_16x16x32_bf16 v[84:87], v[200:203], v[160:163], v[84:87]
    ds_read_b64_tr_b16 v[174:175], v11 offset:40
    v_mfma_f32_16x16x32_bf16 v[88:91], v[204:207], v[160:163], v[88:91]
    ds_read_b64_tr_b16 v[176:177], v10 offset:80
    v_mfma_f32_16x16x32_bf16 v[92:95], v[188:191], v[164:167], v[92:95]
    ds_read_b64_tr_b16 v[178:179], v11 offset:80
    ds_read_b64_tr_b16 v[180:181], v10 offset:120
    v_mfma_f32_16x16x32_bf16 v[96:99], v[192:195], v[164:167], v[96:99]
    ds_read_b64_tr_b16 v[182:183], v11 offset:120
    v_mfma_f32_16x16x32_bf16 v[100:103], v[196:199], v[164:167], v[100:103]
    ds_read_b64_tr_b16 v[184:185], v12 offset:0
    v_mfma_f32_16x16x32_bf16 v[104:107], v[200:203], v[164:167], v[104:107]
    ds_read_b64_tr_b16 v[186:187], v13 offset:0
    v_mfma_f32_16x16x32_bf16 v[108:111], v[204:207], v[164:167], v[108:111]
    ds_read_b128 v[156:159], v4 offset:2048
    s_waitcnt lgkmcnt(9)
    v_mfma_f32_16x16x32_bf16 v[32:35], v[168:171], v[152:155], v[32:35]
    ds_read_b128 v[160:163], v4 offset:4096
    ds_read_b64_tr_b16 v[188:189], v10 offset:5120
    ds_read_b64_tr_b16 v[190:191], v11 offset:5120
    s_waitcnt lgkmcnt(10)
    v_mfma_f32_16x16x32_bf16 v[36:39], v[172:175], v[152:155], v[36:39]
    ds_read_b64_tr_b16 v[192:193], v10 offset:5160
    ds_read_b64_tr_b16 v[194:195], v11 offset:5160
    s_lshl_b32 s45, s44, 7
    s_waitcnt lgkmcnt(10)
    v_mfma_f32_16x16x32_bf16 v[40:43], v[176:179], v[152:155], v[40:43]
    v_add_u32_e64 v26, s45, v23
    ds_read_b128 v[136:139], v26 offset:0
    ds_read_b128 v[124:127], v20
    s_waitcnt lgkmcnt(10)
    v_mfma_f32_16x16x32_bf16 v[44:47], v[180:183], v[152:155], v[44:47]
    v_xor_b32 v20, 64, v20
    ds_read_b128 v[128:131], v21
    v_xor_b32 v21, 64, v21
    s_waitcnt lgkmcnt(9)
    v_mfma_f32_16x16x32_bf16 v[48:51], v[184:187], v[152:155], v[48:51]
    ds_read_b128 v[132:135], v22
    v_xor_b32 v22, 64, v22
    s_waitcnt lgkmcnt(9)
    v_mfma_f32_16x16x32_bf16 v[52:55], v[168:171], v[156:159], v[52:55]
    ds_read_b128 v[164:167], v4 offset:6144
    v_mfma_f32_16x16x32_bf16 v[56:59], v[172:175], v[156:159], v[56:59]
    ds_read_b64_tr_b16 v[196:197], v10 offset:5200
    v_mfma_f32_16x16x32_bf16 v[60:63], v[176:179], v[156:159], v[60:63]
    ds_read_b64_tr_b16 v[198:199], v11 offset:5200
    v_mfma_f32_16x16x32_bf16 v[64:67], v[180:183], v[156:159], v[64:67]
    ds_read_b64_tr_b16 v[200:201], v10 offset:5240
    v_mfma_f32_16x16x32_bf16 v[68:71], v[184:187], v[156:159], v[68:71]
    ds_read_b64_tr_b16 v[202:203], v11 offset:5240
    s_waitcnt lgkmcnt(7)
    v_mfma_f32_16x16x32_bf16 v[112:115], v[136:139], v[124:127], v[112:115]
    s_waitcnt lgkmcnt(6)
    v_mfma_f32_16x16x32_bf16 v[116:119], v[136:139], v[128:131], v[116:119]
    s_waitcnt lgkmcnt(5)
    v_mfma_f32_16x16x32_bf16 v[120:123], v[136:139], v[132:135], v[120:123]
    v_mfma_f32_16x16x32_bf16 v[72:75], v[168:171], v[160:163], v[72:75]
    ds_read_b128 v[152:155], v5 offset:0
    v_mfma_f32_16x16x32_bf16 v[76:79], v[172:175], v[160:163], v[76:79]
    ds_read_b64_tr_b16 v[204:205], v12 offset:5120
    v_mfma_f32_16x16x32_bf16 v[80:83], v[176:179], v[160:163], v[80:83]
    ds_read_b64_tr_b16 v[206:207], v13 offset:5120
    v_mfma_f32_16x16x32_bf16 v[84:87], v[180:183], v[160:163], v[84:87]
    v_mfma_f32_16x16x32_bf16 v[88:91], v[184:187], v[160:163], v[88:91]
    s_waitcnt lgkmcnt(7)
    v_mfma_f32_16x16x32_bf16 v[92:95], v[168:171], v[164:167], v[92:95]
    ds_read_b128 v[156:159], v5 offset:2048
    v_mfma_f32_16x16x32_bf16 v[96:99], v[172:175], v[164:167], v[96:99]
    v_mfma_f32_16x16x32_bf16 v[100:103], v[176:179], v[164:167], v[100:103]
    v_mfma_f32_16x16x32_bf16 v[104:107], v[180:183], v[164:167], v[104:107]
    v_mfma_f32_16x16x32_bf16 v[108:111], v[184:187], v[164:167], v[108:111]
    s_waitcnt lgkmcnt(3)
    v_mfma_f32_16x16x32_bf16 v[32:35], v[188:191], v[152:155], v[32:35]
    ds_read_b128 v[160:163], v5 offset:4096
    ds_read_b128 v[164:167], v5 offset:6144
    s_add_u32 s44, s44, 1
    v_mfma_f32_16x16x32_bf16 v[36:39], v[192:195], v[152:155], v[36:39]
    s_cmp_eq_u32 s44, 10
    s_cselect_b32 s44, 0, s44
    ds_read_b128 v[136:139], v26 offset:64
    v_mfma_f32_16x16x32_bf16 v[40:43], v[196:199], v[152:155], v[40:43]
    ds_read_b128 v[124:127], v20
    v_xor_b32_e64 v20, 64, v20
    v_add_u32 v20, 45056, v20
    v_mfma_f32_16x16x32_bf16 v[44:47], v[200:203], v[152:155], v[44:47]
    ds_read_b128 v[128:131], v21
    v_xor_b32_e64 v21, 64, v21
    v_add_u32 v21, 45056, v21
    s_waitcnt lgkmcnt(6)
    v_mfma_f32_16x16x32_bf16 v[48:51], v[204:207], v[152:155], v[48:51]
    ds_read_b128 v[132:135], v22
    v_xor_b32 v22, 64, v22
    v_add_u32 v22, 45056, v22
    s_waitcnt lgkmcnt(6)
    v_mfma_f32_16x16x32_bf16 v[52:55], v[188:191], v[156:159], v[52:55]
    v_mfma_f32_16x16x32_bf16 v[56:59], v[192:195], v[156:159], v[56:59]
    v_mfma_f32_16x16x32_bf16 v[60:63], v[196:199], v[156:159], v[60:63]
    v_mfma_f32_16x16x32_bf16 v[64:67], v[200:203], v[156:159], v[64:67]
    v_mfma_f32_16x16x32_bf16 v[68:71], v[204:207], v[156:159], v[68:71]
    s_waitcnt lgkmcnt(2)
    v_mfma_f32_16x16x32_bf16 v[112:115], v[136:139], v[124:127], v[112:115]
    s_waitcnt lgkmcnt(1)
    v_mfma_f32_16x16x32_bf16 v[116:119], v[136:139], v[128:131], v[116:119]
    s_waitcnt lgkmcnt(0)
    v_mfma_f32_16x16x32_bf16 v[120:123], v[136:139], v[132:135], v[120:123]
    v_mfma_f32_16x16x32_bf16 v[72:75], v[188:191], v[160:163], v[72:75]
    s_waitcnt lgkmcnt(0)
    s_barrier
    ds_read_b128 v[152:155], v6 offset:0
    v_mfma_f32_16x16x32_bf16 v[76:79], v[192:195], v[160:163], v[76:79]
    ds_read_b64_tr_b16 v[168:169], v10 offset:10240
    ds_read_b64_tr_b16 v[170:171], v11 offset:10240
    v_mfma_f32_16x16x32_bf16 v[80:83], v[196:199], v[160:163], v[80:83]
    ds_read_b64_tr_b16 v[172:173], v10 offset:10280
    v_mfma_f32_16x16x32_bf16 v[84:87], v[200:203], v[160:163], v[84:87]
    ds_read_b64_tr_b16 v[174:175], v11 offset:10280
    v_mfma_f32_16x16x32_bf16 v[88:91], v[204:207], v[160:163], v[88:91]
    ds_read_b64_tr_b16 v[176:177], v10 offset:10320
    v_mfma_f32_16x16x32_bf16 v[92:95], v[188:191], v[164:167], v[92:95]
    ds_read_b64_tr_b16 v[178:179], v11 offset:10320
    ds_read_b64_tr_b16 v[180:181], v10 offset:10360
    v_mfma_f32_16x16x32_bf16 v[96:99], v[192:195], v[164:167], v[96:99]
    ds_read_b64_tr_b16 v[182:183], v11 offset:10360
    v_mfma_f32_16x16x32_bf16 v[100:103], v[196:199], v[164:167], v[100:103]
    ds_read_b64_tr_b16 v[184:185], v12 offset:10240
    v_mfma_f32_16x16x32_bf16 v[104:107], v[200:203], v[164:167], v[104:107]
    ds_read_b64_tr_b16 v[186:187], v13 offset:10240
    v_mfma_f32_16x16x32_bf16 v[108:111], v[204:207], v[164:167], v[108:111]
    ds_read_b128 v[156:159], v6 offset:2048
    s_waitcnt lgkmcnt(9)
    v_mfma_f32_16x16x32_bf16 v[32:35], v[168:171], v[152:155], v[32:35]
    ds_read_b128 v[160:163], v6 offset:4096
    ds_read_b64_tr_b16 v[188:189], v10 offset:15360
    ds_read_b64_tr_b16 v[190:191], v11 offset:15360
    s_waitcnt lgkmcnt(10)
    v_mfma_f32_16x16x32_bf16 v[36:39], v[172:175], v[152:155], v[36:39]
    ds_read_b64_tr_b16 v[192:193], v10 offset:15400
    ds_read_b64_tr_b16 v[194:195], v11 offset:15400
    s_lshl_b32 s45, s44, 7
    s_waitcnt lgkmcnt(10)
    v_mfma_f32_16x16x32_bf16 v[40:43], v[176:179], v[152:155], v[40:43]
    v_add_u32_e64 v26, s45, v23
    ds_read_b128 v[136:139], v26 offset:0
    ds_read_b128 v[124:127], v20
    s_waitcnt lgkmcnt(10)
    v_mfma_f32_16x16x32_bf16 v[44:47], v[180:183], v[152:155], v[44:47]
    v_xor_b32 v20, 64, v20
    ds_read_b128 v[128:131], v21
    v_xor_b32 v21, 64, v21
    s_waitcnt lgkmcnt(9)
    v_mfma_f32_16x16x32_bf16 v[48:51], v[184:187], v[152:155], v[48:51]
    ds_read_b128 v[132:135], v22
    v_xor_b32 v22, 64, v22
    s_waitcnt lgkmcnt(9)
    v_mfma_f32_16x16x32_bf16 v[52:55], v[168:171], v[156:159], v[52:55]
    ds_read_b128 v[164:167], v6 offset:6144
    v_mfma_f32_16x16x32_bf16 v[56:59], v[172:175], v[156:159], v[56:59]
    ds_read_b64_tr_b16 v[196:197], v10 offset:15440
    v_mfma_f32_16x16x32_bf16 v[60:63], v[176:179], v[156:159], v[60:63]
    ds_read_b64_tr_b16 v[198:199], v11 offset:15440
    v_mfma_f32_16x16x32_bf16 v[64:67], v[180:183], v[156:159], v[64:67]
    ds_read_b64_tr_b16 v[200:201], v10 offset:15480
    v_mfma_f32_16x16x32_bf16 v[68:71], v[184:187], v[156:159], v[68:71]
    ds_read_b64_tr_b16 v[202:203], v11 offset:15480
    s_waitcnt lgkmcnt(7)
    v_mfma_f32_16x16x32_bf16 v[112:115], v[136:139], v[124:127], v[112:115]
    s_waitcnt lgkmcnt(6)
    v_mfma_f32_16x16x32_bf16 v[116:119], v[136:139], v[128:131], v[116:119]
    s_waitcnt lgkmcnt(5)
    v_mfma_f32_16x16x32_bf16 v[120:123], v[136:139], v[132:135], v[120:123]
    v_mfma_f32_16x16x32_bf16 v[72:75], v[168:171], v[160:163], v[72:75]
    ds_read_b128 v[152:155], v7 offset:0
    v_mfma_f32_16x16x32_bf16 v[76:79], v[172:175], v[160:163], v[76:79]
    ds_read_b64_tr_b16 v[204:205], v12 offset:15360
    v_mfma_f32_16x16x32_bf16 v[80:83], v[176:179], v[160:163], v[80:83]
    ds_read_b64_tr_b16 v[206:207], v13 offset:15360
    v_mfma_f32_16x16x32_bf16 v[84:87], v[180:183], v[160:163], v[84:87]
    v_mfma_f32_16x16x32_bf16 v[88:91], v[184:187], v[160:163], v[88:91]
    s_waitcnt lgkmcnt(7)
    v_mfma_f32_16x16x32_bf16 v[92:95], v[168:171], v[164:167], v[92:95]
    ds_read_b128 v[156:159], v7 offset:2048
    v_mfma_f32_16x16x32_bf16 v[96:99], v[172:175], v[164:167], v[96:99]
    v_mfma_f32_16x16x32_bf16 v[100:103], v[176:179], v[164:167], v[100:103]
    v_mfma_f32_16x16x32_bf16 v[104:107], v[180:183], v[164:167], v[104:107]
    v_mfma_f32_16x16x32_bf16 v[108:111], v[184:187], v[164:167], v[108:111]
    s_waitcnt lgkmcnt(3)
    v_mfma_f32_16x16x32_bf16 v[32:35], v[188:191], v[152:155], v[32:35]
    ds_read_b128 v[160:163], v7 offset:4096
    ds_read_b128 v[164:167], v7 offset:6144
    s_add_u32 s44, s44, 1
    v_mfma_f32_16x16x32_bf16 v[36:39], v[192:195], v[152:155], v[36:39]
    s_cmp_eq_u32 s44, 10
    s_cselect_b32 s44, 0, s44
    ds_read_b128 v[136:139], v26 offset:64
    v_mfma_f32_16x16x32_bf16 v[40:43], v[196:199], v[152:155], v[40:43]
    ds_read_b128 v[124:127], v20
    v_xor_b32_e64 v20, 64, v20
    v_add_u32 v20, 45056, v20
    v_mfma_f32_16x16x32_bf16 v[44:47], v[200:203], v[152:155], v[44:47]
    ds_read_b128 v[128:131], v21
    v_xor_b32_e64 v21, 64, v21
    v_add_u32 v21, 45056, v21
    s_waitcnt lgkmcnt(6)
    v_mfma_f32_16x16x32_bf16 v[48:51], v[204:207], v[152:155], v[48:51]
    ds_read_b128 v[132:135], v22
    v_xor_b32 v22, 64, v22
    v_add_u32 v22, 45056, v22
    s_waitcnt lgkmcnt(6)
    v_mfma_f32_16x16x32_bf16 v[52:55], v[188:191], v[156:159], v[52:55]
    v_mfma_f32_16x16x32_bf16 v[56:59], v[192:195], v[156:159], v[56:59]
    v_mfma_f32_16x16x32_bf16 v[60:63], v[196:199], v[156:159], v[60:63]
    v_mfma_f32_16x16x32_bf16 v[64:67], v[200:203], v[156:159], v[64:67]
    v_mfma_f32_16x16x32_bf16 v[68:71], v[204:207], v[156:159], v[68:71]
    s_waitcnt lgkmcnt(2)
    v_mfma_f32_16x16x32_bf16 v[112:115], v[136:139], v[124:127], v[112:115]
    s_waitcnt lgkmcnt(1)
    v_mfma_f32_16x16x32_bf16 v[116:119], v[136:139], v[128:131], v[116:119]
    s_waitcnt lgkmcnt(0)
    v_mfma_f32_16x16x32_bf16 v[120:123], v[136:139], v[132:135], v[120:123]
    v_mfma_f32_16x16x32_bf16 v[72:75], v[188:191], v[160:163], v[72:75]
    s_waitcnt lgkmcnt(0)
    s_barrier
    ds_read_b128 v[152:155], v8 offset:0
    v_mfma_f32_16x16x32_bf16 v[76:79], v[192:195], v[160:163], v[76:79]
    ds_read_b64_tr_b16 v[168:169], v10 offset:0
    ds_read_b64_tr_b16 v[170:171], v11 offset:0
    v_mfma_f32_16x16x32_bf16 v[80:83], v[196:199], v[160:163], v[80:83]
    ds_read_b64_tr_b16 v[172:173], v10 offset:40
    v_mfma_f32_16x16x32_bf16 v[84:87], v[200:203], v[160:163], v[84:87]
    ds_read_b64_tr_b16 v[174:175], v11 offset:40
    v_mfma_f32_16x16x32_bf16 v[88:91], v[204:207], v[160:163], v[88:91]
    ds_read_b64_tr_b16 v[176:177], v10 offset:80
    v_mfma_f32_16x16x32_bf16 v[92:95], v[188:191], v[164:167], v[92:95]
    ds_read_b64_tr_b16 v[178:179], v11 offset:80
    ds_read_b64_tr_b16 v[180:181], v10 offset:120
    v_mfma_f32_16x16x32_bf16 v[96:99], v[192:195], v[164:167], v[96:99]
    ds_read_b64_tr_b16 v[182:183], v11 offset:120
    v_mfma_f32_16x16x32_bf16 v[100:103], v[196:199], v[164:167], v[100:103]
    ds_read_b64_tr_b16 v[184:185], v12 offset:0
    v_mfma_f32_16x16x32_bf16 v[104:107], v[200:203], v[164:167], v[104:107]
    ds_read_b64_tr_b16 v[186:187], v13 offset:0
    v_mfma_f32_16x16x32_bf16 v[108:111], v[204:207], v[164:167], v[108:111]
    ds_read_b128 v[156:159], v8 offset:2048
    s_waitcnt lgkmcnt(9)
    v_mfma_f32_16x16x32_bf16 v[32:35], v[168:171], v[152:155], v[32:35]
    ds_read_b128 v[160:163], v8 offset:4096
    ds_read_b64_tr_b16 v[188:189], v10 offset:5120
    ds_read_b64_tr_b16 v[190:191], v11 offset:5120
    s_waitcnt lgkmcnt(10)
    v_mfma_f32_16x16x32_bf16 v[36:39], v[172:175], v[152:155], v[36:39]
    ds_read_b64_tr_b16 v[192:193], v10 offset:5160
    ds_read_b64_tr_b16 v[194:195], v11 offset:5160
    s_lshl_b32 s45, s44, 7
    s_waitcnt lgkmcnt(10)
    v_mfma_f32_16x16x32_bf16 v[40:43], v[176:179], v[152:155], v[40:43]
    v_add_u32_e64 v26, s45, v23
    ds_read_b128 v[136:139], v26 offset:0
    ds_read_b128 v[124:127], v20
    s_waitcnt lgkmcnt(10)
    v_mfma_f32_16x16x32_bf16 v[44:47], v[180:183], v[152:155], v[44:47]
    v_xor_b32 v20, 64, v20
    ds_read_b128 v[128:131], v21
    v_xor_b32 v21, 64, v21
    s_waitcnt lgkmcnt(9)
    v_mfma_f32_16x16x32_bf16 v[48:51], v[184:187], v[152:155], v[48:51]
    ds_read_b128 v[132:135], v22
    v_xor_b32 v22, 64, v22
    s_waitcnt lgkmcnt(9)
    v_mfma_f32_16x16x32_bf16 v[52:55], v[168:171], v[156:159], v[52:55]
    ds_read_b128 v[164:167], v8 offset:6144
    v_mfma_f32_16x16x32_bf16 v[56:59], v[172:175], v[156:159], v[56:59]
    ds_read_b64_tr_b16 v[196:197], v10 offset:5200
    v_mfma_f32_16x16x32_bf16 v[60:63], v[176:179], v[156:159], v[60:63]
    ds_read_b64_tr_b16 v[198:199], v11 offset:5200
    v_mfma_f32_16x16x32_bf16 v[64:67], v[180:183], v[156:159], v[64:67]
    ds_read_b64_tr_b16 v[200:201], v10 offset:5240
    v_mfma_f32_16x16x32_bf16 v[68:71], v[184:187], v[156:159], v[68:71]
    ds_read_b64_tr_b16 v[202:203], v11 offset:5240
    s_waitcnt lgkmcnt(7)
    v_mfma_f32_16x16x32_bf16 v[112:115], v[136:139], v[124:127], v[112:115]
    s_waitcnt lgkmcnt(6)
    v_mfma_f32_16x16x32_bf16 v[116:119], v[136:139], v[128:131], v[116:119]
    s_waitcnt lgkmcnt(5)
    v_mfma_f32_16x16x32_bf16 v[120:123], v[136:139], v[132:135], v[120:123]
    v_mfma_f32_16x16x32_bf16 v[72:75], v[168:171], v[160:163], v[72:75]
    ds_read_b128 v[152:155], v9 offset:0
    v_mfma_f32_16x16x32_bf16 v[76:79], v[172:175], v[160:163], v[76:79]
    ds_read_b64_tr_b16 v[204:205], v12 offset:5120
    v_mfma_f32_16x16x32_bf16 v[80:83], v[176:179], v[160:163], v[80:83]
    ds_read_b64_tr_b16 v[206:207], v13 offset:5120
    v_mfma_f32_16x16x32_bf16 v[84:87], v[180:183], v[160:163], v[84:87]
    v_mfma_f32_16x16x32_bf16 v[88:91], v[184:187], v[160:163], v[88:91]
    s_waitcnt lgkmcnt(7)
    v_mfma_f32_16x16x32_bf16 v[92:95], v[168:171], v[164:167], v[92:95]
    ds_read_b128 v[156:159], v9 offset:2048
    v_mfma_f32_16x16x32_bf16 v[96:99], v[172:175], v[164:167], v[96:99]
    ds_read_b32 v14, v14
    v_mfma_f32_16x16x32_bf16 v[100:103], v[176:179], v[164:167], v[100:103]
    v_mfma_f32_16x16x32_bf16 v[104:107], v[180:183], v[164:167], v[104:107]
    v_mfma_f32_16x16x32_bf16 v[108:111], v[184:187], v[164:167], v[108:111]
    s_waitcnt lgkmcnt(4)
    v_mfma_f32_16x16x32_bf16 v[32:35], v[188:191], v[152:155], v[32:35]
    ds_read_b128 v[160:163], v9 offset:4096
    ds_read_b128 v[164:167], v9 offset:6144
    s_add_u32 s44, s44, 1
    v_mfma_f32_16x16x32_bf16 v[36:39], v[192:195], v[152:155], v[36:39]
    s_cmp_eq_u32 s44, 10
    s_cselect_b32 s44, 0, s44
    ds_read_b128 v[136:139], v26 offset:64
    v_mfma_f32_16x16x32_bf16 v[40:43], v[196:199], v[152:155], v[40:43]
    ds_read_b128 v[124:127], v20
    v_xor_b32_e64 v20, 64, v20
    v_add_u32 v20, -90112, v20
    v_mfma_f32_16x16x32_bf16 v[44:47], v[200:203], v[152:155], v[44:47]
    ds_read_b128 v[128:131], v21
    v_xor_b32_e64 v21, 64, v21
    v_add_u32 v21, -90112, v21
    s_waitcnt lgkmcnt(7)
    v_mfma_f32_16x16x32_bf16 v[48:51], v[204:207], v[152:155], v[48:51]
    ds_read_b128 v[132:135], v22
    v_xor_b32 v22, 64, v22
    v_add_u32 v22, -90112, v22
    s_waitcnt lgkmcnt(7)
    v_mfma_f32_16x16x32_bf16 v[52:55], v[188:191], v[156:159], v[52:55]
    s_waitcnt lgkmcnt(6)
    v_readfirstlane_b32 s68, v14
    v_mfma_f32_16x16x32_bf16 v[56:59], v[192:195], v[156:159], v[56:59]
    v_mfma_f32_16x16x32_bf16 v[60:63], v[196:199], v[156:159], v[60:63]
    v_mfma_f32_16x16x32_bf16 v[64:67], v[200:203], v[156:159], v[64:67]
    v_mfma_f32_16x16x32_bf16 v[68:71], v[204:207], v[156:159], v[68:71]
    s_waitcnt lgkmcnt(2)
    v_mfma_f32_16x16x32_bf16 v[112:115], v[136:139], v[124:127], v[112:115]
    s_waitcnt lgkmcnt(1)
    v_mfma_f32_16x16x32_bf16 v[116:119], v[136:139], v[128:131], v[116:119]
    s_waitcnt lgkmcnt(0)
    v_mfma_f32_16x16x32_bf16 v[120:123], v[136:139], v[132:135], v[120:123]
    v_mfma_f32_16x16x32_bf16 v[72:75], v[188:191], v[160:163], v[72:75]
    s_waitcnt lgkmcnt(0)
    s_barrier
    ds_read_b128 v[152:155], v4 offset:0
    v_mfma_f32_16x16x32_bf16 v[76:79], v[192:195], v[160:163], v[76:79]
    ds_read_b64_tr_b16 v[168:169], v10 offset:10240
    ds_read_b64_tr_b16 v[170:171], v11 offset:10240
    v_mfma_f32_16x16x32_bf16 v[80:83], v[196:199], v[160:163], v[80:83]
    ds_read_b64_tr_b16 v[172:173], v10 offset:10280
    v_mfma_f32_16x16x32_bf16 v[84:87], v[200:203], v[160:163], v[84:87]
    ds_read_b64_tr_b16 v[174:175], v11 offset:10280
    v_mfma_f32_16x16x32_bf16 v[88:91], v[204:207], v[160:163], v[88:91]
    ds_read_b64_tr_b16 v[176:177], v10 offset:10320
    v_mfma_f32_16x16x32_bf16 v[92:95], v[188:191], v[164:167], v[92:95]
    ds_read_b64_tr_b16 v[178:179], v11 offset:10320
    ds_read_b64_tr_b16 v[180:181], v10 offset:10360
    v_mfma_f32_16x16x32_bf16 v[96:99], v[192:195], v[164:167], v[96:99]
    ds_read_b64_tr_b16 v[182:183], v11 offset:10360
    v_mfma_f32_16x16x32_bf16 v[100:103], v[196:199], v[164:167], v[100:103]
    ds_read_b64_tr_b16 v[184:185], v12 offset:10240
    v_mfma_f32_16x16x32_bf16 v[104:107], v[200:203], v[164:167], v[104:107]
    ds_read_b64_tr_b16 v[186:187], v13 offset:10240
    v_mfma_f32_16x16x32_bf16 v[108:111], v[204:207], v[164:167], v[108:111]
    ds_read_b128 v[156:159], v4 offset:2048
    s_cmp_eq_u32 s68, 0
    s_cbranch_scc1 L_qglob_14
    s_lshl_b32 s45, s44, 7
    v_add_u32_e64 v26, s45, v23
    s_waitcnt lgkmcnt(9)
    v_mfma_f32_16x16x32_bf16 v[32:35], v[168:171], v[152:155], v[32:35]
    ds_read_b128 v[160:163], v5 offset:0
    ds_read_b64_tr_b16 v[188:189], v10 offset:15360
    s_waitcnt lgkmcnt(9)
    v_mfma_f32_16x16x32_bf16 v[36:39], v[172:175], v[152:155], v[36:39]
    ds_read_b64_tr_b16 v[190:191], v11 offset:15360
    ds_read_b128 v[164:167], v5 offset:2048
    s_waitcnt lgkmcnt(9)
    v_mfma_f32_16x16x32_bf16 v[40:43], v[176:179], v[152:155], v[40:43]
    ds_read_b64_tr_b16 v[192:193], v10 offset:15400
    s_waitcnt lgkmcnt(8)
    v_mfma_f32_16x16x32_bf16 v[44:47], v[180:183], v[152:155], v[44:47]
    ds_read_b64_tr_b16 v[194:195], v11 offset:15400
    s_waitcnt lgkmcnt(7)
    v_mfma_f32_16x16x32_bf16 v[48:51], v[184:187], v[152:155], v[48:51]
    ds_read_b64_tr_b16 v[196:197], v10 offset:15440
    s_waitcnt lgkmcnt(7)
    v_mfma_f32_16x16x32_bf16 v[52:55], v[168:171], v[156:159], v[52:55]
    ds_read_b64_tr_b16 v[198:199], v11 offset:15440
    v_mfma_f32_16x16x32_bf16 v[56:59], v[172:175], v[156:159], v[56:59]
    ds_read_b64_tr_b16 v[200:201], v10 offset:15480
    v_mfma_f32_16x16x32_bf16 v[60:63], v[176:179], v[156:159], v[60:63]
    ds_read_b64_tr_b16 v[202:203], v11 offset:15480
    v_mfma_f32_16x16x32_bf16 v[64:67], v[180:183], v[156:159], v[64:67]
    ds_read_b64_tr_b16 v[204:205], v12 offset:15360
    v_mfma_f32_16x16x32_bf16 v[68:71], v[184:187], v[156:159], v[68:71]
    ds_read_b64_tr_b16 v[206:207], v13 offset:15360
    s_waitcnt lgkmcnt(9)
    v_mfma_f32_16x16x32_bf16 v[32:35], v[188:191], v[160:163], v[32:35]
    ds_read_b128 v[224:227], v4 offset:4096
    s_waitcnt lgkmcnt(9)
    v_mfma_f32_16x16x32_bf16 v[52:55], v[188:191], v[164:167], v[52:55]
    ds_read_b128 v[232:235], v5 offset:4096
    s_waitcnt lgkmcnt(8)
    v_mfma_f32_16x16x32_bf16 v[36:39], v[192:195], v[160:163], v[36:39]
    ds_read_b128 v[236:239], v5 offset:6144
    v_mfma_f32_16x16x32_bf16 v[56:59], v[192:195], v[164:167], v[56:59]
    ds_read_b128 v[228:231], v4 offset:6144
    s_waitcnt lgkmcnt(8)
    v_mfma_f32_16x16x32_bf16 v[40:43], v[196:199], v[160:163], v[40:43]
    s_nop 0
    ds_read_b128 v[136:139], v26 offset:0
    v_mfma_f32_16x16x32_bf16 v[60:63], v[196:199], v[164:167], v[60:63]
    ds_read_b128 v[124:127], v20
    v_cvt_pk_bf16_f32 v208, v32, v33
    v_cvt_pk_bf16_f32 v209, v34, v35
    s_waitcnt lgkmcnt(8)
    v_mfma_f32_16x16x32_bf16 v[44:47], v[200:203], v[160:163], v[44:47]
    v_xor_b32 v20, 64, v20
    v_cvt_pk_bf16_f32 v210, v52, v53
    v_cvt_pk_bf16_f32 v211, v54, v55
    v_mfma_f32_16x16x32_bf16 v[64:67], v[200:203], v[164:167], v[64:67]
    ds_read_b128 v[128:131], v21
    global_store_dwordx4 v18, v[208:211], s[20:21] offset:-2048 nt
    s_waitcnt lgkmcnt(7)
    v_mfma_f32_16x16x32_bf16 v[48:51], v[204:207], v[160:163], v[48:51]
    v_xor_b32 v21, 64, v21
    v_cvt_pk_bf16_f32 v212, v36, v37
    v_cvt_pk_bf16_f32 v213, v38, v39
    v_mfma_f32_16x16x32_bf16 v[68:71], v[204:207], v[164:167], v[68:71]
    ds_read_b128 v[132:135], v22
    v_cvt_pk_bf16_f32 v214, v56, v57
    v_cvt_pk_bf16_f32 v215, v58, v59
    s_waitcnt lgkmcnt(7)
    v_mfma_f32_16x16x32_bf16 v[72:75], v[168:171], v[224:227], v[72:75]
    v_xor_b32 v22, 64, v22
    global_store_dwordx4 v18, v[212:215], s[20:21] offset:-1024 nt
    s_waitcnt lgkmcnt(6)
    v_mfma_f32_16x16x32_bf16 v[72:75], v[188:191], v[232:235], v[72:75]
    v_cvt_pk_bf16_f32 v216, v40, v41
    v_cvt_pk_bf16_f32 v217, v42, v43
    s_waitcnt lgkmcnt(5)
    v_mfma_f32_16x16x32_bf16 v[92:95], v[188:191], v[236:239], v[92:95]
    v_cvt_pk_bf16_f32 v218, v60, v61
    v_cvt_pk_bf16_f32 v219, v62, v63
    s_waitcnt lgkmcnt(4)
    v_mfma_f32_16x16x32_bf16 v[92:95], v[168:171], v[228:231], v[92:95]
    s_waitcnt lgkmcnt(2)
    v_mfma_f32_16x16x32_bf16 v[112:115], v[136:139], v[124:127], v[112:115]
    s_waitcnt lgkmcnt(1)
    v_mfma_f32_16x16x32_bf16 v[116:119], v[136:139], v[128:131], v[116:119]
    s_waitcnt lgkmcnt(0)
    v_mfma_f32_16x16x32_bf16 v[120:123], v[136:139], v[132:135], v[120:123]
    global_store_dwordx4 v18, v[216:219], s[20:21] offset:0 nt
    v_mfma_f32_16x16x32_bf16 v[76:79], v[172:175], v[224:227], v[76:79]
    ds_read_b128 v[136:139], v26 offset:64
    v_cvt_pk_bf16_f32 v220, v44, v45
    v_cvt_pk_bf16_f32 v221, v46, v47
    v_mfma_f32_16x16x32_bf16 v[76:79], v[192:195], v[232:235], v[76:79]
    ds_read_b128 v[124:127], v20
    v_cvt_pk_bf16_f32 v222, v64, v65
    v_cvt_pk_bf16_f32 v223, v66, v67
    v_mfma_f32_16x16x32_bf16 v[96:99], v[192:195], v[236:239], v[96:99]
    v_xor_b32_e64 v20, 64, v20
    global_store_dwordx4 v18, v[220:223], s[20:21] offset:1024 nt
    v_mfma_f32_16x16x32_bf16 v[96:99], v[172:175], v[228:231], v[96:99]
    ds_read_b128 v[128:131], v21
    v_cvt_pk_bf16_f32 v208, v48, v49
    v_cvt_pk_bf16_f32 v209, v50, v51
    v_mfma_f32_16x16x32_bf16 v[80:83], v[176:179], v[224:227], v[80:83]
    v_xor_b32_e64 v21, 64, v21
    v_cvt_pk_bf16_f32 v210, v68, v69
    v_cvt_pk_bf16_f32 v211, v70, v71
    v_mfma_f32_16x16x32_bf16 v[80:83], v[196:199], v[232:235], v[80:83]
    ds_read_b128 v[132:135], v22
    global_store_dwordx4 v18, v[208:211], s[20:21] offset:2048 nt
    v_mfma_f32_16x16x32_bf16 v[100:103], v[196:199], v[236:239], v[100:103]
    v_xor_b32_e64 v22, 64, v22
    v_add_u32 v18, 5120, v18
    v_cvt_pk_bf16_f32 v212, v72, v73
    v_mfma_f32_16x16x32_bf16 v[100:103], v[176:179], v[228:231], v[100:103]
    v_cvt_pk_bf16_f32 v213, v74, v75
    v_cvt_pk_bf16_f32 v214, v92, v93
    v_mfma_f32_16x16x32_bf16 v[84:87], v[180:183], v[224:227], v[84:87]
    v_cvt_pk_bf16_f32 v215, v94, v95
    global_store_dwordx4 v18, v[212:215], s[20:21] offset:-2048 nt
    v_mfma_f32_16x16x32_bf16 v[84:87], v[200:203], v[232:235], v[84:87]
    s_waitcnt lgkmcnt(2)
    v_mfma_f32_16x16x32_bf16 v[112:115], v[136:139], v[124:127], v[112:115]
    s_waitcnt lgkmcnt(1)
    v_mfma_f32_16x16x32_bf16 v[116:119], v[136:139], v[128:131], v[116:119]
    s_waitcnt lgkmcnt(0)
    s_nop 0
    v_mfma_f32_16x16x32_bf16 v[120:123], v[136:139], v[132:135], v[120:123]
    v_cvt_pk_bf16_f32 v216, v76, v77
    v_cvt_pk_bf16_f32 v217, v78, v79
    v_mfma_f32_16x16x32_bf16 v[104:107], v[200:203], v[236:239], v[104:107]
    v_cvt_pk_bf16_f32 v218, v96, v97
    v_cvt_pk_bf16_f32 v219, v98, v99
    v_mfma_f32_16x16x32_bf16 v[104:107], v[180:183], v[228:231], v[104:107]
    global_store_dwordx4 v18, v[216:219], s[20:21] offset:-1024 nt
    v_mfma_f32_16x16x32_bf16 v[88:91], v[184:187], v[224:227], v[88:91]
    v_cvt_pk_bf16_f32 v220, v80, v81
    v_cvt_pk_bf16_f32 v221, v82, v83
    v_mfma_f32_16x16x32_bf16 v[88:91], v[204:207], v[232:235], v[88:91]
    v_cvt_pk_bf16_f32 v222, v100, v101
    v_cvt_pk_bf16_f32 v223, v102, v103
    v_mfma_f32_16x16x32_bf16 v[108:111], v[204:207], v[236:239], v[108:111]
    global_store_dwordx4 v18, v[220:223], s[20:21] offset:0 nt
    v_mfma_f32_16x16x32_bf16 v[108:111], v[184:187], v[228:231], v[108:111]
    v_cvt_pk_bf16_f32 v208, v84, v85
    v_cvt_pk_bf16_f32 v209, v86, v87
    v_cvt_pk_bf16_f32 v210, v104, v105
    v_cvt_pk_bf16_f32 v211, v106, v107
    global_store_dwordx4 v18, v[208:211], s[20:21] offset:1024 nt
    v_cvt_pk_bf16_f32 v212, v88, v89
    v_cvt_pk_bf16_f32 v213, v90, v91
    s_nop 0
    v_cvt_pk_bf16_f32 v214, v108, v109
    v_cvt_pk_bf16_f32 v215, v110, v111
    global_store_dwordx4 v18, v[212:215], s[20:21] offset:2048 nt
    s_mov_b64 exec, 1
    s_waitcnt vmcnt(0)
    global_store_dword v15, v19, s[20:21] nt
    s_mov_b64 exec, -1
L_qjoin_15:
    v_cmp_eq_u32 vcc, 1, v3
    s_nop 1
    v_cndmask_b32 v112, v112, v116, vcc
    v_cmp_eq_u32 vcc, 2, v3
    s_nop 1
    v_cndmask_b32 v112, v112, v120, vcc
    v_mul_f32 v112, 0xbfb8aa3b, v112
    v_exp_f32 v112, v112
    s_nop 0
    v_add_f32 v112, 1.0, v112
    s_mov_b64 exec, s[46:47]
    global_store_dword v25, v112, s[20:21] sc1
    s_mov_b64 exec, -1
    s_barrier
    s_branch L_fcompute
L_tail:
    s_barrier
    s_mul_i32 s46, s70, 160
    s_movk_i32 s45, 1120
    v_lshl_add_u32 v4, v1, 4, s46
    v_mul_u32_u24 v5, 6554, v1
    v_lshrrev_b32 v6, 16, v5
    v_mad_u32_u24 v12, v6, s45, v4
    v_add_u32 v5, 419456, v5
    v_add_u32 v4, 1024, v4
    v_lshrrev_b32_e64 v6, 16, v5
    v_mad_u32_u24 v13, v6, s45, v4
    v_add_u32 v5, 419456, v5
    v_add_u32 v4, 1024, v4
    v_lshrrev_b32_e64 v6, 16, v5
    v_mad_u32_u24 v14, v6, s45, v4
    v_add_u32 v5, 419456, v5
    v_add_u32 v4, 1024, v4
    v_lshrrev_b32_e64 v6, 16, v5
    v_mad_u32_u24 v15, v6, s45, v4
    v_add_u32 v5, 419456, v5
    v_add_u32 v4, 1024, v4
    v_lshrrev_b32_e64 v6, 16, v5
    v_mad_u32_u24 v16, v6, s45, v4
    s_mov_b32 s28, s60
    s_nop 0
    s_and_b32 s29, s61, 0xffff
    s_mov_b32 s30, 819200
    s_mov_b32 s31, 0x20000
    s_mul_i32 s44, s26, 5120
    s_mul_i32 s45, s26, 40960
    s_add_u32 s45, s45, 0
    s_add_u32 m0, s44, 0
    s_nop 0
    buffer_load_dwordx4 v12, s[28:31], s45 offen lds
    s_add_u32 m0, s44, 1024
    s_nop 0
    buffer_load_dwordx4 v13, s[28:31], s45 offen lds
    s_add_u32 m0, s44, 2048
    s_nop 0
    buffer_load_dwordx4 v14, s[28:31], s45 offen lds
    s_add_u32 m0, s44, 3072
    s_nop 0
    buffer_load_dwordx4 v15, s[28:31], s45 offen lds
    s_add_u32 m0, s44, 4096
    s_nop 0
    buffer_load_dwordx4 v16, s[28:31], s45 offen lds
    s_mul_i32 s45, s26, 40960
    s_add_u32 s45, s45, 163840
    s_add_u32 m0, s44, 20480
    s_nop 0
    buffer_load_dwordx4 v12, s[28:31], s45 offen lds
    s_add_u32 m0, s44, 21504
    s_nop 0
    buffer_load_dwordx4 v13, s[28:31], s45 offen lds
    s_add_u32 m0, s44, 22528
    s_nop 0
    buffer_load_dwordx4 v14, s[28:31], s45 offen lds
    s_add_u32 m0, s44, 23552
    s_nop 0
    buffer_load_dwordx4 v15, s[28:31], s45 offen lds
    s_add_u32 m0, s44, 24576
    s_nop 0
    buffer_load_dwordx4 v16, s[28:31], s45 offen lds
    s_mul_i32 s45, s26, 40960
    s_add_u32 s45, s45, 327680
    s_add_u32 m0, s44, 40960
    s_nop 0
    buffer_load_dwordx4 v12, s[28:31], s45 offen lds
    s_add_u32 m0, s44, 41984
    s_nop 0
    buffer_load_dwordx4 v13, s[28:31], s45 offen lds
    s_add_u32 m0, s44, 43008
    s_nop 0
    buffer_load_dwordx4 v14, s[28:31], s45 offen lds
    s_add_u32 m0, s44, 44032
    s_nop 0
    buffer_load_dwordx4 v15, s[28:31], s45 offen lds
    s_add_u32 m0, s44, 45056
    s_nop 0
    buffer_load_dwordx4 v16, s[28:31], s45 offen lds
    s_mul_i32 s45, s26, 40960
    s_add_u32 s45, s45, 491520
    s_add_u32 m0, s44, 61440
    s_nop 0
    buffer_load_dwordx4 v12, s[28:31], s45 offen lds
    s_add_u32 m0, s44, 62464
    s_nop 0
    buffer_load_dwordx4 v13, s[28:31], s45 offen lds
    s_add_u32 m0, s44, 63488
    s_nop 0
    buffer_load_dwordx4 v14, s[28:31], s45 offen lds
    s_add_u32 m0, s44, 64512
    s_nop 0
    buffer_load_dwordx4 v15, s[28:31], s45 offen lds
    s_add_u32 m0, s44, 65536
    s_nop 0
    buffer_load_dwordx4 v16, s[28:31], s45 offen lds
    s_mul_i32 s45, s26, 40960
    s_add_u32 s45, s45, 655360
    s_add_u32 m0, s44, 81920
    s_nop 0
    buffer_load_dwordx4 v12, s[28:31], s45 offen lds
    s_add_u32 m0, s44, 82944
    s_nop 0
    buffer_load_dwordx4 v13, s[28:31], s45 offen lds
    s_add_u32 m0, s44, 83968
    s_nop 0
    buffer_load_dwordx4 v14, s[28:31], s45 offen lds
    s_add_u32 m0, s44, 84992
    s_nop 0
    buffer_load_dwordx4 v15, s[28:31], s45 offen lds
    s_add_u32 m0, s44, 86016
    s_nop 0
    buffer_load_dwordx4 v16, s[28:31], s45 offen lds
    s_mov_b32 s32, s20
    s_and_b32 s33, s21, 0xffff
    s_mov_b32 s34, 2625536
    s_mov_b32 s35, 0x20000
    v_and_b32_e64 v2, 15, v0
    v_bfe_u32 v3, v0, 4, 2
    s_lshl_b32 s45, s70, 3
    s_add_u32 s45, s45, s22
    s_lshl_b32 s45, s45, 7
    s_add_u32 s45, s45, 16384000
    v_mov_b32 v232, s45
    v_mov_b32 v239, 0
    s_lshl_b32 s45, s69, 8
    s_add_u32 s45, s45, 16252928
    v_lshl_add_u32 v238, v1, 2, s45
    v_lshlrev_b32_e64 v234, 4, v1
    s_mul_i32 s37, s26, 2560
    s_mul_i32 s36, s70, 10240
    s_mul_i32 s44, s69, 82048
    s_add_u32 s36, s36, s44
    s_add_u32 s36, s36, s37
    s_add_u32 s37, s37, s71
    v_lshrrev_b32 v235, 1, v2
    v_lshlrev_b32 v235, 6, v235
    v_and_b32 v236, 1, v1
    v_lshl_add_u32 v235, v236, 3, v235
    v_lshl_add_u32 v235, v3, 4, v235
    v_add_u32 v235, s37, v235
    s_add_u32 s45, s23, 2
    v_and_b32 v236, 1, v3
    v_add_u32 v236, s45, v236
    v_and_b32 v236, 3, v236
    v_lshrrev_b32 v237, 1, v3
    v_lshl_add_u32 v236, v236, 1, v237
    v_mul_u32_u24 v236, 5120, v236
    s_lshl_b32 s45, s26, 8
    s_add_u32 s45, s45, 102400
    v_lshl_add_u32 v237, v2, 4, s45
    v_add_u32 v236, v236, v237
    v_lshl_add_u32 v237, v1, 2, s37
    s_waitcnt vmcnt(0)
    s_barrier
    s_branch L_floader
.p2align 12
L_kv:
    s_branch L_kvc
    s_nop 0
L_kvgo:
    s_waitcnt lgkmcnt(0)
    s_lshl_b32 s45, s43, 7
    s_add_u32 s45, s45, s40
    s_add_u32 m0, s41, 32768
    s_nop 0
    buffer_load_dwordx4 v10, s[28:31], s45 offen lds
    s_add_u32 m0, s41, 33792
    s_add_u32 s45, s45, 10240
    buffer_load_dwordx4 v11, s[28:31], s45 offen lds
    s_add_u32 m0, s41, 34816
    s_add_u32 s45, s45, 10240
    buffer_load_dwordx4 v10, s[28:31], s45 offen lds
    s_add_u32 m0, s41, 35840
    s_add_u32 s45, s45, 10240
    buffer_load_dwordx4 v11, s[28:31], s45 offen lds
    s_add_u32 s43, s43, 1
    s_cmp_eq_u32 s43, 10
    s_cselect_b32 s43, 0, s43
    s_load_dwordx16 s[4:19], s[0:1], 0
    s_load_dwordx8 s[56:63], s[0:1], 64
    s_load_dwordx4 s[64:67], s[0:1], 96
    s_load_dwordx2 s[20:21], s[0:1], 112
    s_bitcmp1_b32 s23, 0
    s_cbranch_scc1 L_wr_16
    s_mul_i32 s45, s44, 245760
    s_add_u32 m0, s42, 40960
    s_nop 0
    buffer_load_dwordx4 v12, s[32:35], s45 offen lds
    s_add_u32 m0, s42, 41984
    s_nop 0
    buffer_load_dwordx4 v13, s[32:35], s45 offen lds
    s_add_u32 m0, s42, 43008
    s_nop 0
    buffer_load_dwordx4 v14, s[32:35], s45 offen lds
    s_add_u32 m0, s42, 44032
    s_nop 0
    buffer_load_dwordx4 v15, s[32:35], s45 offen lds
    s_add_u32 m0, s42, 45056
    s_nop 0
    buffer_load_dwordx4 v16, s[32:35], s45 offen lds
    s_add_u32 s44, s44, 1
    s_cmp_eq_u32 s44, 10
    s_cselect_b32 s44, 0, s44
    s_branch L_wr_17
L_wr_16:
    s_mul_i32 s45, s44, 245760
    s_add_u32 m0, s42, 45056
    s_nop 0
    buffer_load_dwordx4 v16, s[32:35], s45 offen lds
    s_add_u32 m0, s42, 44032
    s_nop 0
    buffer_load_dwordx4 v15, s[32:35], s45 offen lds
    s_add_u32 m0, s42, 43008
    s_nop 0
    buffer_load_dwordx4 v14, s[32:35], s45 offen lds
    s_add_u32 m0, s42, 41984
    s_nop 0
    buffer_load_dwordx4 v13, s[32:35], s45 offen lds
    s_add_u32 m0, s42, 40960
    s_nop 0
    buffer_load_dwordx4 v12, s[32:35], s45 offen lds
    s_add_u32 s44, s44, 1
    s_cmp_eq_u32 s44, 10
    s_cselect_b32 s44, 0, s44
L_wr_17:
    s_getreg_b32 s72, hwreg(HW_REG_XCC_ID, 0, 4)
    s_or_b32 s72, s72, 0x80
    s_mul_i32 s72, s72, 0x01010101
    s_lshl_b32 s69, s22, 2
    s_lshr_b32 s73, s23, 3
    s_add_u32 s69, s69, s73
    s_and_b32 s70, s23, 7
    s_add_u32 s73, s23, 1
    s_and_b32 s73, s73, 3
    s_mul_i32 s73, s73, 10240
    s_add_u32 s71, s73, 102400
    v_lshlrev_b32_e64 v2, 4, v1
    s_setprio 0
    s_mul_i32 s46, s70, 160
    s_movk_i32 s45, 1120
    v_lshl_add_u32 v4, v1, 4, s46
    v_mul_u32_u24 v5, 6554, v1
    v_lshrrev_b32 v6, 16, v5
    v_mad_u32_u24 v72, v6, s45, v4
    v_add_u32 v5, 419456, v5
    v_add_u32 v4, 1024, v4
    v_lshrrev_b32_e64 v6, 16, v5
    v_mad_u32_u24 v73, v6, s45, v4
    v_add_u32 v5, 419456, v5
    v_add_u32 v4, 1024, v4
    v_lshrrev_b32_e64 v6, 16, v5
    v_mad_u32_u24 v74, v6, s45, v4
    v_add_u32 v5, 419456, v5
    v_add_u32 v4, 1024, v4
    v_lshrrev_b32_e64 v6, 16, v5
    v_mad_u32_u24 v75, v6, s45, v4
    v_add_u32 v5, 419456, v5
    v_add_u32 v4, 1024, v4
    v_lshrrev_b32_e64 v6, 16, v5
    v_mad_u32_u24 v76, v6, s45, v4
    s_and_b32 s50, s23, 3
    s_mul_i32 s48, s50, 800
    s_add_u32 s48, s48, 147456
    v_bfe_u32 v20, v1, 2, 2
    v_and_b32 v21, 3, v1
    v_lshrrev_b32 v26, 4, v1
    v_lshrrev_b32 v22, 2, v1
    v_mul_u32_u24 v22, 40, v22
    v_add_u32 v22, s48, v22
    v_mul_u32_u24 v23, 40, v20
    v_add_u32 v23, s48, v23
    v_add_u32 v23, 640, v23
    v_mov_b32 v24, 151552
    v_cmp_eq_u32 vcc, s50, v26
    s_nop 1
    v_cndmask_b32_e64 v23, v24, v23, vcc
    v_lshl_add_u32 v24, v21, 3, v22
    v_lshl_add_u32 v25, v21, 3, v23
    v_and_b32_e64 v26, 1, v20
    v_mul_u32_u24 v26, 0x8000, v26
    v_lshl_or_b32 v26, v26, 16, v26
    v_mov_b32 v52, 0
    v_mov_b32 v53, 0
    v_mov_b32 v54, 0
    v_mov_b32 v55, 0
    v_add_u32 v3, 151552, v2
    ds_write_b128 v3, v[52:55]
    s_and_b32 s50, s23, 3
    s_andn2_b32 s51, s23, 3
    s_add_u32 s51, s51, s26
    s_lshl_b32 s51, s51, 2
    s_lshl_b32 s53, s22, 2
    s_add_u32 s53, s53, s50
    s_lshl_b32 s48, s51, 5
    s_add_u32 s48, s48, s53
    s_mul_i32 s48, s48, 1280
    s_add_u32 s48, s48, 12587008
    v_lshl_add_u32 v44, v1, 4, s48
    v_lshrrev_b32_e64 v45, 4, v1
    v_mul_u32_u24 v45, 40704, v45
    v_add_u32 v45, v45, v44
    v_mov_b32 v48, -1
    v_mov_b32 v49, -1
    v_mov_b32 v50, -1
    v_mov_b32_e64 v51, -1
    s_lshl_b32 s74, s22, 5
    s_add_u32 s74, s74, s23
    s_and_b32 s75, s72, 0xff
    v_mul_u32_u24 v28, 22, v1
    v_add_u32 v28, s74, v28
    v_lshlrev_b32_e64 v29, 3, v28
    v_lshlrev_b32 v29, v29, s75
    v_and_b32 v28, 0xfc, v28
    s_cmp_lt_u32 s23, 10
    s_cselect_b64 s[74:75], 3, 1
    s_add_u32 s73, s23, s22
    s_and_b32 s73, s73, 7
    s_cmp_eq_u32 s24, 4
    s_cselect_b32 s73, s73, -1
    s_lshl_b32 s45, s43, 7
    s_add_u32 s45, s45, s40
    s_add_u32 m0, s41, 49152
    s_nop 0
    s_nop 0
    buffer_load_dwordx4 v10, s[28:31], s45 offen lds
    s_add_u32 m0, s41, 50176
    s_add_u32 s45, s45, 10240
    buffer_load_dwordx4 v11, s[28:31], s45 offen lds
    s_add_u32 m0, s41, 51200
    s_add_u32 s45, s45, 10240
    buffer_load_dwordx4 v10, s[28:31], s45 offen lds
    s_add_u32 m0, s41, 52224
    s_add_u32 s45, s45, 10240
    buffer_load_dwordx4 v11, s[28:31], s45 offen lds
    s_add_u32 s43, s43, 1
    s_cmp_eq_u32 s43, 10
    s_cselect_b32 s43, 0, s43
    s_waitcnt vmcnt(4) lgkmcnt(0)
    s_barrier
    s_mul_i32 s45, s44, 245760
    s_add_u32 m0, s42, 61440
    s_nop 0
    buffer_load_dwordx4 v12, s[32:35], s45 offen lds
    s_add_u32 m0, s42, 62464
    s_nop 0
    buffer_load_dwordx4 v13, s[32:35], s45 offen lds
    s_add_u32 m0, s42, 63488
    s_nop 0
    buffer_load_dwordx4 v14, s[32:35], s45 offen lds
    s_add_u32 m0, s42, 64512
    s_nop 0
    buffer_load_dwordx4 v15, s[32:35], s45 offen lds
    s_add_u32 m0, s42, 65536
    s_nop 0
    buffer_load_dwordx4 v16, s[32:35], s45 offen lds
    s_add_u32 s44, s44, 1
    s_cmp_eq_u32 s44, 10
    s_cselect_b32 s44, 0, s44
    s_lshl_b32 s45, s43, 7
    s_add_u32 s45, s45, s40
    s_add_u32 m0, s41, 0
    s_nop 0
    s_nop 0
    buffer_load_dwordx4 v10, s[28:31], s45 offen lds
    s_add_u32 m0, s41, 1024
    s_add_u32 s45, s45, 10240
    buffer_load_dwordx4 v11, s[28:31], s45 offen lds
    s_add_u32 m0, s41, 2048
    s_add_u32 s45, s45, 10240
    buffer_load_dwordx4 v10, s[28:31], s45 offen lds
    s_add_u32 m0, s41, 3072
    s_add_u32 s45, s45, 10240
    buffer_load_dwordx4 v11, s[28:31], s45 offen lds
    s_add_u32 s43, s43, 1
    s_cmp_eq_u32 s43, 10
    s_cselect_b32 s43, 0, s43
    s_mul_i32 s45, s44, 245760
    s_add_u32 m0, s42, 0
    s_nop 0
    buffer_load_dwordx4 v12, s[32:35], s45 offen lds
    s_add_u32 m0, s42, 1024
    s_nop 0
    buffer_load_dwordx4 v13, s[32:35], s45 offen lds
    s_add_u32 m0, s42, 2048
    s_nop 0
    buffer_load_dwordx4 v14, s[32:35], s45 offen lds
    s_add_u32 m0, s42, 3072
    s_nop 0
    buffer_load_dwordx4 v15, s[32:35], s45 offen lds
    s_add_u32 m0, s42, 4096
    s_nop 0
    buffer_load_dwordx4 v16, s[32:35], s45 offen lds
    s_add_u32 s44, s44, 1
    s_cmp_eq_u32 s44, 10
    s_cselect_b32 s44, 0, s44
    s_waitcnt vmcnt(9)
    s_barrier
    s_lshl_b32 s45, s43, 7
    s_add_u32 s45, s45, s40
    s_add_u32 m0, s41, 16384
    s_nop 0
    s_nop 0
    buffer_load_dwordx4 v10, s[28:31], s45 offen lds
    s_add_u32 m0, s41, 17408
    s_add_u32 s45, s45, 10240
    buffer_load_dwordx4 v11, s[28:31], s45 offen lds
    s_add_u32 m0, s41, 18432
    s_add_u32 s45, s45, 10240
    buffer_load_dwordx4 v10, s[28:31], s45 offen lds
    s_add_u32 m0, s41, 19456
    s_add_u32 s45, s45, 10240
    buffer_load_dwordx4 v11, s[28:31], s45 offen lds
    s_add_u32 s43, s43, 1
    s_cmp_eq_u32 s43, 10
    s_cselect_b32 s43, 0, s43
    s_cmp_lg_u32 s73, 0
    s_cbranch_scc1 L_ann_18
    s_mov_b64 exec, s[74:75]
        global_atomic_or v28, v29, s[66:67] sc1
    s_mov_b64 exec, -1
L_ann_18:
    s_mul_i32 s45, s44, 245760
    s_add_u32 m0, s42, 20480
    s_nop 0
    buffer_load_dwordx4 v12, s[32:35], s45 offen lds
    s_add_u32 m0, s42, 21504
    s_nop 0
    buffer_load_dwordx4 v13, s[32:35], s45 offen lds
    s_add_u32 m0, s42, 22528
    s_nop 0
    buffer_load_dwordx4 v14, s[32:35], s45 offen lds
    s_add_u32 m0, s42, 23552
    s_nop 0
    buffer_load_dwordx4 v15, s[32:35], s45 offen lds
    s_add_u32 m0, s42, 24576
    s_nop 0
    buffer_load_dwordx4 v16, s[32:35], s45 offen lds
    s_add_u32 s44, s44, 1
    s_cmp_eq_u32 s44, 10
    s_cselect_b32 s44, 0, s44
    s_cmp_lg_u32 s73, 1
    s_cbranch_scc1 L_ann_19
    s_mov_b64 exec, s[74:75]
        global_atomic_or v28, v29, s[66:67] sc1
    s_mov_b64 exec, -1
L_ann_19:
    s_waitcnt vmcnt(9)
    s_barrier
    s_lshl_b32 s45, s43, 7
    s_add_u32 s45, s45, s40
    s_add_u32 m0, s41, 32768
    s_nop 0
    buffer_load_dwordx4 v10, s[28:31], s45 offen lds
    s_add_u32 m0, s41, 33792
    s_add_u32 s45, s45, 10240
    buffer_load_dwordx4 v11, s[28:31], s45 offen lds
    s_add_u32 m0, s41, 34816
    s_add_u32 s45, s45, 10240
    buffer_load_dwordx4 v10, s[28:31], s45 offen lds
    s_add_u32 m0, s41, 35840
    s_add_u32 s45, s45, 10240
    buffer_load_dwordx4 v11, s[28:31], s45 offen lds
    s_add_u32 s43, s43, 1
    s_cmp_eq_u32 s43, 10
    s_cselect_b32 s43, 0, s43
    s_cmp_lg_u32 s73, 2
    s_cbranch_scc1 L_ann_20
    s_mov_b64 exec, s[74:75]
        global_atomic_or v28, v29, s[66:67] sc1
    s_mov_b64 exec, -1
L_ann_20:
    s_mul_i32 s45, s44, 245760
    s_add_u32 m0, s42, 40960
    s_nop 0
    buffer_load_dwordx4 v12, s[32:35], s45 offen lds
    s_add_u32 m0, s42, 41984
    s_nop 0
    buffer_load_dwordx4 v13, s[32:35], s45 offen lds
    s_add_u32 m0, s42, 43008
    s_nop 0
    buffer_load_dwordx4 v14, s[32:35], s45 offen lds
    s_add_u32 m0, s42, 44032
    s_nop 0
    buffer_load_dwordx4 v15, s[32:35], s45 offen lds
    s_add_u32 m0, s42, 45056
    s_nop 0
    buffer_load_dwordx4 v16, s[32:35], s45 offen lds
    s_add_u32 s44, s44, 1
    s_cmp_eq_u32 s44, 10
    s_cselect_b32 s44, 0, s44
    s_cmp_lg_u32 s73, 3
    s_cbranch_scc1 L_ann_21
    s_mov_b64 exec, s[74:75]
        global_atomic_or v28, v29, s[66:67] sc1
    s_mov_b64 exec, -1
L_ann_21:
    s_waitcnt vmcnt(9)
    s_barrier
    s_lshl_b32 s45, s43, 7
    s_add_u32 s45, s45, s40
    s_add_u32 m0, s41, 49152
    s_nop 0
    buffer_load_dwordx4 v10, s[28:31], s45 offen lds
    s_add_u32 m0, s41, 50176
    s_add_u32 s45, s45, 10240
    buffer_load_dwordx4 v11, s[28:31], s45 offen lds
    s_add_u32 m0, s41, 51200
    s_add_u32 s45, s45, 10240
    buffer_load_dwordx4 v10, s[28:31], s45 offen lds
    s_add_u32 m0, s41, 52224
    s_add_u32 s45, s45, 10240
    buffer_load_dwordx4 v11, s[28:31], s45 offen lds
    s_add_u32 s43, s43, 1
    s_cmp_eq_u32 s43, 10
    s_cselect_b32 s43, 0, s43
    s_cmp_lg_u32 s73, 4
    s_cbranch_scc1 L_ann_22
    s_mov_b64 exec, s[74:75]
        global_atomic_or v28, v29, s[66:67] sc1
    s_mov_b64 exec, -1
L_ann_22:
    s_mul_i32 s45, s44, 245760
    s_add_u32 m0, s42, 61440
    s_nop 0
    buffer_load_dwordx4 v12, s[32:35], s45 offen lds
    s_add_u32 m0, s42, 62464
    s_nop 0
    buffer_load_dwordx4 v13, s[32:35], s45 offen lds
    s_add_u32 m0, s42, 63488
    s_nop 0
    buffer_load_dwordx4 v14, s[32:35], s45 offen lds
    s_add_u32 m0, s42, 64512
    s_nop 0
    buffer_load_dwordx4 v15, s[32:35], s45 offen lds
    s_add_u32 m0, s42, 65536
    s_nop 0
    buffer_load_dwordx4 v16, s[32:35], s45 offen lds
    s_add_u32 s44, s44, 1
    s_cmp_eq_u32 s44, 10
    s_cselect_b32 s44, 0, s44
    s_cmp_lg_u32 s73, 5
    s_cbranch_scc1 L_ann_23
    s_mov_b64 exec, s[74:75]
        global_atomic_or v28, v29, s[66:67] sc1
    s_mov_b64 exec, -1
L_ann_23:
    s_waitcnt vmcnt(9)
    s_barrier
    s_lshl_b32 s45, s43, 7
    s_add_u32 s45, s45, s40
    s_add_u32 m0, s41, 0
    s_nop 0
    s_nop 0
    buffer_load_dwordx4 v10, s[28:31], s45 offen lds
    s_add_u32 m0, s41, 1024
    s_add_u32 s45, s45, 10240
    buffer_load_dwordx4 v11, s[28:31], s45 offen lds
    s_add_u32 m0, s41, 2048
    s_add_u32 s45, s45, 10240
    buffer_load_dwordx4 v10, s[28:31], s45 offen lds
    s_add_u32 m0, s41, 3072
    s_add_u32 s45, s45, 10240
    buffer_load_dwordx4 v11, s[28:31], s45 offen lds
    s_add_u32 s43, s43, 1
    s_cmp_eq_u32 s43, 10
    s_cselect_b32 s43, 0, s43
    s_cmp_lg_u32 s73, 6
    s_cbranch_scc1 L_ann_24
    s_mov_b64 exec, s[74:75]
        global_atomic_or v28, v29, s[66:67] sc1
    s_mov_b64 exec, -1
L_ann_24:
    s_mul_i32 s45, s44, 245760
    s_add_u32 m0, s42, 0
    s_nop 0
    buffer_load_dwordx4 v12, s[32:35], s45 offen lds
    s_add_u32 m0, s42, 1024
    s_nop 0
    buffer_load_dwordx4 v13, s[32:35], s45 offen lds
    s_add_u32 m0, s42, 2048
    s_nop 0
    buffer_load_dwordx4 v14, s[32:35], s45 offen lds
    s_add_u32 m0, s42, 3072
    s_nop 0
    buffer_load_dwordx4 v15, s[32:35], s45 offen lds
    s_add_u32 m0, s42, 4096
    s_nop 0
    buffer_load_dwordx4 v16, s[32:35], s45 offen lds
    s_add_u32 s44, s44, 1
    s_cmp_eq_u32 s44, 10
    s_cselect_b32 s44, 0, s44
    s_cmp_lg_u32 s73, 7
    s_cbranch_scc1 L_ann_25
    s_mov_b64 exec, s[74:75]
        global_atomic_or v28, v29, s[66:67] sc1
    s_mov_b64 exec, -1
L_ann_25:
    global_store_dwordx4 v44, v[48:51], s[20:21] sc1
    v_add_u32 v44, 40960, v44
    global_store_dwordx4 v44, v[48:51], s[20:21] sc1
    v_add_u32 v44, 40960, v44
    global_store_dwordx4 v44, v[48:51], s[20:21] sc1
    v_add_u32 v44, 40960, v44
    global_store_dwordx4 v44, v[48:51], s[20:21] sc1
    v_add_u32 v44, 40960, v44
    global_store_dwordx4 v45, v[48:51], s[20:21] offset:1024 sc1
    s_waitcnt vmcnt(14)
    s_barrier
    s_lshl_b32 s45, s43, 7
    s_add_u32 s45, s45, s40
    s_add_u32 m0, s41, 16384
    s_nop 0
    s_nop 0
    buffer_load_dwordx4 v10, s[28:31], s45 offen lds
    s_add_u32 m0, s41, 17408
    s_add_u32 s45, s45, 10240
    buffer_load_dwordx4 v11, s[28:31], s45 offen lds
    s_add_u32 m0, s41, 18432
    s_add_u32 s45, s45, 10240
    buffer_load_dwordx4 v10, s[28:31], s45 offen lds
    s_add_u32 m0, s41, 19456
    s_add_u32 s45, s45, 10240
    buffer_load_dwordx4 v11, s[28:31], s45 offen lds
    s_add_u32 s43, s43, 1
    s_cmp_eq_u32 s43, 10
    s_cselect_b32 s43, 0, s43
    s_mul_i32 s45, s44, 245760
    s_add_u32 m0, s42, 20480
    s_nop 0
    buffer_load_dwordx4 v12, s[32:35], s45 offen lds
    s_add_u32 m0, s42, 21504
    s_nop 0
    buffer_load_dwordx4 v13, s[32:35], s45 offen lds
    s_add_u32 m0, s42, 22528
    s_nop 0
    buffer_load_dwordx4 v14, s[32:35], s45 offen lds
    s_add_u32 m0, s42, 23552
    s_nop 0
    buffer_load_dwordx4 v15, s[32:35], s45 offen lds
    s_add_u32 m0, s42, 24576
    s_nop 0
    buffer_load_dwordx4 v16, s[32:35], s45 offen lds
    s_add_u32 s44, s44, 1
    s_cmp_eq_u32 s44, 10
    s_cselect_b32 s44, 0, s44
    s_waitcnt vmcnt(14)
    s_barrier
    s_lshl_b32 s45, s43, 7
    s_add_u32 s45, s45, s40
    s_add_u32 m0, s41, 32768
    s_nop 0
    buffer_load_dwordx4 v10, s[28:31], s45 offen lds
    s_add_u32 m0, s41, 33792
    s_add_u32 s45, s45, 10240
    buffer_load_dwordx4 v11, s[28:31], s45 offen lds
    s_add_u32 m0, s41, 34816
    s_add_u32 s45, s45, 10240
    buffer_load_dwordx4 v10, s[28:31], s45 offen lds
    s_add_u32 m0, s41, 35840
    s_add_u32 s45, s45, 10240
    buffer_load_dwordx4 v11, s[28:31], s45 offen lds
    s_add_u32 s43, s43, 1
    s_cmp_eq_u32 s43, 10
    s_cselect_b32 s43, 0, s43
    s_mul_i32 s45, s44, 245760
    s_add_u32 m0, s42, 40960
    s_nop 0
    buffer_load_dwordx4 v12, s[32:35], s45 offen lds
    s_add_u32 m0, s42, 41984
    s_nop 0
    buffer_load_dwordx4 v13, s[32:35], s45 offen lds
    s_add_u32 m0, s42, 43008
    s_nop 0
    buffer_load_dwordx4 v14, s[32:35], s45 offen lds
    s_add_u32 m0, s42, 44032
    s_nop 0
    buffer_load_dwordx4 v15, s[32:35], s45 offen lds
    s_add_u32 m0, s42, 45056
    s_nop 0
    buffer_load_dwordx4 v16, s[32:35], s45 offen lds
    s_add_u32 s44, s44, 1
    s_cmp_eq_u32 s44, 10
    s_cselect_b32 s44, 0, s44
    s_waitcnt vmcnt(9)
    s_barrier
    v_lshlrev_b32 v30, 2, v1
    s_cmp_lg_u32 s24, 4
    s_cbranch_scc1 L_ma_26
        global_load_dword v31, v30, s[66:67] sc1
L_ma_26:
    s_lshl_b32 s45, s43, 7
    s_add_u32 s45, s45, s40
    s_add_u32 m0, s41, 49152
    s_nop 0
    s_nop 0
    buffer_load_dwordx4 v10, s[28:31], s45 offen lds
    s_add_u32 m0, s41, 50176
    s_add_u32 s45, s45, 10240
    buffer_load_dwordx4 v11, s[28:31], s45 offen lds
    s_add_u32 m0, s41, 51200
    s_add_u32 s45, s45, 10240
    buffer_load_dwordx4 v10, s[28:31], s45 offen lds
    s_add_u32 m0, s41, 52224
    s_add_u32 s45, s45, 10240
    buffer_load_dwordx4 v11, s[28:31], s45 offen lds
    s_add_u32 s43, s43, 1
    s_cmp_eq_u32 s43, 10
    s_cselect_b32 s43, 0, s43
    s_mul_i32 s45, s44, 245760
    s_add_u32 m0, s42, 61440
    s_nop 0
    buffer_load_dwordx4 v12, s[32:35], s45 offen lds
    s_add_u32 m0, s42, 62464
    s_nop 0
    buffer_load_dwordx4 v13, s[32:35], s45 offen lds
    s_add_u32 m0, s42, 63488
    s_nop 0
    buffer_load_dwordx4 v14, s[32:35], s45 offen lds
    s_add_u32 m0, s42, 64512
    s_nop 0
    buffer_load_dwordx4 v15, s[32:35], s45 offen lds
    s_add_u32 m0, s42, 65536
    s_nop 0
    buffer_load_dwordx4 v16, s[32:35], s45 offen lds
    s_add_u32 s44, s44, 1
    s_cmp_eq_u32 s44, 10
    s_cselect_b32 s44, 0, s44
    s_waitcnt vmcnt(9)
    s_barrier
    s_cmp_lg_u32 s24, 4
    s_cbranch_scc1 L_mt_27
    s_setprio 3
        s_waitcnt vmcnt(9)
    v_and_b32 v32, 0x80808080, v31
    v_cmp_ne_u32 vcc, 0x80808080, v32
    s_nop 0
    s_cbranch_vccz L_ann_28
    s_mov_b32 s27, 0
L_poll_29:
    global_load_dword v31, v30, s[66:67] sc1
    s_waitcnt vmcnt(0)
    v_and_b32 v32, 0x80808080, v31
    v_cmp_ne_u32 vcc, 0x80808080, v32
    s_nop 0
    s_cbranch_vccz L_polled_30
    s_add_u32 s27, s27, 1
    s_cmp_lt_u32 s27, 262144
    s_cbranch_scc1 L_poll_29
L_polled_30:
L_ann_28:
    v_cmp_eq_u32 vcc, s72, v31
    s_lshl_b32 s74, s22, 3
    s_lshr_b64 s[74:75], vcc, s74
    s_and_b32 s74, s74, 0xff
    s_cmp_eq_u32 s74, 0xff
    s_cselect_b32 s68, 1, 0
    v_mov_b32 v32, 152576
    v_mov_b32 v33, s68
    ds_write_b32 v32, v33
    s_setprio 0
L_mt_27:
    ds_read_b64_tr_b16 v[60:61], v24
    ds_read_b64_tr_b16 v[62:63], v25
    ds_read_b64_tr_b16 v[64:65], v22 offset:32
    ds_read_b64_tr_b16 v[66:67], v23 offset:32
    s_mov_b32 s28, s60
    s_and_b32 s29, s61, 0xffff
    s_mov_b32 s30, 819200
    s_mov_b32 s31, 0x20000
    s_mul_i32 s44, s26, 5120
    s_mul_i32 s45, s26, 40960
    s_add_u32 s45, s45, 0
    s_add_u32 m0, s44, 0
    s_nop 0
    buffer_load_dwordx4 v72, s[28:31], s45 offen lds
    s_add_u32 m0, s44, 1024
    s_nop 0
    buffer_load_dwordx4 v73, s[28:31], s45 offen lds
    s_add_u32 m0, s44, 2048
    s_nop 0
    buffer_load_dwordx4 v74, s[28:31], s45 offen lds
    s_add_u32 m0, s44, 3072
    s_nop 0
    buffer_load_dwordx4 v75, s[28:31], s45 offen lds
    s_add_u32 m0, s44, 4096
    s_nop 0
    buffer_load_dwordx4 v76, s[28:31], s45 offen lds
    s_waitcnt vmcnt(5) lgkmcnt(0)
    s_barrier
    s_mov_b32 s28, s60
    s_and_b32 s29, s61, 0xffff
    s_mov_b32 s30, 819200
    s_mov_b32 s31, 0x20000
    s_mul_i32 s44, s26, 5120
    s_mul_i32 s45, s26, 40960
    s_add_u32 s45, s45, 655360
    s_add_u32 m0, s44, 81920
    s_nop 0
    buffer_load_dwordx4 v72, s[28:31], s45 offen lds
    s_add_u32 m0, s44, 82944
    s_nop 0
    buffer_load_dwordx4 v73, s[28:31], s45 offen lds
    s_add_u32 m0, s44, 83968
    s_nop 0
    buffer_load_dwordx4 v74, s[28:31], s45 offen lds
    s_add_u32 m0, s44, 84992
    s_nop 0
    buffer_load_dwordx4 v75, s[28:31], s45 offen lds
    s_add_u32 m0, s44, 86016
    s_nop 0
    buffer_load_dwordx4 v76, s[28:31], s45 offen lds
    s_waitcnt lgkmcnt(0)
    s_barrier
    s_mov_b32 s28, s60
    s_and_b32 s29, s61, 0xffff
    s_mov_b32 s30, 819200
    s_mov_b32 s31, 0x20000
    s_mul_i32 s44, s26, 5120
    s_mul_i32 s45, s26, 40960
    s_add_u32 s45, s45, 163840
    s_add_u32 m0, s44, 20480
    s_nop 0
    buffer_load_dwordx4 v72, s[28:31], s45 offen lds
    s_add_u32 m0, s44, 21504
    s_nop 0
    buffer_load_dwordx4 v73, s[28:31], s45 offen lds
    s_add_u32 m0, s44, 22528
    s_nop 0
    buffer_load_dwordx4 v74, s[28:31], s45 offen lds
    s_add_u32 m0, s44, 23552
    s_nop 0
    buffer_load_dwordx4 v75, s[28:31], s45 offen lds
    s_add_u32 m0, s44, 24576
    s_nop 0
    buffer_load_dwordx4 v76, s[28:31], s45 offen lds
    s_mul_i32 s45, s26, 40960
    s_add_u32 s45, s45, 491520
    s_add_u32 m0, s44, 61440
    s_branch L_over_kv_0
L_warm_kv:
    s_branch L_warm_kv_1
L_over_kv_0:
    s_nop 0
    buffer_load_dwordx4 v72, s[28:31], s45 offen lds
    s_add_u32 m0, s44, 62464
    s_nop 0
    buffer_load_dwordx4 v73, s[28:31], s45 offen lds
    s_add_u32 m0, s44, 63488
    s_nop 0
    buffer_load_dwordx4 v74, s[28:31], s45 offen lds
    s_add_u32 m0, s44, 64512
    s_nop 0
    buffer_load_dwordx4 v75, s[28:31], s45 offen lds
    s_add_u32 m0, s44, 65536
    s_nop 0
    buffer_load_dwordx4 v76, s[28:31], s45 offen lds
    s_mul_i32 s45, s26, 40960
    s_add_u32 s45, s45, 327680
    s_add_u32 m0, s44, 40960
    s_nop 0
    buffer_load_dwordx4 v72, s[28:31], s45 offen lds
    s_add_u32 m0, s44, 41984
    s_nop 0
    buffer_load_dwordx4 v73, s[28:31], s45 offen lds
    s_add_u32 m0, s44, 43008
    s_nop 0
    buffer_load_dwordx4 v74, s[28:31], s45 offen lds
    s_add_u32 m0, s44, 44032
    s_nop 0
    buffer_load_dwordx4 v75, s[28:31], s45 offen lds
    s_add_u32 m0, s44, 45056
    s_nop 0
    buffer_load_dwordx4 v76, s[28:31], s45 offen lds
    v_cmp_gt_u32 vcc, 2, v20
    v_xor_b32 v64, v26, v64
    s_nop 0
    v_cndmask_b32 v68, v64, 0, vcc
    v_cndmask_b32 v64, 0, v64, vcc
    v_xor_b32 v65, v26, v65
    v_cndmask_b32 v69, v65, 0, vcc
    v_cndmask_b32 v65, 0, v65, vcc
    v_xor_b32 v66, v26, v66
    v_cndmask_b32 v70, v66, 0, vcc
    v_cndmask_b32 v66, 0, v66, vcc
    v_xor_b32 v67, v26, v67
    v_cndmask_b32 v71, v67, 0, vcc
    v_cndmask_b32 v67, 0, v67, vcc
    v_and_b32 v2, 15, v0
    v_bfe_u32 v3, v0, 4, 2
    s_and_b32 s50, s23, 3
    s_andn2_b32 s51, s23, 3
    s_add_u32 s51, s51, s26
    s_lshl_b32 s51, s51, 2
    s_lshl_b32 s40, s22, 9
    s_mul_i32 s41, s26, 0
    s_add_u32 s40, s40, s41
    s_add_u32 s40, s40, 16318720
    v_add_u32 v4, s51, v1
    v_mul_u32_u24 v7, 373, v4
    v_lshrrev_b32 v7, 12, v7
    v_cmp_lt_u32_e64 vcc, 53, v4
    s_nop 1
    v_cndmask_b32 v7, v7, 5, vcc
    v_subb_co_u32 v8, vcc, 0, 0, vcc
    v_mul_u32_u24 v9, 11, v7
    v_add_u32 v9, v9, v8
    v_sub_u32 v4, v4, v9
    v_cmp_lt_u32_e64 vcc, 3, v7
    s_nop 1
    v_cndmask_b32 v8, 0, 1, vcc
    v_lshrrev_b32 v9, 3, v4
    v_and_b32 v8, v8, v9
    v_add_u32_e64 v4, v4, v8
    v_mul_u32_u24 v4, 86, v4
    v_lshrrev_b32_e64 v4, 8, v4
    v_lshl_add_u32 v4, v7, 2, v4
    v_min_u32_e64 v4, 23, v4
    v_lshl_add_u32 v4, v4, 2, s40
    s_lshl_b32 s40, s22, 6
    s_add_u32 s40, s40, s51
    s_mul_i32 s40, s40, 5120
    s_add_u32 s40, s40, 4194304
    s_lshl_b32 s41, s50, 10
    s_add_u32 s41, s41, s40
    s_add_u32 s40, s40, 4096
    v_lshl_add_u32 v5, v1, 4, s41
    v_lshl_add_u32 v6, v1, 4, s40
    s_mul_i32 s52, s50, 10240
    s_add_u32 s52, s52, 102400
    v_lshl_add_u32 v15, v1, 4, s52
    v_and_b32_e64 v8, 7, v1
    v_lshl_add_u32 v8, v3, 3, v8
    v_lshl_add_u32 v8, v8, 4, s52
    v_and_b32_e64 v9, 31, v1
    v_lshl_add_u32 v9, v9, 4, s52
    s_lshl_b32 s53, s22, 2
    s_add_u32 s53, s53, s50
    s_lshl_b32 s40, s51, 5
    s_add_u32 s40, s40, s53
    s_mul_i32 s40, s40, 1280
    s_add_u32 s40, s40, 12587008
    v_lshl_add_u32 v10, v1, 4, s40
    v_mul_u32_u24 v11, 40960, v3
    v_lshl_add_u32 v11, v2, 4, v11
    v_add_u32 v11, s40, v11
    s_lshr_b32 s40, s22, 2
    s_add_u32 s40, s40, s51
    s_lshl_b32 s40, s40, 8
    s_add_u32 s40, s40, 16449536
    v_and_b32 v12, 2, v1
    v_add_u32 v12, v12, v1
    v_lshl_add_u32 v12, v12, 7, s40
    s_and_b32 s40, s22, 3
    s_lshl_b32 s40, s40, 3
    s_lshl_b32 s40, 1, s40
    v_mov_b32 v13, s40
    v_mov_b32 v54, 0x358637bd
    s_mov_b32 s32, s20
    s_and_b32 s33, s21, 0xffff
    s_mov_b32 s34, 2625536
    s_mov_b32 s35, 0x20000
    v_and_b32 v2, 15, v0
    v_bfe_u32 v3, v0, 4, 2
    s_lshl_b32 s45, s70, 3
    s_add_u32 s45, s45, s22
    s_lshl_b32 s45, s45, 7
    s_add_u32 s45, s45, 16384000
    v_mov_b32 v232, s45
    v_mov_b32 v239, 0
    s_lshl_b32 s45, s69, 8
    s_add_u32 s45, s45, 16252928
    v_lshl_add_u32 v238, v1, 2, s45
    v_lshlrev_b32_e64 v234, 4, v1
    s_mul_i32 s37, s26, 2560
    s_mul_i32 s36, s70, 10240
    s_mul_i32 s44, s69, 82048
    s_add_u32 s36, s36, s44
    s_add_u32 s36, s36, s37
    s_add_u32 s37, s37, s71
    v_lshrrev_b32 v235, 1, v2
    v_lshlrev_b32 v235, 6, v235
    v_and_b32 v236, 1, v1
    v_lshl_add_u32 v235, v236, 3, v235
    v_lshl_add_u32 v235, v3, 4, v235
    v_add_u32 v235, s37, v235
    s_add_u32 s45, s23, 2
    v_and_b32 v236, 1, v3
    v_add_u32 v236, s45, v236
    v_and_b32 v236, 3, v236
    v_lshrrev_b32 v237, 1, v3
    v_lshl_add_u32 v236, v236, 1, v237
    v_mul_u32_u24 v236, 5120, v236
    s_lshl_b32 s45, s26, 8
    s_add_u32 s45, s45, 102400
    v_lshl_add_u32 v237, v2, 4, s45
    v_add_u32 v236, v236, v237
    v_lshl_add_u32 v237, v1, 2, s37
    s_and_b32 s45, s23, 3
    s_mul_i32 s45, s45, 2560
    s_add_u32 s45, s45, s26
    s_lshl_b32 s45, s45, 2
    s_add_u32 s45, s45, 106496
    v_mov_b32_e64 v241, s45
    s_barrier
    s_mov_b64 exec, 15
    s_mov_b32 s27, 0
L_poll_31:
    global_load_dword v7, v4, s[20:21] sc1
    s_waitcnt vmcnt(0)
    v_cmp_ne_u32_e64 vcc, 1, v7
    s_nop 0
    s_cbranch_vccz L_polled_32
    s_add_u32 s27, s27, 1
    s_cmp_lt_u32 s27, 262144
    s_cbranch_scc1 L_poll_31
L_polled_32:
    s_mov_b64 exec, -1
    global_load_dwordx4 v[72:75], v5, s[20:21] sc1 nt
    global_load_dwordx4 v[76:79], v6, s[20:21] sc1
    v_add_u32 v5, 5120, v5
    v_add_u32 v6, 5120, v6
    global_load_dwordx4 v[80:83], v5, s[20:21] sc1 nt
    global_load_dwordx4 v[84:87], v6, s[20:21] sc1
    v_add_u32 v5, 5120, v5
    v_add_u32 v6, 5120, v6
    global_load_dwordx4 v[88:91], v5, s[20:21] sc1 nt
    global_load_dwordx4 v[92:95], v6, s[20:21] sc1
    v_add_u32 v5, 5120, v5
    v_add_u32 v6, 5120, v6
    global_load_dwordx4 v[96:99], v5, s[20:21] sc1 nt
    global_load_dwordx4 v[100:103], v6, s[20:21] sc1
    s_waitcnt vmcnt(6)
    v_swap_b32 v74, v76
    v_swap_b32 v75, v77
    s_nop 1
    v_mfma_f32_16x16x32_bf16 v[144:147], v[60:63], v[72:75], 0
    v_mfma_f32_16x16x32_bf16 v[148:151], v[60:63], v[76:79], 0
    v_mfma_f32_16x16x32_bf16 v[152:155], v[64:67], v[72:75], 0
    v_mfma_f32_16x16x32_bf16 v[152:155], v[68:71], v[76:79], v[152:155]
    s_waitcnt vmcnt(4)
    v_swap_b32 v82, v84
    v_swap_b32 v83, v85
    s_nop 1
    v_mfma_f32_16x16x32_bf16 v[188:191], v[60:63], v[80:83], 0
    v_mfma_f32_16x16x32_bf16 v[192:195], v[60:63], v[84:87], 0
    v_exp_f32_e64 v156, v144
    v_mfma_f32_16x16x32_bf16 v[196:199], v[64:67], v[80:83], 0
    v_exp_f32 v157, v145
    v_exp_f32 v158, v146
    v_mfma_f32_16x16x32_bf16 v[196:199], v[68:71], v[84:87], v[196:199]
    v_exp_f32_e64 v159, v147
    v_exp_f32 v160, -v144
    v_exp_f32 v161, -v145
    v_exp_f32 v162, -v146
    v_exp_f32 v163, -v147
    v_exp_f32 v164, v148
    s_waitcnt vmcnt(2)
    v_swap_b32 v90, v92
    v_exp_f32 v165, v149
    v_swap_b32 v91, v93
    v_exp_f32_e64 v166, v150
    s_nop 0
    v_mfma_f32_16x16x32_bf16 v[16:19], v[60:63], v[88:91], 0
    v_exp_f32_e64 v167, v151
    v_exp_f32 v168, -v148
    v_mfma_f32_16x16x32_bf16 v[20:23], v[60:63], v[92:95], 0
    v_exp_f32 v169, -v149
    v_mfma_f32_16x16x32_bf16 v[24:27], v[64:67], v[88:91], 0
    v_exp_f32 v170, -v150
    v_mfma_f32_16x16x32_bf16 v[24:27], v[68:71], v[92:95], v[24:27]
    v_exp_f32 v171, -v151
    v_exp_f32 v172, v152
    s_waitcnt vmcnt(0)
    v_swap_b32 v98, v100
    v_exp_f32 v173, v153
    v_swap_b32 v99, v101
    v_exp_f32_e64 v174, v154
    s_nop 0
    v_mfma_f32_16x16x32_bf16 v[28:31], v[60:63], v[96:99], 0
    v_exp_f32 v175, v155
    v_exp_f32 v200, v188
    v_mfma_f32_16x16x32_bf16 v[32:35], v[60:63], v[100:103], 0
    v_exp_f32_e64 v201, v189
    v_mfma_f32_16x16x32_bf16 v[36:39], v[64:67], v[96:99], 0
    v_exp_f32_e64 v202, v190
    v_mfma_f32_16x16x32_bf16 v[36:39], v[68:71], v[100:103], v[36:39]
    v_exp_f32_e64 v203, v191
    v_exp_f32 v204, -v188
    v_exp_f32 v205, -v189
    v_exp_f32 v206, -v190
    v_exp_f32 v207, -v191
    v_exp_f32 v208, v192
    v_exp_f32 v209, v193
    v_exp_f32 v210, v194
    v_exp_f32 v211, v195
    v_exp_f32 v212, -v192
    v_exp_f32 v213, -v193
    v_exp_f32 v214, -v194
    v_exp_f32 v215, -v195
    v_exp_f32 v216, v196
    v_exp_f32 v217, v197
    v_exp_f32 v218, v198
    v_exp_f32 v219, v199
    v_pk_add_f32 v[176:177], v[156:157], v[158:159]
    v_pk_add_f32 v[220:221], v[200:201], v[202:203]
    v_pk_add_f32 v[178:179], v[160:161], v[162:163]
    v_pk_add_f32 v[222:223], v[204:205], v[206:207]
    v_pk_add_f32 v[180:181], v[164:165], v[166:167]
    v_pk_add_f32 v[224:225], v[208:209], v[210:211]
    v_pk_add_f32 v[182:183], v[168:169], v[170:171]
    v_pk_add_f32 v[226:227], v[212:213], v[214:215]
    v_pk_add_f32 v[184:185], v[172:173], v[174:175]
    v_pk_add_f32 v[228:229], v[216:217], v[218:219]
    v_add_f32 v176, v176, v177
    v_add_f32 v220, v220, v221
    v_add_f32 v178, v178, v179
    v_add_f32 v222, v222, v223
    v_add_f32 v180, v180, v181
    v_add_f32 v224, v224, v225
    v_add_f32 v182, v182, v183
    v_add_f32 v226, v226, v227
    v_add_f32 v184, v184, v185
    v_add_f32 v228, v228, v229
    v_permlane32_swap_b32 v176, v180
    v_permlane32_swap_b32 v220, v224
    v_permlane32_swap_b32 v178, v182
    v_permlane32_swap_b32 v222, v226
    v_add_f32 v176, v176, v180
    v_add_f32 v220, v220, v224
    v_add_f32 v178, v178, v182
    v_add_f32 v222, v222, v226
    s_nop 0
    v_permlane16_swap_b32 v176, v178
    v_permlane16_swap_b32 v220, v222
    v_add_f32 v184, v184, v176
    v_add_f32 v228, v228, v220
    v_add_f32 v184, v184, v178
    v_add_f32 v228, v228, v222
    v_max_f32 v14, v184, v228
    v_cmp_lt_f32 vcc, 0x5d800000, v14
    s_nop 0
    s_cbranch_vccnz L_qslow_33
L_qback_34:
    v_rcp_f32 v184, v184
    v_rcp_f32 v228, v228
    v_mov_b32 v176, v184
    v_mov_b32 v220, v228
    v_mov_b32 v178, v184
    v_mov_b32 v222, v228
    s_nop 0
    v_permlane16_swap_b32 v176, v178
    v_permlane16_swap_b32 v220, v222
    v_mov_b32 v180, v176
    v_mov_b32 v224, v220
    v_mov_b32 v182, v178
    v_mov_b32_e64 v226, v222
    v_permlane32_swap_b32 v176, v180
    v_permlane32_swap_b32 v220, v224
    v_permlane32_swap_b32 v178, v182
    v_permlane32_swap_b32 v222, v226
    v_pk_mul_f32 v[156:157], v[156:157], v[176:177] op_sel_hi:[1,0]
    v_pk_mul_f32 v[200:201], v[200:201], v[220:221] op_sel_hi:[1,0]
    v_pk_mul_f32 v[158:159], v[158:159], v[176:177] op_sel_hi:[1,0]
    v_pk_mul_f32 v[202:203], v[202:203], v[220:221] op_sel_hi:[1,0]
    v_pk_mul_f32 v[160:161], v[160:161], v[178:179] op_sel_hi:[1,0]
    v_pk_mul_f32 v[204:205], v[204:205], v[222:223] op_sel_hi:[1,0]
    v_pk_mul_f32 v[162:163], v[162:163], v[178:179] op_sel_hi:[1,0]
    v_pk_mul_f32 v[206:207], v[206:207], v[222:223] op_sel_hi:[1,0]
    v_pk_mul_f32 v[164:165], v[164:165], v[180:181] op_sel_hi:[1,0]
    v_pk_mul_f32 v[208:209], v[208:209], v[224:225] op_sel_hi:[1,0]
    v_pk_mul_f32 v[166:167], v[166:167], v[180:181] op_sel_hi:[1,0]
    v_pk_mul_f32 v[210:211], v[210:211], v[224:225] op_sel_hi:[1,0]
    v_pk_mul_f32 v[168:169], v[168:169], v[182:183] op_sel_hi:[1,0]
    v_pk_mul_f32 v[212:213], v[212:213], v[226:227] op_sel_hi:[1,0]
    v_pk_mul_f32 v[170:171], v[170:171], v[182:183] op_sel_hi:[1,0]
    v_pk_mul_f32 v[214:215], v[214:215], v[226:227] op_sel_hi:[1,0]
    v_pk_mul_f32 v[172:173], v[172:173], v[184:185] op_sel_hi:[1,0]
    v_pk_mul_f32 v[216:217], v[216:217], v[228:229] op_sel_hi:[1,0]
    v_pk_mul_f32 v[174:175], v[174:175], v[184:185] op_sel_hi:[1,0]
    v_pk_mul_f32 v[218:219], v[218:219], v[228:229] op_sel_hi:[1,0]
    v_cvt_pk_bf16_f32 v104, v156, v157
    v_cvt_pk_bf16_f32 v114, v200, v201
    v_cvt_pk_bf16_f32 v105, v158, v159
    v_cvt_pk_bf16_f32 v115, v202, v203
    v_cvt_pk_bf16_f32 v106, v160, v161
    v_cvt_pk_bf16_f32 v116, v204, v205
    v_cvt_pk_bf16_f32 v107, v162, v163
    v_cvt_pk_bf16_f32 v117, v206, v207
    v_cvt_pk_bf16_f32 v108, v164, v165
    v_cvt_pk_bf16_f32 v118, v208, v209
    v_cvt_pk_bf16_f32 v109, v166, v167
    v_cvt_pk_bf16_f32 v119, v210, v211
    v_cvt_pk_bf16_f32 v110, v168, v169
    v_cvt_pk_bf16_f32 v120, v212, v213
    v_cvt_pk_bf16_f32 v111, v170, v171
    v_cvt_pk_bf16_f32 v121, v214, v215
    v_cvt_pk_bf16_f32 v112, v172, v173
    v_cvt_pk_bf16_f32 v122, v216, v217
    v_cvt_pk_bf16_f32 v113, v174, v175
    v_cvt_pk_bf16_f32 v123, v218, v219
    v_exp_f32 v156, v16
    v_exp_f32 v157, v17
    v_exp_f32 v158, v18
    v_exp_f32 v159, v19
    v_exp_f32 v160, -v16
    v_exp_f32 v161, -v17
    v_exp_f32 v162, -v18
    v_exp_f32 v163, -v19
    v_exp_f32 v164, v20
    v_exp_f32 v165, v21
    v_exp_f32 v166, v22
    v_exp_f32 v167, v23
    v_exp_f32 v168, -v20
    v_exp_f32 v169, -v21
    v_exp_f32 v170, -v22
    v_exp_f32 v171, -v23
    v_exp_f32 v172, v24
    v_exp_f32 v173, v25
    v_exp_f32 v174, v26
    v_exp_f32 v175, v27
    v_exp_f32 v200, v28
    v_exp_f32 v201, v29
    v_exp_f32 v202, v30
    v_exp_f32 v203, v31
    v_exp_f32 v204, -v28
    v_exp_f32 v205, -v29
    v_exp_f32 v206, -v30
    v_exp_f32 v207, -v31
    v_exp_f32 v208, v32
    v_exp_f32 v209, v33
    v_exp_f32 v210, v34
    v_exp_f32 v211, v35
    v_exp_f32 v212, -v32
    v_exp_f32 v213, -v33
    v_exp_f32 v214, -v34
    v_exp_f32 v215, -v35
    v_exp_f32 v216, v36
    v_exp_f32 v217, v37
    v_exp_f32 v218, v38
    v_exp_f32 v219, v39
    v_pk_add_f32 v[176:177], v[156:157], v[158:159]
    v_pk_add_f32 v[220:221], v[200:201], v[202:203]
    v_pk_add_f32 v[178:179], v[160:161], v[162:163]
    v_pk_add_f32 v[222:223], v[204:205], v[206:207]
    v_pk_add_f32 v[180:181], v[164:165], v[166:167]
    v_pk_add_f32 v[224:225], v[208:209], v[210:211]
    v_pk_add_f32 v[182:183], v[168:169], v[170:171]
    v_pk_add_f32 v[226:227], v[212:213], v[214:215]
    v_pk_add_f32 v[184:185], v[172:173], v[174:175]
    v_pk_add_f32 v[228:229], v[216:217], v[218:219]
    v_add_f32 v176, v176, v177
    v_add_f32 v220, v220, v221
    v_add_f32 v178, v178, v179
    v_add_f32 v222, v222, v223
    v_add_f32 v180, v180, v181
    v_add_f32 v224, v224, v225
    v_add_f32 v182, v182, v183
    v_add_f32 v226, v226, v227
    v_add_f32 v184, v184, v185
    v_add_f32 v228, v228, v229
    v_permlane32_swap_b32 v176, v180
    v_permlane32_swap_b32 v220, v224
    v_permlane32_swap_b32 v178, v182
    v_permlane32_swap_b32 v222, v226
    v_add_f32 v176, v176, v180
    v_add_f32 v220, v220, v224
    v_add_f32 v178, v178, v182
    v_add_f32 v222, v222, v226
    s_nop 0
    v_permlane16_swap_b32 v176, v178
    v_permlane16_swap_b32 v220, v222
    v_add_f32 v184, v184, v176
    v_add_f32 v228, v228, v220
    v_add_f32 v184, v184, v178
    v_add_f32 v228, v228, v222
    v_max_f32 v14, v184, v228
    v_cmp_lt_f32 vcc, 0x5d800000, v14
    s_nop 0
    s_cbranch_vccnz L_qslow_35
L_qback_36:
    v_rcp_f32 v184, v184
    v_rcp_f32 v228, v228
    v_mov_b32 v176, v184
    v_mov_b32 v220, v228
    v_mov_b32 v178, v184
    v_mov_b32 v222, v228
    s_nop 0
    v_permlane16_swap_b32 v176, v178
    v_permlane16_swap_b32 v220, v222
    v_mov_b32 v180, v176
    v_mov_b32 v224, v220
    v_mov_b32 v182, v178
    v_mov_b32_e64 v226, v222
    v_permlane32_swap_b32 v176, v180
    v_permlane32_swap_b32 v220, v224
    v_permlane32_swap_b32 v178, v182
    v_permlane32_swap_b32 v222, v226
    v_pk_mul_f32 v[156:157], v[156:157], v[176:177] op_sel_hi:[1,0]
    v_pk_mul_f32 v[200:201], v[200:201], v[220:221] op_sel_hi:[1,0]
    v_pk_mul_f32 v[158:159], v[158:159], v[176:177] op_sel_hi:[1,0]
    v_pk_mul_f32 v[202:203], v[202:203], v[220:221] op_sel_hi:[1,0]
    v_pk_mul_f32 v[160:161], v[160:161], v[178:179] op_sel_hi:[1,0]
    v_pk_mul_f32 v[204:205], v[204:205], v[222:223] op_sel_hi:[1,0]
    v_pk_mul_f32 v[162:163], v[162:163], v[178:179] op_sel_hi:[1,0]
    v_pk_mul_f32 v[206:207], v[206:207], v[222:223] op_sel_hi:[1,0]
    v_pk_mul_f32 v[164:165], v[164:165], v[180:181] op_sel_hi:[1,0]
    v_pk_mul_f32 v[208:209], v[208:209], v[224:225] op_sel_hi:[1,0]
    v_pk_mul_f32 v[166:167], v[166:167], v[180:181] op_sel_hi:[1,0]
    v_pk_mul_f32 v[210:211], v[210:211], v[224:225] op_sel_hi:[1,0]
    v_pk_mul_f32 v[168:169], v[168:169], v[182:183] op_sel_hi:[1,0]
    v_pk_mul_f32 v[212:213], v[212:213], v[226:227] op_sel_hi:[1,0]
    v_pk_mul_f32 v[170:171], v[170:171], v[182:183] op_sel_hi:[1,0]
    v_pk_mul_f32 v[214:215], v[214:215], v[226:227] op_sel_hi:[1,0]
    v_pk_mul_f32 v[172:173], v[172:173], v[184:185] op_sel_hi:[1,0]
    v_pk_mul_f32 v[216:217], v[216:217], v[228:229] op_sel_hi:[1,0]
    v_pk_mul_f32 v[174:175], v[174:175], v[184:185] op_sel_hi:[1,0]
    v_pk_mul_f32 v[218:219], v[218:219], v[228:229] op_sel_hi:[1,0]
    v_cvt_pk_bf16_f32 v124, v156, v157
    v_cvt_pk_bf16_f32 v134, v200, v201
    v_cvt_pk_bf16_f32 v125, v158, v159
    v_cvt_pk_bf16_f32 v135, v202, v203
    v_cvt_pk_bf16_f32 v126, v160, v161
    v_cvt_pk_bf16_f32 v136, v204, v205
    v_cvt_pk_bf16_f32 v127, v162, v163
    v_cvt_pk_bf16_f32 v137, v206, v207
    v_cvt_pk_bf16_f32 v128, v164, v165
    v_cvt_pk_bf16_f32 v138, v208, v209
    v_cvt_pk_bf16_f32 v129, v166, v167
    v_cvt_pk_bf16_f32 v139, v210, v211
    v_cvt_pk_bf16_f32 v130, v168, v169
    v_cvt_pk_bf16_f32 v140, v212, v213
    v_cvt_pk_bf16_f32 v131, v170, v171
    v_cvt_pk_bf16_f32 v141, v214, v215
    v_cvt_pk_bf16_f32 v132, v172, v173
    v_cvt_pk_bf16_f32 v142, v216, v217
    v_cvt_pk_bf16_f32 v133, v174, v175
    v_cvt_pk_bf16_f32 v143, v218, v219
    v_cmp_gt_u32_e64 vcc, 32, v1
    s_setprio 2
    s_barrier
    global_load_dword v240, v238, s[20:21] sc1
    ds_read_b128 v[20:23], v8 offset:1024
    ds_read_b128 v[24:27], v9 offset:1536
    ds_read_b128 v[16:19], v15
    s_waitcnt lgkmcnt(2)
    v_mfma_f32_16x16x32_bf16 v[148:151], v[20:23], v[104:107], v[52:55]
    v_mfma_f32_16x16x32_bf16 v[156:159], v[20:23], v[108:111], v[52:55]
    s_waitcnt lgkmcnt(0)
    v_mfma_f32_16x16x32_bf16 v[144:147], v[16:19], v[104:107], 0
    v_mfma_f32_16x16x32_bf16 v[152:155], v[16:19], v[108:111], 0
    v_cndmask_b32 v28, v24, 0, vcc
    v_mfma_f32_16x16x32_bf16 v[164:167], v[20:23], v[114:117], v[52:55]
    v_cndmask_b32_e64 v24, 0, v24, vcc
    v_cndmask_b32 v29, v25, 0, vcc
    v_mfma_f32_16x16x32_bf16 v[172:175], v[20:23], v[118:121], v[52:55]
    v_cndmask_b32_e64 v25, 0, v25, vcc
    v_cndmask_b32 v30, v26, 0, vcc
    v_mfma_f32_16x16x32_bf16 v[160:163], v[16:19], v[114:117], 0
    v_cndmask_b32_e64 v26, 0, v26, vcc
    v_cndmask_b32 v31, v27, 0, vcc
    v_mfma_f32_16x16x32_bf16 v[168:171], v[16:19], v[118:121], 0
    v_cndmask_b32 v27, 0, v27, vcc
    s_nop 1
    v_mfma_f32_16x16x16_bf16 v[148:151], v[26:27], v[112:113], v[148:151]
    v_mfma_f32_16x16x16_bf16 v[156:159], v[30:31], v[112:113], v[156:159]
    v_mfma_f32_16x16x16_bf16 v[144:147], v[24:25], v[112:113], v[144:147]
    v_mfma_f32_16x16x16_bf16 v[152:155], v[28:29], v[112:113], v[152:155]
    v_mfma_f32_16x16x32_bf16 v[180:183], v[20:23], v[124:127], v[52:55]
    v_mfma_f32_16x16x32_bf16 v[188:191], v[20:23], v[128:131], v[52:55]
    v_mfma_f32_16x16x32_bf16 v[176:179], v[16:19], v[124:127], 0
    v_mfma_f32_16x16x32_bf16 v[184:187], v[16:19], v[128:131], 0
    s_nop 0
    v_rcp_f32 v150, v150
    v_mfma_f32_16x16x16_bf16 v[164:167], v[26:27], v[122:123], v[164:167]
    v_rcp_f32 v158, v158
    v_mul_f32 v148, v150, v148
    v_mul_f32_e64 v149, v150, v149
    v_mfma_f32_16x16x16_bf16 v[172:175], v[30:31], v[122:123], v[172:175]
    v_mul_f32 v144, v150, v144
    v_mul_f32 v145, v150, v145
    v_mul_f32_e64 v146, v150, v146
    v_mfma_f32_16x16x16_bf16 v[160:163], v[24:25], v[122:123], v[160:163]
    v_mul_f32 v147, v150, v147
    v_mul_f32 v156, v158, v156
    v_mul_f32_e64 v157, v158, v157
    v_mfma_f32_16x16x16_bf16 v[168:171], v[28:29], v[122:123], v[168:171]
    v_mul_f32 v152, v158, v152
    v_mul_f32 v153, v158, v153
    v_mul_f32_e64 v154, v158, v154
    v_mfma_f32_16x16x32_bf16 v[196:199], v[20:23], v[134:137], v[52:55]
    v_mul_f32_e64 v155, v158, v155
    v_cvt_pk_bf16_f32 v32, v144, v145
    v_cvt_pk_bf16_f32 v33, v146, v147
    v_mfma_f32_16x16x32_bf16 v[204:207], v[20:23], v[138:141], v[52:55]
    v_cvt_pk_bf16_f32 v34, v152, v153
    v_cvt_pk_bf16_f32 v35, v154, v155
    global_store_dwordx4 v10, v[32:35], s[20:21] sc1
    v_mfma_f32_16x16x32_bf16 v[192:195], v[16:19], v[134:137], 0
    v_cvt_pk_bf16_f32 v36, v148, v149
    v_cvt_pk_bf16_f32 v37, v156, v157
    v_cndmask_b32_e64 v48, v37, v36, vcc
    v_mfma_f32_16x16x32_bf16 v[200:203], v[16:19], v[138:141], 0
    v_add_u32 v10, 40960, v10
    v_rcp_f32_e64 v166, v166
    v_mfma_f32_16x16x16_bf16 v[180:183], v[26:27], v[132:133], v[180:183]
    v_rcp_f32 v174, v174
    v_mul_f32 v164, v166, v164
    v_mul_f32_e64 v165, v166, v165
    v_mfma_f32_16x16x16_bf16 v[188:191], v[30:31], v[132:133], v[188:191]
    v_mul_f32 v160, v166, v160
    v_mul_f32 v161, v166, v161
    v_mul_f32_e64 v162, v166, v162
    v_mfma_f32_16x16x16_bf16 v[176:179], v[24:25], v[132:133], v[176:179]
    v_mul_f32 v163, v166, v163
    v_mul_f32 v172, v174, v172
    v_mul_f32_e64 v173, v174, v173
    v_mfma_f32_16x16x16_bf16 v[184:187], v[28:29], v[132:133], v[184:187]
    v_mul_f32 v168, v174, v168
    v_mul_f32 v169, v174, v169
    v_mul_f32_e64 v170, v174, v170
    v_mfma_f32_16x16x16_bf16 v[196:199], v[26:27], v[142:143], v[196:199]
    v_mul_f32_e64 v171, v174, v171
    v_cvt_pk_bf16_f32 v40, v160, v161
    v_cvt_pk_bf16_f32 v41, v162, v163
    v_mfma_f32_16x16x16_bf16 v[204:207], v[30:31], v[142:143], v[204:207]
    v_cvt_pk_bf16_f32 v42, v168, v169
    v_cvt_pk_bf16_f32 v43, v170, v171
    global_store_dwordx4 v10, v[40:43], s[20:21] sc1
    v_mfma_f32_16x16x16_bf16 v[192:195], v[24:25], v[142:143], v[192:195]
    v_cvt_pk_bf16_f32 v44, v164, v165
    v_cvt_pk_bf16_f32 v45, v172, v173
    v_cndmask_b32_e64 v49, v45, v44, vcc
    v_mfma_f32_16x16x16_bf16 v[200:203], v[28:29], v[142:143], v[200:203]
    v_add_u32 v10, 40960, v10
    v_rcp_f32 v182, v182
    v_rcp_f32 v190, v190
    v_pk_mul_f32 v[176:177], v[176:177], v[182:183] op_sel_hi:[1,0]
    v_pk_mul_f32 v[178:179], v[178:179], v[182:183] op_sel_hi:[1,0]
    v_pk_mul_f32 v[180:181], v[180:181], v[182:183] op_sel_hi:[1,0]
    v_pk_mul_f32 v[184:185], v[184:185], v[190:191] op_sel_hi:[1,0]
    v_pk_mul_f32 v[186:187], v[186:187], v[190:191] op_sel_hi:[1,0]
    v_pk_mul_f32 v[188:189], v[188:189], v[190:191] op_sel_hi:[1,0]
    v_cvt_pk_bf16_f32 v32, v176, v177
    v_cvt_pk_bf16_f32 v33, v178, v179
    v_cvt_pk_bf16_f32 v34, v184, v185
    v_cvt_pk_bf16_f32 v35, v186, v187
    global_store_dwordx4 v10, v[32:35], s[20:21] sc1
    v_cvt_pk_bf16_f32 v36, v180, v181
    v_cvt_pk_bf16_f32 v37, v188, v189
    v_cndmask_b32_e64 v50, v37, v36, vcc
    v_add_u32 v10, 40960, v10
    v_rcp_f32 v198, v198
    v_rcp_f32 v206, v206
    v_pk_mul_f32 v[192:193], v[192:193], v[198:199] op_sel_hi:[1,0]
    v_pk_mul_f32 v[194:195], v[194:195], v[198:199] op_sel_hi:[1,0]
    v_pk_mul_f32 v[196:197], v[196:197], v[198:199] op_sel_hi:[1,0]
    v_pk_mul_f32 v[200:201], v[200:201], v[206:207] op_sel_hi:[1,0]
    v_pk_mul_f32 v[202:203], v[202:203], v[206:207] op_sel_hi:[1,0]
    v_pk_mul_f32 v[204:205], v[204:205], v[206:207] op_sel_hi:[1,0]
    v_cvt_pk_bf16_f32 v40, v192, v193
    v_cvt_pk_bf16_f32 v41, v194, v195
    v_cvt_pk_bf16_f32 v42, v200, v201
    v_cvt_pk_bf16_f32 v43, v202, v203
    global_store_dwordx4 v10, v[40:43], s[20:21] sc1
    v_cvt_pk_bf16_f32 v44, v196, v197
    v_cvt_pk_bf16_f32 v45, v204, v205
    v_cndmask_b32_e64 v51, v45, v44, vcc
    v_permlane32_swap_b32 v48, v50
    s_nop 0
    v_permlane32_swap_b32 v49, v51
    s_nop 1
    v_permlane16_swap_b32 v48, v49
    v_permlane16_swap_b32 v50, v51
    global_store_dwordx4 v11, v[48:51], s[20:21] offset:1024 sc1
    s_mov_b64 exec, 15
    global_atomic_add v12, v13, s[20:21] sc1
    s_mov_b64 exec, -1
    v_lshlrev_b32 v13, 4, v13
    s_mov_b64 exec, 1
    global_atomic_add v233, v232, v239, s[20:21] sc0 sc1
    s_mov_b64 exec, -1
    ds_write_b32 v241, v239
    s_waitcnt lgkmcnt(0)
    s_barrier
    s_waitcnt vmcnt(0)
    s_setprio 0
    s_mov_b32 s27, 0
L_hold_37:
    ds_read_b32 v20, v241
    s_waitcnt lgkmcnt(0)
    v_cmp_eq_u32 vcc, 0, v20
    s_nop 0
    s_cbranch_vccz L_held_38
    s_sleep 2
    s_add_u32 s27, s27, 1
    s_cmp_lt_u32 s27, 0x40000
    s_cbranch_scc1 L_hold_37
L_held_38:
    v_readfirstlane_b32 s45, v233
    s_nop 0
    s_cmp_eq_u32 s45, 10
    s_cbranch_scc1 L_flgo_39
L_floader:
    global_load_dword v240, v238, s[20:21] sc1
    s_branch L_over_kv_1
L_warm_kv_1:
    s_branch L_warm_kv_2
L_over_kv_1:
    s_mov_b64 exec, 1
    s_mov_b32 s27, 0
L_poll_40:
    global_atomic_add v233, v232, v239, s[20:21] sc0 sc1
    s_waitcnt vmcnt(0)
    v_cmp_ne_u32_e64 vcc, 10, v233
    s_nop 0
    s_cbranch_vccz L_polled_41
    s_sleep 8
    s_add_u32 s27, s27, 1
    s_cmp_lt_u32 s27, 262144
    s_cbranch_scc1 L_poll_40
L_polled_41:
    s_mov_b64 exec, -1
L_flgo_39:
    s_add_u32 m0, s37, 0
    s_nop 0
    buffer_load_dwordx4 v234, s[32:35], s36 offen sc1 lds
    s_add_u32 s36, s36, 1024
    s_add_u32 m0, s37, 1024
    s_nop 0
    buffer_load_dwordx4 v234, s[32:35], s36 offen sc1 lds
    s_add_u32 s36, s36, 1024
    s_add_u32 m0, s37, 2048
    s_mov_b32 exec_hi, 0
    buffer_load_dwordx4 v234, s[32:35], s36 offen sc1 lds
    s_mov_b32 exec_hi, -1
    v_cmp_eq_u32_e64 vcc, 0, v240
    s_nop 0
    s_cbranch_vccz L_gate_42
    s_mov_b32 s27, 0
L_poll_43:
    global_load_dword v240, v238, s[20:21] sc1
    s_waitcnt vmcnt(0)
    v_cmp_eq_u32_e64 vcc, 0, v240
    s_nop 0
    s_cbranch_vccz L_polled_44
    s_add_u32 s27, s27, 1
    s_cmp_lt_u32 s27, 262144
    s_cbranch_scc1 L_poll_43
L_polled_44:
L_gate_42:
    s_waitcnt vmcnt(0)
    v_rcp_f32_e64 v20, v240
    s_mov_b32 s45, 0xffff0000
    v_sub_f32_e64 v21, 1.0, v20
    ds_read_b64_tr_b16 v[24:25], v235 offset:0
    ds_read_b64_tr_b16 v[26:27], v235 offset:512
    ds_read_b64_tr_b16 v[28:29], v235 offset:1024
    ds_read_b64_tr_b16 v[30:31], v235 offset:1536
    ds_read_b64_tr_b16 v[32:33], v235 offset:2048
    s_waitcnt lgkmcnt(4)
    v_lshlrev_b32 v36, 16, v24
    v_and_b32 v37, s45, v24
    v_mul_f32 v36, v20, v36
    v_mul_f32 v37, v20, v37
    v_lshlrev_b32 v38, 16, v25
    v_and_b32 v39, s45, v25
    v_mul_f32 v38, v20, v38
    v_mul_f32_e64 v39, v20, v39
    ds_write_b128 v236, v[36:39] offset:0
    s_waitcnt lgkmcnt(4)
    v_lshlrev_b32 v40, 16, v26
    v_and_b32 v41, s45, v26
    v_mul_f32 v40, v20, v40
    v_mul_f32 v41, v20, v41
    v_lshlrev_b32 v42, 16, v27
    v_and_b32 v43, s45, v27
    v_mul_f32 v42, v20, v42
    v_mul_f32_e64 v43, v20, v43
    ds_write_b128 v236, v[40:43] offset:1024
    s_waitcnt lgkmcnt(4)
    v_lshlrev_b32 v44, 16, v28
    v_and_b32 v45, s45, v28
    v_mul_f32 v44, v20, v44
    v_mul_f32 v45, v20, v45
    v_lshlrev_b32 v46, 16, v29
    v_and_b32 v47, s45, v29
    v_mul_f32 v46, v20, v46
    v_mul_f32_e64 v47, v20, v47
    ds_write_b128 v236, v[44:47] offset:2048
    s_waitcnt lgkmcnt(4)
    v_lshlrev_b32 v48, 16, v30
    v_and_b32 v49, s45, v30
    v_mul_f32 v48, v20, v48
    v_mul_f32 v49, v20, v49
    v_lshlrev_b32 v50, 16, v31
    v_and_b32 v51, s45, v31
    v_mul_f32 v50, v20, v50
    v_mul_f32_e64 v51, v20, v51
    ds_write_b128 v236, v[48:51] offset:3072
    s_waitcnt lgkmcnt(4)
    v_lshlrev_b32 v52, 16, v32
    v_and_b32 v53, s45, v32
    v_mul_f32 v52, v20, v52
    v_mul_f32 v53, v20, v53
    v_lshlrev_b32 v54, 16, v33
    v_and_b32 v55, s45, v33
    v_mul_f32 v54, v20, v54
    v_mul_f32_e64 v55, v20, v55
    ds_write_b128 v236, v[52:55] offset:4096
    ds_write_b32 v237, v21
    s_cmp_ge_u32 s23, 16
    s_cbranch_scc1 L_dr_45
    s_mov_b64 exec, 15
    global_atomic_add v12, v13, s[20:21] sc1
    s_mov_b64 exec, -1
L_dr_45:
    s_waitcnt lgkmcnt(0)
    s_barrier
L_end:
    s_endpgm
L_kvc:
    s_load_dwordx16 s[4:19], s[0:1], 0
    s_load_dwordx8 s[56:63], s[0:1], 64
    s_load_dwordx4 s[64:67], s[0:1], 96
    s_load_dwordx2 s[20:21], s[0:1], 112
    s_lshr_b32 s24, s24, 6
    s_and_b32 s22, s2, 7
    s_lshr_b32 s23, s2, 3
    s_and_b32 s26, s24, 3
    s_getreg_b32 s72, hwreg(HW_REG_XCC_ID, 0, 4)
    s_or_b32 s72, s72, 0x80
    s_mul_i32 s72, s72, 0x01010101
    s_lshl_b32 s69, s22, 2
    s_lshr_b32 s73, s23, 3
    s_add_u32 s69, s69, s73
    s_and_b32 s70, s23, 7
    s_add_u32 s73, s23, 1
    s_and_b32 s73, s73, 3
    s_mul_i32 s73, s73, 10240
    s_add_u32 s71, s73, 102400
    v_and_b32 v1, 63, v0
    v_and_b32 v2, 15, v0
    v_bfe_u32 v3, v0, 4, 2
    s_cmp_lg_u32 s24, 0
    s_cbranch_scc1 L_clr_46
    s_lshl_b32 s40, s22, 9
    s_lshl_b32 s41, s23, 2
    s_add_u32 s40, s40, s41
    s_add_u32 s40, s40, 16318464
    v_and_b32 v16, 3, v1
    v_lshl_add_u32 v16, v16, 6, s40
    v_lshrrev_b32 v17, 2, v1
    v_mul_u32_u24 v17, 0, v17
    v_add_u32 v16, v16, v17
    s_lshl_b32 s40, s2, 7
    s_add_u32 s41, s40, 16449536
    s_add_u32 s40, s40, 16384000
    v_writelane_b32 v16, s41, 16
    v_writelane_b32 v16, s40, 17
    v_mov_b32 v17, 0
    s_waitcnt lgkmcnt(0)
    s_mov_b64 exec, 0x3000f
    global_store_dword v16, v17, s[20:21] sc1
    s_mov_b64 exec, -1
L_clr_46:
    s_waitcnt lgkmcnt(0)
    s_mov_b32 s36, s58
    s_and_b32 s37, s59, 0xffff
    s_mov_b32 s38, 25600
    s_mov_b32 s39, 0x20000
    s_lshl_b32 s47, s24, 10
    s_mul_i32 s45, s22, 3200
    s_add_u32 s45, s45, s47
    v_lshlrev_b32 v20, 4, v1
    buffer_load_dwordx4 v[24:27], v20, s[36:39], s45 offen
    s_add_u32 s47, s47, 147456
    v_add_u32 v20, s47, v20
    v_lshrrev_b32 v16, 1, v2
    v_xor_b32 v16, v16, v3
    v_lshlrev_b32 v16, 4, v16
    v_lshl_add_u32 v16, v2, 7, v16
    s_lshl_b32 s40, s24, 12
    v_add_u32 v4, s40, v16
    v_xor_b32 v5, 64, v4
    v_lshrrev_b32 v16, 2, v2
    v_lshl_add_u32 v16, v3, 3, v16
    v_mul_u32_u24 v16, 320, v16
    v_and_b32_e64 v17, 1, v3
    v_mul_u32_u24 v17, 160, v17
    v_and_b32 v18, 3, v2
    v_mul_u32_u24 v19, 40, v18
    v_add_u32 v16, 65536, v16
    v_add3_u32 v6, v16, v17, v19
    v_sub_u32_e64 v16, v16, v17
    v_add_u32 v16, 160, v16
    v_lshl_add_u32 v8, v18, 3, v16
    v_add3_u32 v10, v16, v19, 32
    v_add_u32 v7, 61440, v6
    v_add_u32 v9, 61440, v8
    v_add_u32 v11, 61440, v10
    v_lshrrev_b32 v16, 2, v2
    v_mul_u32_u24 v16, 40, v16
    v_mul_u32_u24 v17, 800, v3
    s_mov_b32 s41, 147456
    v_add3_u32 v16, v16, v17, s41
    v_mov_b32 v17, 151552
    v_cmp_eq_u32 vcc, v18, v3
    s_nop 1
    v_cndmask_b32_e64 v12, v17, v16, vcc
    s_mul_i32 s41, s24, 5120
    s_add_u32 s41, s41, 143360
    v_lshl_add_u32 v212, v1, 4, s41
    v_mul_u32_u24 v14, 10240, v3
    v_add_u32 v14, 102400, v14
    s_lshl_b32 s41, s24, 5
    v_add_u32 v15, s41, v2
    v_lshl_add_u32 v221, v15, 4, v14
    v_lshl_add_u32 v14, v15, 5, v14
    v_and_b32_e64 v15, 4, v2
    v_lshl_add_u32 v213, v15, 2, v14
    v_xor_b32_e64 v220, 16, v213
    s_mul_i32 s41, s24, 10240
    s_add_u32 s41, s41, 102400
    v_lshlrev_b32 v16, 3, v1
    v_and_b32 v17, 16, v1
    v_xor_b32 v16, v16, v17
    v_add_u32 v214, s41, v16
    v_lshrrev_b32 v16, 2, v1
    v_lshlrev_b32 v16, 4, v16
    v_and_b32_e64 v17, 1, v2
    v_lshl_add_u32 v16, v17, 3, v16
    v_add_u32 v215, s41, v16
    s_lshl_b32 s41, s24, 10
    s_add_u32 s41, s41, 143360
    v_lshl_add_u32 v216, v1, 4, s41
    v_bfe_u32 v16, v2, 2, 1
    v_and_b32_e64 v17, 1, v2
    v_lshl_add_u32 v16, v16, 1, v17
    v_lshl_add_u32 v16, v3, 4, v16
    s_lshl_b32 s41, s24, 6
    s_add_u32 s41, s41, 147456
    v_lshl_add_u32 v217, v16, 4, s41
    v_and_b32 v17, 2, v2
    v_cmp_eq_u32 s[48:49], 0, v17
    v_lshlrev_b32 v19, 4, v1
    s_lshl_b32 s44, s22, 2
    s_add_u32 s44, s44, s24
    s_lshl_b32 s44, s44, 4
    s_add_u32 s44, s44, s23
    s_lshl_b32 s44, s44, 11
    s_add_u32 s44, s44, 8388608
    v_add_u32_e64 v218, s44, v19
    v_lshl_add_u32 v16, v3, 3, v2
    v_lshl_add_u32 v219, v16, 4, s44
    v_and_b32 v16, 1, v2
    v_lshlrev_b32_e64 v16, 4, v16
    s_movk_i32 s41, 0x3f80
    v_lshlrev_b32 v16, v16, s41
    v_lshrrev_b32 v17, 1, v2
    v_cmp_eq_u32 vcc, 0, v17
    s_nop 1
    v_cndmask_b32 v152, 0, v16, vcc
    v_cmp_eq_u32 vcc, 1, v17
    s_nop 1
    v_cndmask_b32 v153, 0, v16, vcc
    v_cmp_eq_u32 vcc, 2, v17
    s_nop 1
    v_cndmask_b32 v154, 0, v16, vcc
    v_cmp_eq_u32 vcc, 3, v17
    s_nop 1
    v_cndmask_b32 v155, 0, v16, vcc
    v_cmp_eq_u32 vcc, 4, v17
    s_nop 1
    v_cndmask_b32 v156, 0, v16, vcc
    v_cmp_eq_u32 vcc, 5, v17
    s_nop 1
    v_cndmask_b32 v157, 0, v16, vcc
    v_cmp_eq_u32 vcc, 6, v17
    s_nop 1
    v_cndmask_b32 v158, 0, v16, vcc
    v_cmp_eq_u32 vcc, 7, v17
    s_nop 1
    v_cndmask_b32 v159, 0, v16, vcc
    s_lshl_b32 s40, s22, 9
    s_add_u32 s40, s40, 16318464
    s_lshl_b32 s41, s24, 4
    s_add_u32 s41, s41, s23
    s_lshl_b32 s41, s41, 2
    s_add_u32 s41, s41, s40
    v_mul_u32_u24 v222, 0, v1
    v_add_u32_e64 v222, s41, v222
    s_and_b32 s50, s23, 3
    s_lshl_b32 s41, s50, 6
    s_add_u32 s41, s41, s40
    s_mul_i32 s40, s24, 0
    s_add_u32 s41, s41, s40
    v_lshl_add_u32 v223, v2, 2, s41
    s_lshl_b32 s41, s22, 2
    s_add_u32 s41, s41, s50
    s_lshl_b32 s41, s41, 15
    s_lshl_b32 s40, s24, 9
    s_add_u32 s41, s41, s40
    s_add_u32 s41, s41, 8388608
    v_lshlrev_b32 v16, 11, v3
    v_lshl_add_u32 v16, v2, 4, v16
    v_add_u32_e64 v224, s41, v16
    s_mul_i32 s41, s50, 10240
    s_add_u32 s41, s41, s40
    s_add_u32 s41, s41, 102400
    v_lshrrev_b32 v16, 1, v3
    v_lshl_add_u32 v16, v16, 4, v2
    v_and_b32_e64 v17, 1, v3
    v_lshl_add_u32 v16, v16, 1, v17
    v_lshl_add_u32 v225, v16, 3, s41
    v_mov_b32 v226, 152576
    s_waitcnt lgkmcnt(0)
    s_cmp_eq_u32 s24, 1
    s_cbranch_scc1 L_warm_kv
L_warmed_kv:
    s_barrier
    ds_read_b128 v[232:235], v4 offset:32768
    ds_read_b128 v[240:243], v5 offset:32768
    ds_read_b64_tr_b16 v[128:129], v6 offset:40960
    ds_read_b64_tr_b16 v[130:131], v6 offset:42240
    ds_read_b64_tr_b16 v[132:133], v6 offset:51200
    ds_read_b64_tr_b16 v[134:135], v6 offset:52480
    ds_read_b128 v[244:247], v5 offset:34816
    ds_read_b128 v[236:239], v4 offset:34816
    ds_read_b64_tr_b16 v[136:137], v6 offset:40968
    ds_read_b64_tr_b16 v[138:139], v6 offset:42248
    ds_read_b64_tr_b16 v[140:141], v6 offset:51208
    ds_read_b64_tr_b16 v[142:143], v6 offset:52488
    s_waitcnt lgkmcnt(8)
    v_mfma_f32_16x16x32_bf16 v[32:35], v[128:131], v[232:235], 0
    ds_read_b64_tr_b16 v[144:145], v6 offset:40976
    s_waitcnt lgkmcnt(7)
    v_mfma_f32_16x16x32_bf16 v[32:35], v[132:135], v[240:243], v[32:35]
    ds_read_b64_tr_b16 v[146:147], v6 offset:42256
    s_waitcnt lgkmcnt(7)
    v_mfma_f32_16x16x32_bf16 v[52:55], v[132:135], v[244:247], 0
    ds_read_b64_tr_b16 v[148:149], v6 offset:51216
    s_waitcnt lgkmcnt(7)
    v_mfma_f32_16x16x32_bf16 v[52:55], v[128:131], v[236:239], v[52:55]
    ds_read_b64_tr_b16 v[150:151], v6 offset:52496
    s_waitcnt lgkmcnt(6)
    v_mfma_f32_16x16x32_bf16 v[36:39], v[136:139], v[232:235], 0
    ds_read_b64_tr_b16 v[128:129], v6 offset:40984
    s_mov_b32 s45, 0x3fb8aa3b
    s_waitcnt lgkmcnt(5)
    v_mfma_f32_16x16x32_bf16 v[36:39], v[140:143], v[240:243], v[36:39]
    ds_read_b64_tr_b16 v[130:131], v6 offset:42264
    s_waitcnt vmcnt(0)
    v_lshlrev_b32 v21, 16, v24
    v_mfma_f32_16x16x32_bf16 v[56:59], v[140:143], v[244:247], 0
    ds_read_b64_tr_b16 v[132:133], v6 offset:51224
    v_and_b32 v22, 0xffff0000, v24
    v_mfma_f32_16x16x32_bf16 v[56:59], v[136:139], v[236:239], v[56:59]
    ds_read_b64_tr_b16 v[134:135], v6 offset:52504
    v_mul_f32 v21, s45, v21
    s_waitcnt lgkmcnt(6)
    v_mfma_f32_16x16x32_bf16 v[40:43], v[144:147], v[232:235], 0
    ds_read_b64_tr_b16 v[136:137], v6 offset:40992
    v_mul_f32 v22, s45, v22
    s_waitcnt lgkmcnt(5)
    v_mfma_f32_16x16x32_bf16 v[40:43], v[148:151], v[240:243], v[40:43]
    ds_read_b64_tr_b16 v[138:139], v6 offset:42272
    v_cvt_pk_bf16_f32 v24, v21, v22
    v_mfma_f32_16x16x32_bf16 v[60:63], v[148:151], v[244:247], 0
    ds_read_b64_tr_b16 v[140:141], v6 offset:51232
    v_lshlrev_b32_e64 v21, 16, v25
    v_mfma_f32_16x16x32_bf16 v[60:63], v[144:147], v[236:239], v[60:63]
    ds_read_b64_tr_b16 v[142:143], v6 offset:52512
    v_and_b32 v22, 0xffff0000, v25
    s_waitcnt lgkmcnt(6)
    v_mfma_f32_16x16x32_bf16 v[44:47], v[128:131], v[232:235], 0
    ds_read_b64_tr_b16 v[144:145], v8 offset:40960
    v_mul_f32_e64 v21, s45, v21
    s_waitcnt lgkmcnt(5)
    v_mfma_f32_16x16x32_bf16 v[44:47], v[132:135], v[240:243], v[44:47]
    ds_read_b64_tr_b16 v[146:147], v8 offset:42240
    v_mul_f32_e64 v22, s45, v22
    v_mfma_f32_16x16x32_bf16 v[64:67], v[132:135], v[244:247], 0
    ds_read_b64_tr_b16 v[148:149], v8 offset:51200
    v_cvt_pk_bf16_f32 v25, v21, v22
    v_mfma_f32_16x16x32_bf16 v[64:67], v[128:131], v[236:239], v[64:67]
    ds_read_b64_tr_b16 v[150:151], v8 offset:52480
    v_lshlrev_b32 v21, 16, v26
    s_waitcnt lgkmcnt(6)
    v_mfma_f32_16x16x32_bf16 v[48:51], v[136:139], v[232:235], 0
    ds_read_b64_tr_b16 v[128:129], v8 offset:41000
    v_and_b32 v22, 0xffff0000, v26
    s_waitcnt lgkmcnt(5)
    v_mfma_f32_16x16x32_bf16 v[48:51], v[140:143], v[240:243], v[48:51]
    ds_read_b64_tr_b16 v[130:131], v8 offset:42280
    v_mul_f32 v21, s45, v21
    v_mfma_f32_16x16x32_bf16 v[68:71], v[140:143], v[244:247], 0
    ds_read_b64_tr_b16 v[132:133], v8 offset:51240
    v_mul_f32_e64 v22, s45, v22
    v_mfma_f32_16x16x32_bf16 v[68:71], v[136:139], v[236:239], v[68:71]
    ds_read_b64_tr_b16 v[134:135], v8 offset:52520
    v_cvt_pk_bf16_f32 v26, v21, v22
    s_waitcnt lgkmcnt(6)
    v_mfma_f32_16x16x32_bf16 v[72:75], v[232:235], v[144:147], 0
    ds_read_b64_tr_b16 v[136:137], v8 offset:41040
    v_lshlrev_b32_e64 v21, 16, v27
    s_waitcnt lgkmcnt(5)
    v_mfma_f32_16x16x32_bf16 v[72:75], v[240:243], v[148:151], v[72:75]
    ds_read_b64_tr_b16 v[138:139], v8 offset:42320
    v_and_b32 v22, 0xffff0000, v27
    v_mfma_f32_16x16x32_bf16 v[92:95], v[244:247], v[148:151], 0
    ds_read_b64_tr_b16 v[140:141], v8 offset:51280
    v_mul_f32_e64 v21, s45, v21
    v_mfma_f32_16x16x32_bf16 v[92:95], v[236:239], v[144:147], v[92:95]
    ds_read_b64_tr_b16 v[142:143], v8 offset:52560
    v_mul_f32 v22, s45, v22
    s_waitcnt lgkmcnt(6)
    v_mfma_f32_16x16x32_bf16 v[76:79], v[232:235], v[128:131], 0
    ds_read_b64_tr_b16 v[144:145], v8 offset:41080
    v_cvt_pk_bf16_f32 v27, v21, v22
    s_waitcnt lgkmcnt(5)
    v_mfma_f32_16x16x32_bf16 v[76:79], v[240:243], v[132:135], v[76:79]
    ds_read_b64_tr_b16 v[146:147], v8 offset:42360
    ds_write_b128 v20, v[24:27]
    v_mfma_f32_16x16x32_bf16 v[96:99], v[244:247], v[132:135], 0
    ds_read_b64_tr_b16 v[148:149], v8 offset:51320
    v_mfma_f32_16x16x32_bf16 v[96:99], v[236:239], v[128:131], v[96:99]
    ds_read_b64_tr_b16 v[150:151], v8 offset:52600
    s_waitcnt lgkmcnt(7)
    v_mfma_f32_16x16x32_bf16 v[80:83], v[232:235], v[136:139], 0
    ds_read_b64_tr_b16 v[128:129], v10 offset:40960
    s_waitcnt lgkmcnt(6)
    v_mfma_f32_16x16x32_bf16 v[80:83], v[240:243], v[140:143], v[80:83]
    ds_read_b64_tr_b16 v[130:131], v10 offset:42240
    v_mfma_f32_16x16x32_bf16 v[100:103], v[244:247], v[140:143], 0
    ds_read_b64_tr_b16 v[132:133], v10 offset:51200
    v_mfma_f32_16x16x32_bf16 v[100:103], v[236:239], v[136:139], v[100:103]
    ds_read_b64_tr_b16 v[134:135], v10 offset:52480
    s_waitcnt lgkmcnt(7)
    v_mfma_f32_16x16x32_bf16 v[84:87], v[232:235], v[144:147], 0
    s_waitcnt vmcnt(0)
    s_barrier
    ds_read_b128 v[112:115], v4 offset:49152
    ds_read_b128 v[120:123], v5 offset:49152
    ds_read_b64_tr_b16 v[136:137], v7 offset:0
    s_waitcnt lgkmcnt(7)
    v_mfma_f32_16x16x32_bf16 v[84:87], v[240:243], v[148:151], v[84:87]
    s_nop 0
    ds_read_b64_tr_b16 v[138:139], v7 offset:1280
    v_mfma_f32_16x16x32_bf16 v[104:107], v[244:247], v[148:151], 0
    ds_read_b128 v[124:127], v5 offset:51200
    ds_read_b128 v[116:119], v4 offset:51200
    ds_read_b64_tr_b16 v[140:141], v7 offset:10240
    v_mfma_f32_16x16x32_bf16 v[104:107], v[236:239], v[144:147], v[104:107]
    ds_read_b64_tr_b16 v[142:143], v7 offset:11520
    s_waitcnt lgkmcnt(10)
    v_mfma_f32_16x16x32_bf16 v[88:91], v[232:235], v[128:131], 0
    ds_read_b64_tr_b16 v[144:145], v7 offset:8
    s_waitcnt lgkmcnt(9)
    v_mfma_f32_16x16x32_bf16 v[88:91], v[240:243], v[132:135], v[88:91]
    ds_read_b64_tr_b16 v[146:147], v7 offset:1288
    v_mfma_f32_16x16x32_bf16 v[108:111], v[244:247], v[132:135], 0
    ds_read_b64_tr_b16 v[148:149], v7 offset:10248
    v_mfma_f32_16x16x32_bf16 v[108:111], v[236:239], v[128:131], v[108:111]
    ds_read_b64_tr_b16 v[150:151], v7 offset:11528
    s_waitcnt lgkmcnt(8)
    v_mfma_f32_16x16x32_bf16 v[32:35], v[136:139], v[112:115], v[32:35]
    ds_read_b64_tr_b16 v[128:129], v7 offset:16
    s_waitcnt lgkmcnt(5)
    v_mfma_f32_16x16x32_bf16 v[32:35], v[140:143], v[120:123], v[32:35]
    ds_read_b64_tr_b16 v[130:131], v7 offset:1296
    v_mfma_f32_16x16x32_bf16 v[52:55], v[140:143], v[124:127], v[52:55]
    ds_read_b64_tr_b16 v[132:133], v7 offset:10256
    v_mfma_f32_16x16x32_bf16 v[52:55], v[136:139], v[116:119], v[52:55]
    ds_read_b64_tr_b16 v[134:135], v7 offset:11536
    s_waitcnt lgkmcnt(6)
    v_mfma_f32_16x16x32_bf16 v[36:39], v[144:147], v[112:115], v[36:39]
    ds_read_b64_tr_b16 v[136:137], v7 offset:24
    s_waitcnt lgkmcnt(5)
    v_mfma_f32_16x16x32_bf16 v[36:39], v[148:151], v[120:123], v[36:39]
    ds_read_b64_tr_b16 v[138:139], v7 offset:1304
    v_mfma_f32_16x16x32_bf16 v[56:59], v[148:151], v[124:127], v[56:59]
    ds_read_b64_tr_b16 v[140:141], v7 offset:10264
    v_mfma_f32_16x16x32_bf16 v[56:59], v[144:147], v[116:119], v[56:59]
    ds_read_b64_tr_b16 v[142:143], v7 offset:11544
    s_waitcnt lgkmcnt(6)
    v_mfma_f32_16x16x32_bf16 v[40:43], v[128:131], v[112:115], v[40:43]
    ds_read_b64_tr_b16 v[144:145], v7 offset:32
    s_waitcnt lgkmcnt(5)
    v_mfma_f32_16x16x32_bf16 v[40:43], v[132:135], v[120:123], v[40:43]
    ds_read_b64_tr_b16 v[146:147], v7 offset:1312
    v_mfma_f32_16x16x32_bf16 v[60:63], v[132:135], v[124:127], v[60:63]
    ds_read_b64_tr_b16 v[148:149], v7 offset:10272
    v_mfma_f32_16x16x32_bf16 v[60:63], v[128:131], v[116:119], v[60:63]
    ds_read_b64_tr_b16 v[150:151], v7 offset:11552
    s_waitcnt lgkmcnt(6)
    v_mfma_f32_16x16x32_bf16 v[44:47], v[136:139], v[112:115], v[44:47]
    ds_read_b64_tr_b16 v[128:129], v9 offset:0
    s_waitcnt lgkmcnt(5)
    v_mfma_f32_16x16x32_bf16 v[44:47], v[140:143], v[120:123], v[44:47]
    ds_read_b64_tr_b16 v[130:131], v9 offset:1280
    v_mfma_f32_16x16x32_bf16 v[64:67], v[140:143], v[124:127], v[64:67]
    ds_read_b64_tr_b16 v[132:133], v9 offset:10240
    v_mfma_f32_16x16x32_bf16 v[64:67], v[136:139], v[116:119], v[64:67]
    ds_read_b64_tr_b16 v[134:135], v9 offset:11520
    s_waitcnt lgkmcnt(6)
    v_mfma_f32_16x16x32_bf16 v[48:51], v[144:147], v[112:115], v[48:51]
    ds_read_b64_tr_b16 v[136:137], v9 offset:40
    s_waitcnt lgkmcnt(5)
    v_mfma_f32_16x16x32_bf16 v[48:51], v[148:151], v[120:123], v[48:51]
    ds_read_b64_tr_b16 v[138:139], v9 offset:1320
    v_mfma_f32_16x16x32_bf16 v[68:71], v[148:151], v[124:127], v[68:71]
    ds_read_b64_tr_b16 v[140:141], v9 offset:10280
    v_mfma_f32_16x16x32_bf16 v[68:71], v[144:147], v[116:119], v[68:71]
    ds_read_b64_tr_b16 v[142:143], v9 offset:11560
    s_waitcnt lgkmcnt(6)
    v_mfma_f32_16x16x32_bf16 v[72:75], v[112:115], v[128:131], v[72:75]
    ds_read_b64_tr_b16 v[144:145], v9 offset:80
    s_waitcnt lgkmcnt(5)
    v_mfma_f32_16x16x32_bf16 v[72:75], v[120:123], v[132:135], v[72:75]
    ds_read_b64_tr_b16 v[146:147], v9 offset:1360
    v_mfma_f32_16x16x32_bf16 v[92:95], v[124:127], v[132:135], v[92:95]
    ds_read_b64_tr_b16 v[148:149], v9 offset:10320
    v_mfma_f32_16x16x32_bf16 v[92:95], v[116:119], v[128:131], v[92:95]
    ds_read_b64_tr_b16 v[150:151], v9 offset:11600
    s_waitcnt lgkmcnt(6)
    v_mfma_f32_16x16x32_bf16 v[76:79], v[112:115], v[136:139], v[76:79]
    ds_read_b64_tr_b16 v[128:129], v9 offset:120
    s_waitcnt lgkmcnt(5)
    v_mfma_f32_16x16x32_bf16 v[76:79], v[120:123], v[140:143], v[76:79]
    ds_read_b64_tr_b16 v[130:131], v9 offset:1400
    v_mfma_f32_16x16x32_bf16 v[96:99], v[124:127], v[140:143], v[96:99]
    ds_read_b64_tr_b16 v[132:133], v9 offset:10360
    v_mfma_f32_16x16x32_bf16 v[96:99], v[116:119], v[136:139], v[96:99]
    ds_read_b64_tr_b16 v[134:135], v9 offset:11640
    s_waitcnt lgkmcnt(6)
    v_mfma_f32_16x16x32_bf16 v[80:83], v[112:115], v[144:147], v[80:83]
    ds_read_b64_tr_b16 v[136:137], v11 offset:0
    s_waitcnt lgkmcnt(5)
    v_mfma_f32_16x16x32_bf16 v[80:83], v[120:123], v[148:151], v[80:83]
    ds_read_b64_tr_b16 v[138:139], v11 offset:1280
    v_mfma_f32_16x16x32_bf16 v[100:103], v[124:127], v[148:151], v[100:103]
    ds_read_b64_tr_b16 v[140:141], v11 offset:10240
    v_mfma_f32_16x16x32_bf16 v[100:103], v[116:119], v[144:147], v[100:103]
    ds_read_b64_tr_b16 v[142:143], v11 offset:11520
    s_waitcnt lgkmcnt(6)
    v_mfma_f32_16x16x32_bf16 v[84:87], v[112:115], v[128:131], v[84:87]
    s_barrier
    ds_read_b128 v[232:235], v4 offset:0
    ds_read_b128 v[240:243], v5 offset:0
    ds_read_b64_tr_b16 v[144:145], v6 offset:0
    s_waitcnt lgkmcnt(7)
    v_mfma_f32_16x16x32_bf16 v[84:87], v[120:123], v[132:135], v[84:87]
    s_nop 0
    ds_read_b64_tr_b16 v[146:147], v6 offset:1280
    v_mfma_f32_16x16x32_bf16 v[104:107], v[124:127], v[132:135], v[104:107]
    ds_read_b128 v[244:247], v5 offset:2048
    ds_read_b128 v[236:239], v4 offset:2048
    ds_read_b64_tr_b16 v[148:149], v6 offset:10240
    v_mfma_f32_16x16x32_bf16 v[104:107], v[116:119], v[128:131], v[104:107]
    ds_read_b64_tr_b16 v[150:151], v6 offset:11520
    s_waitcnt lgkmcnt(10)
    v_mfma_f32_16x16x32_bf16 v[88:91], v[112:115], v[136:139], v[88:91]
    ds_read_b64_tr_b16 v[128:129], v6 offset:8
    s_waitcnt lgkmcnt(9)
    v_mfma_f32_16x16x32_bf16 v[88:91], v[120:123], v[140:143], v[88:91]
    ds_read_b64_tr_b16 v[130:131], v6 offset:1288
    v_mfma_f32_16x16x32_bf16 v[108:111], v[124:127], v[140:143], v[108:111]
    ds_read_b64_tr_b16 v[132:133], v6 offset:10248
    v_mfma_f32_16x16x32_bf16 v[108:111], v[116:119], v[136:139], v[108:111]
    ds_read_b64_tr_b16 v[134:135], v6 offset:11528
    s_waitcnt lgkmcnt(8)
    v_mfma_f32_16x16x32_bf16 v[32:35], v[144:147], v[232:235], v[32:35]
    ds_read_b64_tr_b16 v[136:137], v6 offset:16
    s_waitcnt lgkmcnt(5)
    v_mfma_f32_16x16x32_bf16 v[32:35], v[148:151], v[240:243], v[32:35]
    ds_read_b64_tr_b16 v[138:139], v6 offset:1296
    v_mfma_f32_16x16x32_bf16 v[52:55], v[148:151], v[244:247], v[52:55]
    ds_read_b64_tr_b16 v[160:161], v12 offset:0
    ds_read_b64_tr_b16 v[140:141], v6 offset:10256
    v_mfma_f32_16x16x32_bf16 v[52:55], v[144:147], v[236:239], v[52:55]
    ds_read_b64_tr_b16 v[142:143], v6 offset:11536
    s_waitcnt lgkmcnt(7)
    v_mfma_f32_16x16x32_bf16 v[36:39], v[128:131], v[232:235], v[36:39]
    ds_read_b64_tr_b16 v[144:145], v6 offset:24
    s_waitcnt lgkmcnt(6)
    v_mfma_f32_16x16x32_bf16 v[36:39], v[132:135], v[240:243], v[36:39]
    ds_read_b64_tr_b16 v[146:147], v6 offset:1304
    v_mfma_f32_16x16x32_bf16 v[56:59], v[132:135], v[244:247], v[56:59]
    ds_read_b64_tr_b16 v[148:149], v6 offset:10264
    v_mfma_f32_16x16x32_bf16 v[56:59], v[128:131], v[236:239], v[56:59]
    ds_read_b64_tr_b16 v[150:151], v6 offset:11544
    s_waitcnt lgkmcnt(7)
    v_mfma_f32_16x16x32_bf16 v[40:43], v[136:139], v[232:235], v[40:43]
    ds_read_b64_tr_b16 v[128:129], v6 offset:32
    s_waitcnt lgkmcnt(5)
    v_mfma_f32_16x16x32_bf16 v[40:43], v[140:143], v[240:243], v[40:43]
    ds_read_b64_tr_b16 v[130:131], v6 offset:1312
    v_mfma_f32_16x16x32_bf16 v[60:63], v[140:143], v[244:247], v[60:63]
    ds_read_b64_tr_b16 v[162:163], v12 offset:160
    ds_read_b64_tr_b16 v[132:133], v6 offset:10272
    v_mfma_f32_16x16x32_bf16 v[60:63], v[136:139], v[236:239], v[60:63]
    ds_read_b64_tr_b16 v[134:135], v6 offset:11552
    s_waitcnt lgkmcnt(7)
    v_mfma_f32_16x16x32_bf16 v[44:47], v[144:147], v[232:235], v[44:47]
    ds_read_b64_tr_b16 v[136:137], v8 offset:0
    s_waitcnt lgkmcnt(6)
    v_mfma_f32_16x16x32_bf16 v[44:47], v[148:151], v[240:243], v[44:47]
    ds_read_b64_tr_b16 v[138:139], v8 offset:1280
    v_mfma_f32_16x16x32_bf16 v[64:67], v[148:151], v[244:247], v[64:67]
    ds_read_b64_tr_b16 v[140:141], v8 offset:10240
    v_mfma_f32_16x16x32_bf16 v[64:67], v[144:147], v[236:239], v[64:67]
    ds_read_b64_tr_b16 v[142:143], v8 offset:11520
    s_waitcnt lgkmcnt(7)
    v_mfma_f32_16x16x32_bf16 v[48:51], v[128:131], v[232:235], v[48:51]
    ds_read_b64_tr_b16 v[144:145], v8 offset:40
    s_waitcnt lgkmcnt(5)
    v_mfma_f32_16x16x32_bf16 v[48:51], v[132:135], v[240:243], v[48:51]
    ds_read_b64_tr_b16 v[146:147], v8 offset:1320
    v_mfma_f32_16x16x32_bf16 v[68:71], v[132:135], v[244:247], v[68:71]
    ds_read_b64_tr_b16 v[164:165], v12 offset:320
    ds_read_b64_tr_b16 v[148:149], v8 offset:10280
    v_mfma_f32_16x16x32_bf16 v[68:71], v[128:131], v[236:239], v[68:71]
    ds_read_b64_tr_b16 v[150:151], v8 offset:11560
    s_waitcnt lgkmcnt(7)
    v_mfma_f32_16x16x32_bf16 v[72:75], v[232:235], v[136:139], v[72:75]
    ds_read_b64_tr_b16 v[128:129], v8 offset:80
    s_waitcnt lgkmcnt(6)
    v_mfma_f32_16x16x32_bf16 v[72:75], v[240:243], v[140:143], v[72:75]
    ds_read_b64_tr_b16 v[130:131], v8 offset:1360
    v_mfma_f32_16x16x32_bf16 v[92:95], v[244:247], v[140:143], v[92:95]
    ds_read_b64_tr_b16 v[132:133], v8 offset:10320
    v_mfma_f32_16x16x32_bf16 v[92:95], v[236:239], v[136:139], v[92:95]
    ds_read_b64_tr_b16 v[134:135], v8 offset:11600
    s_waitcnt lgkmcnt(7)
    v_mfma_f32_16x16x32_bf16 v[76:79], v[232:235], v[144:147], v[76:79]
    ds_read_b64_tr_b16 v[136:137], v8 offset:120
    s_waitcnt lgkmcnt(5)
    v_mfma_f32_16x16x32_bf16 v[76:79], v[240:243], v[148:151], v[76:79]
    ds_read_b64_tr_b16 v[138:139], v8 offset:1400
    v_mfma_f32_16x16x32_bf16 v[96:99], v[244:247], v[148:151], v[96:99]
    ds_read_b64_tr_b16 v[166:167], v12 offset:480
    ds_read_b64_tr_b16 v[140:141], v8 offset:10360
    v_mfma_f32_16x16x32_bf16 v[96:99], v[236:239], v[144:147], v[96:99]
    ds_read_b64_tr_b16 v[142:143], v8 offset:11640
    s_waitcnt lgkmcnt(7)
    v_mfma_f32_16x16x32_bf16 v[80:83], v[232:235], v[128:131], v[80:83]
    ds_read_b64_tr_b16 v[144:145], v10 offset:0
    s_waitcnt lgkmcnt(6)
    v_mfma_f32_16x16x32_bf16 v[80:83], v[240:243], v[132:135], v[80:83]
    ds_read_b64_tr_b16 v[146:147], v10 offset:1280
    v_mfma_f32_16x16x32_bf16 v[100:103], v[244:247], v[132:135], v[100:103]
    ds_read_b64_tr_b16 v[148:149], v10 offset:10240
    v_mfma_f32_16x16x32_bf16 v[100:103], v[236:239], v[128:131], v[100:103]
    ds_read_b64_tr_b16 v[150:151], v10 offset:11520
    s_waitcnt lgkmcnt(7)
    v_mfma_f32_16x16x32_bf16 v[84:87], v[232:235], v[136:139], v[84:87]
    s_barrier
    s_branch L_over_kv_2
L_warm_kv_2:
    s_branch L_warm_kv_3
L_over_kv_2:
    ds_read_b128 v[112:115], v4 offset:16384
    ds_read_b128 v[120:123], v5 offset:16384
    ds_read_b64_tr_b16 v[128:129], v6 offset:20480
    s_waitcnt lgkmcnt(7)
    v_mfma_f32_16x16x32_bf16 v[84:87], v[240:243], v[140:143], v[84:87]
    s_nop 0
    ds_read_b64_tr_b16 v[130:131], v6 offset:21760
    v_mfma_f32_16x16x32_bf16 v[104:107], v[244:247], v[140:143], v[104:107]
    ds_read_b128 v[124:127], v5 offset:18432
    ds_read_b128 v[116:119], v4 offset:18432
    ds_read_b64_tr_b16 v[132:133], v6 offset:30720
    v_mfma_f32_16x16x32_bf16 v[104:107], v[236:239], v[136:139], v[104:107]
    ds_read_b64_tr_b16 v[134:135], v6 offset:32000
    s_waitcnt lgkmcnt(10)
    v_mfma_f32_16x16x32_bf16 v[88:91], v[232:235], v[144:147], v[88:91]
    ds_read_b64_tr_b16 v[136:137], v6 offset:20488
    s_waitcnt lgkmcnt(9)
    v_mfma_f32_16x16x32_bf16 v[88:91], v[240:243], v[148:151], v[88:91]
    ds_read_b64_tr_b16 v[138:139], v6 offset:21768
    v_mfma_f32_16x16x32_bf16 v[108:111], v[244:247], v[148:151], v[108:111]
    ds_read_b64_tr_b16 v[140:141], v6 offset:30728
    v_mfma_f32_16x16x32_bf16 v[108:111], v[236:239], v[144:147], v[108:111]
    ds_read_b64_tr_b16 v[142:143], v6 offset:32008
    s_waitcnt lgkmcnt(8)
    v_mfma_f32_16x16x32_bf16 v[32:35], v[128:131], v[112:115], v[32:35]
    ds_read_b64_tr_b16 v[144:145], v6 offset:20496
    s_waitcnt lgkmcnt(5)
    v_mfma_f32_16x16x32_bf16 v[32:35], v[132:135], v[120:123], v[32:35]
    ds_read_b64_tr_b16 v[146:147], v6 offset:21776
    v_mfma_f32_16x16x32_bf16 v[52:55], v[132:135], v[124:127], v[52:55]
    ds_read_b64_tr_b16 v[168:169], v12 offset:640
    ds_read_b64_tr_b16 v[148:149], v6 offset:30736
    v_mfma_f32_16x16x32_bf16 v[52:55], v[128:131], v[116:119], v[52:55]
    ds_read_b64_tr_b16 v[150:151], v6 offset:32016
    s_waitcnt lgkmcnt(7)
    v_mfma_f32_16x16x32_bf16 v[36:39], v[136:139], v[112:115], v[36:39]
    ds_read_b64_tr_b16 v[128:129], v6 offset:20504
    s_waitcnt lgkmcnt(6)
    v_mfma_f32_16x16x32_bf16 v[36:39], v[140:143], v[120:123], v[36:39]
    ds_read_b64_tr_b16 v[130:131], v6 offset:21784
    v_mfma_f32_16x16x32_bf16 v[56:59], v[140:143], v[124:127], v[56:59]
    ds_read_b64_tr_b16 v[132:133], v6 offset:30744
    v_mfma_f32_16x16x32_bf16 v[56:59], v[136:139], v[116:119], v[56:59]
    ds_read_b64_tr_b16 v[134:135], v6 offset:32024
    s_waitcnt lgkmcnt(7)
    v_mfma_f32_16x16x32_bf16 v[40:43], v[144:147], v[112:115], v[40:43]
    ds_read_b64_tr_b16 v[136:137], v6 offset:20512
    s_waitcnt lgkmcnt(5)
    v_mfma_f32_16x16x32_bf16 v[40:43], v[148:151], v[120:123], v[40:43]
    ds_read_b64_tr_b16 v[138:139], v6 offset:21792
    v_mfma_f32_16x16x32_bf16 v[60:63], v[148:151], v[124:127], v[60:63]
    ds_read_b64_tr_b16 v[170:171], v12 offset:8
    ds_read_b64_tr_b16 v[140:141], v6 offset:30752
    v_mfma_f32_16x16x32_bf16 v[60:63], v[144:147], v[116:119], v[60:63]
    ds_read_b64_tr_b16 v[142:143], v6 offset:32032
    s_waitcnt lgkmcnt(7)
    v_mfma_f32_16x16x32_bf16 v[44:47], v[128:131], v[112:115], v[44:47]
    ds_read_b64_tr_b16 v[144:145], v8 offset:20480
    s_waitcnt lgkmcnt(6)
    v_mfma_f32_16x16x32_bf16 v[44:47], v[132:135], v[120:123], v[44:47]
    ds_read_b64_tr_b16 v[146:147], v8 offset:21760
    v_mfma_f32_16x16x32_bf16 v[64:67], v[132:135], v[124:127], v[64:67]
    ds_read_b64_tr_b16 v[148:149], v8 offset:30720
    v_mfma_f32_16x16x32_bf16 v[64:67], v[128:131], v[116:119], v[64:67]
    ds_read_b64_tr_b16 v[150:151], v8 offset:32000
    s_waitcnt lgkmcnt(7)
    v_mfma_f32_16x16x32_bf16 v[48:51], v[136:139], v[112:115], v[48:51]
    ds_read_b64_tr_b16 v[128:129], v8 offset:20520
    s_waitcnt lgkmcnt(5)
    v_mfma_f32_16x16x32_bf16 v[48:51], v[140:143], v[120:123], v[48:51]
    ds_read_b64_tr_b16 v[130:131], v8 offset:21800
    v_mfma_f32_16x16x32_bf16 v[68:71], v[140:143], v[124:127], v[68:71]
    ds_read_b64_tr_b16 v[172:173], v12 offset:168
    ds_read_b64_tr_b16 v[132:133], v8 offset:30760
    v_mfma_f32_16x16x32_bf16 v[68:71], v[136:139], v[116:119], v[68:71]
    ds_read_b64_tr_b16 v[134:135], v8 offset:32040
    s_waitcnt lgkmcnt(7)
    v_mfma_f32_16x16x32_bf16 v[72:75], v[112:115], v[144:147], v[72:75]
    ds_read_b64_tr_b16 v[136:137], v8 offset:20560
    s_waitcnt lgkmcnt(6)
    v_mfma_f32_16x16x32_bf16 v[72:75], v[120:123], v[148:151], v[72:75]
    ds_read_b64_tr_b16 v[138:139], v8 offset:21840
    v_mfma_f32_16x16x32_bf16 v[92:95], v[124:127], v[148:151], v[92:95]
    ds_read_b64_tr_b16 v[140:141], v8 offset:30800
    v_mfma_f32_16x16x32_bf16 v[92:95], v[116:119], v[144:147], v[92:95]
    ds_read_b64_tr_b16 v[142:143], v8 offset:32080
    s_waitcnt lgkmcnt(7)
    v_mfma_f32_16x16x32_bf16 v[76:79], v[112:115], v[128:131], v[76:79]
    ds_read_b64_tr_b16 v[144:145], v8 offset:20600
    s_waitcnt lgkmcnt(5)
    v_mfma_f32_16x16x32_bf16 v[76:79], v[120:123], v[132:135], v[76:79]
    ds_read_b64_tr_b16 v[146:147], v8 offset:21880
    v_mfma_f32_16x16x32_bf16 v[96:99], v[124:127], v[132:135], v[96:99]
    ds_read_b64_tr_b16 v[174:175], v12 offset:328
    ds_read_b64_tr_b16 v[148:149], v8 offset:30840
    v_mfma_f32_16x16x32_bf16 v[96:99], v[116:119], v[128:131], v[96:99]
    ds_read_b64_tr_b16 v[150:151], v8 offset:32120
    s_waitcnt lgkmcnt(7)
    v_mfma_f32_16x16x32_bf16 v[80:83], v[112:115], v[136:139], v[80:83]
    ds_read_b64_tr_b16 v[128:129], v10 offset:20480
    s_waitcnt lgkmcnt(6)
    v_mfma_f32_16x16x32_bf16 v[80:83], v[120:123], v[140:143], v[80:83]
    ds_read_b64_tr_b16 v[130:131], v10 offset:21760
    v_mfma_f32_16x16x32_bf16 v[100:103], v[124:127], v[140:143], v[100:103]
    ds_read_b64_tr_b16 v[132:133], v10 offset:30720
    v_mfma_f32_16x16x32_bf16 v[100:103], v[116:119], v[136:139], v[100:103]
    ds_read_b64_tr_b16 v[134:135], v10 offset:32000
    s_waitcnt lgkmcnt(7)
    v_mfma_f32_16x16x32_bf16 v[84:87], v[112:115], v[144:147], v[84:87]
    s_barrier
    ds_read_b128 v[232:235], v4 offset:32768
    ds_read_b128 v[240:243], v5 offset:32768
    ds_read_b64_tr_b16 v[136:137], v6 offset:40960
    s_waitcnt lgkmcnt(7)
    v_mfma_f32_16x16x32_bf16 v[84:87], v[120:123], v[148:151], v[84:87]
    s_nop 0
    ds_read_b64_tr_b16 v[138:139], v6 offset:42240
    v_mfma_f32_16x16x32_bf16 v[104:107], v[124:127], v[148:151], v[104:107]
    ds_read_b128 v[244:247], v5 offset:34816
    ds_read_b128 v[236:239], v4 offset:34816
    ds_read_b64_tr_b16 v[140:141], v6 offset:51200
    v_mfma_f32_16x16x32_bf16 v[104:107], v[116:119], v[144:147], v[104:107]
    ds_read_b64_tr_b16 v[142:143], v6 offset:52480
    s_waitcnt lgkmcnt(10)
    v_mfma_f32_16x16x32_bf16 v[88:91], v[112:115], v[128:131], v[88:91]
    ds_read_b64_tr_b16 v[144:145], v6 offset:40968
    s_waitcnt lgkmcnt(9)
    v_mfma_f32_16x16x32_bf16 v[88:91], v[120:123], v[132:135], v[88:91]
    ds_read_b64_tr_b16 v[146:147], v6 offset:42248
    v_mfma_f32_16x16x32_bf16 v[108:111], v[124:127], v[132:135], v[108:111]
    ds_read_b64_tr_b16 v[148:149], v6 offset:51208
    v_mfma_f32_16x16x32_bf16 v[108:111], v[116:119], v[128:131], v[108:111]
    ds_read_b64_tr_b16 v[150:151], v6 offset:52488
    s_waitcnt lgkmcnt(8)
    v_mfma_f32_16x16x32_bf16 v[32:35], v[136:139], v[232:235], v[32:35]
    ds_read_b64_tr_b16 v[128:129], v6 offset:40976
    s_waitcnt lgkmcnt(5)
    v_mfma_f32_16x16x32_bf16 v[32:35], v[140:143], v[240:243], v[32:35]
    ds_read_b64_tr_b16 v[130:131], v6 offset:42256
    v_mfma_f32_16x16x32_bf16 v[52:55], v[140:143], v[244:247], v[52:55]
    ds_read_b64_tr_b16 v[176:177], v12 offset:488
    ds_read_b64_tr_b16 v[132:133], v6 offset:51216
    v_mfma_f32_16x16x32_bf16 v[52:55], v[136:139], v[236:239], v[52:55]
    ds_read_b64_tr_b16 v[134:135], v6 offset:52496
    s_waitcnt lgkmcnt(7)
    v_mfma_f32_16x16x32_bf16 v[36:39], v[144:147], v[232:235], v[36:39]
    ds_read_b64_tr_b16 v[136:137], v6 offset:40984
    s_waitcnt lgkmcnt(6)
    v_mfma_f32_16x16x32_bf16 v[36:39], v[148:151], v[240:243], v[36:39]
    ds_read_b64_tr_b16 v[138:139], v6 offset:42264
    v_mfma_f32_16x16x32_bf16 v[56:59], v[148:151], v[244:247], v[56:59]
    ds_read_b64_tr_b16 v[140:141], v6 offset:51224
    v_mfma_f32_16x16x32_bf16 v[56:59], v[144:147], v[236:239], v[56:59]
    ds_read_b64_tr_b16 v[142:143], v6 offset:52504
    s_waitcnt lgkmcnt(7)
    v_mfma_f32_16x16x32_bf16 v[40:43], v[128:131], v[232:235], v[40:43]
    ds_read_b64_tr_b16 v[144:145], v6 offset:40992
    s_waitcnt lgkmcnt(5)
    v_mfma_f32_16x16x32_bf16 v[40:43], v[132:135], v[240:243], v[40:43]
    ds_read_b64_tr_b16 v[146:147], v6 offset:42272
    v_mfma_f32_16x16x32_bf16 v[60:63], v[132:135], v[244:247], v[60:63]
    ds_read_b64_tr_b16 v[178:179], v12 offset:648
    ds_read_b64_tr_b16 v[148:149], v6 offset:51232
    v_mfma_f32_16x16x32_bf16 v[60:63], v[128:131], v[236:239], v[60:63]
    ds_read_b64_tr_b16 v[150:151], v6 offset:52512
    s_waitcnt lgkmcnt(7)
    v_mfma_f32_16x16x32_bf16 v[44:47], v[136:139], v[232:235], v[44:47]
    ds_read_b64_tr_b16 v[128:129], v8 offset:40960
    s_waitcnt lgkmcnt(6)
    v_mfma_f32_16x16x32_bf16 v[44:47], v[140:143], v[240:243], v[44:47]
    ds_read_b64_tr_b16 v[130:131], v8 offset:42240
    v_mfma_f32_16x16x32_bf16 v[64:67], v[140:143], v[244:247], v[64:67]
    ds_read_b64_tr_b16 v[132:133], v8 offset:51200
    v_mfma_f32_16x16x32_bf16 v[64:67], v[136:139], v[236:239], v[64:67]
    ds_read_b64_tr_b16 v[134:135], v8 offset:52480
    s_waitcnt lgkmcnt(7)
    v_mfma_f32_16x16x32_bf16 v[48:51], v[144:147], v[232:235], v[48:51]
    ds_read_b64_tr_b16 v[136:137], v8 offset:41000
    s_waitcnt lgkmcnt(5)
    v_mfma_f32_16x16x32_bf16 v[48:51], v[148:151], v[240:243], v[48:51]
    ds_read_b64_tr_b16 v[138:139], v8 offset:42280
    v_mfma_f32_16x16x32_bf16 v[68:71], v[148:151], v[244:247], v[68:71]
    ds_read_b64_tr_b16 v[180:181], v12 offset:16
    ds_read_b64_tr_b16 v[140:141], v8 offset:51240
    v_mfma_f32_16x16x32_bf16 v[68:71], v[144:147], v[236:239], v[68:71]
    ds_read_b64_tr_b16 v[142:143], v8 offset:52520
    s_waitcnt lgkmcnt(7)
    v_mfma_f32_16x16x32_bf16 v[72:75], v[232:235], v[128:131], v[72:75]
    ds_read_b64_tr_b16 v[144:145], v8 offset:41040
    s_waitcnt lgkmcnt(6)
    v_mfma_f32_16x16x32_bf16 v[72:75], v[240:243], v[132:135], v[72:75]
    ds_read_b64_tr_b16 v[146:147], v8 offset:42320
    v_mfma_f32_16x16x32_bf16 v[92:95], v[244:247], v[132:135], v[92:95]
    ds_read_b64_tr_b16 v[148:149], v8 offset:51280
    v_mfma_f32_16x16x32_bf16 v[92:95], v[236:239], v[128:131], v[92:95]
    ds_read_b64_tr_b16 v[150:151], v8 offset:52560
    s_waitcnt lgkmcnt(7)
    v_mfma_f32_16x16x32_bf16 v[76:79], v[232:235], v[136:139], v[76:79]
    ds_read_b64_tr_b16 v[128:129], v8 offset:41080
    s_waitcnt lgkmcnt(5)
    v_mfma_f32_16x16x32_bf16 v[76:79], v[240:243], v[140:143], v[76:79]
    ds_read_b64_tr_b16 v[130:131], v8 offset:42360
    v_mfma_f32_16x16x32_bf16 v[96:99], v[244:247], v[140:143], v[96:99]
    ds_read_b64_tr_b16 v[182:183], v12 offset:176
    ds_read_b64_tr_b16 v[132:133], v8 offset:51320
    v_mfma_f32_16x16x32_bf16 v[96:99], v[236:239], v[136:139], v[96:99]
    ds_read_b64_tr_b16 v[134:135], v8 offset:52600
    s_waitcnt lgkmcnt(7)
    v_mfma_f32_16x16x32_bf16 v[80:83], v[232:235], v[144:147], v[80:83]
    ds_read_b64_tr_b16 v[136:137], v10 offset:40960
    s_waitcnt lgkmcnt(6)
    v_mfma_f32_16x16x32_bf16 v[80:83], v[240:243], v[148:151], v[80:83]
    ds_read_b64_tr_b16 v[138:139], v10 offset:42240
    v_mfma_f32_16x16x32_bf16 v[100:103], v[244:247], v[148:151], v[100:103]
    ds_read_b64_tr_b16 v[140:141], v10 offset:51200
    v_mfma_f32_16x16x32_bf16 v[100:103], v[236:239], v[144:147], v[100:103]
    ds_read_b64_tr_b16 v[142:143], v10 offset:52480
    s_waitcnt lgkmcnt(7)
    v_mfma_f32_16x16x32_bf16 v[84:87], v[232:235], v[128:131], v[84:87]
    s_barrier
    ds_read_b128 v[112:115], v4 offset:49152
    ds_read_b128 v[120:123], v5 offset:49152
    ds_read_b64_tr_b16 v[144:145], v7 offset:0
    s_waitcnt lgkmcnt(7)
    v_mfma_f32_16x16x32_bf16 v[84:87], v[240:243], v[132:135], v[84:87]
    s_nop 0
    ds_read_b64_tr_b16 v[146:147], v7 offset:1280
    v_mfma_f32_16x16x32_bf16 v[104:107], v[244:247], v[132:135], v[104:107]
    ds_read_b128 v[124:127], v5 offset:51200
    ds_read_b128 v[116:119], v4 offset:51200
    ds_read_b64_tr_b16 v[148:149], v7 offset:10240
    v_mfma_f32_16x16x32_bf16 v[104:107], v[236:239], v[128:131], v[104:107]
    ds_read_b64_tr_b16 v[150:151], v7 offset:11520
    s_waitcnt lgkmcnt(10)
    v_mfma_f32_16x16x32_bf16 v[88:91], v[232:235], v[136:139], v[88:91]
    ds_read_b64_tr_b16 v[128:129], v7 offset:8
    s_waitcnt lgkmcnt(9)
    v_mfma_f32_16x16x32_bf16 v[88:91], v[240:243], v[140:143], v[88:91]
    ds_read_b64_tr_b16 v[130:131], v7 offset:1288
    v_mfma_f32_16x16x32_bf16 v[108:111], v[244:247], v[140:143], v[108:111]
    ds_read_b64_tr_b16 v[132:133], v7 offset:10248
    v_mfma_f32_16x16x32_bf16 v[108:111], v[236:239], v[136:139], v[108:111]
    ds_read_b64_tr_b16 v[134:135], v7 offset:11528
    s_waitcnt lgkmcnt(8)
    v_mfma_f32_16x16x32_bf16 v[32:35], v[144:147], v[112:115], v[32:35]
    ds_read_b64_tr_b16 v[136:137], v7 offset:16
    s_waitcnt lgkmcnt(5)
    v_mfma_f32_16x16x32_bf16 v[32:35], v[148:151], v[120:123], v[32:35]
    ds_read_b64_tr_b16 v[138:139], v7 offset:1296
    v_mfma_f32_16x16x32_bf16 v[52:55], v[148:151], v[124:127], v[52:55]
    ds_read_b64_tr_b16 v[184:185], v12 offset:336
    ds_read_b64_tr_b16 v[140:141], v7 offset:10256
    v_mfma_f32_16x16x32_bf16 v[52:55], v[144:147], v[116:119], v[52:55]
    ds_read_b64_tr_b16 v[142:143], v7 offset:11536
    s_waitcnt lgkmcnt(7)
    v_mfma_f32_16x16x32_bf16 v[36:39], v[128:131], v[112:115], v[36:39]
    ds_read_b64_tr_b16 v[144:145], v7 offset:24
    s_waitcnt lgkmcnt(6)
    v_mfma_f32_16x16x32_bf16 v[36:39], v[132:135], v[120:123], v[36:39]
    ds_read_b64_tr_b16 v[146:147], v7 offset:1304
    v_mfma_f32_16x16x32_bf16 v[56:59], v[132:135], v[124:127], v[56:59]
    ds_read_b64_tr_b16 v[148:149], v7 offset:10264
    v_mfma_f32_16x16x32_bf16 v[56:59], v[128:131], v[116:119], v[56:59]
    ds_read_b64_tr_b16 v[150:151], v7 offset:11544
    s_waitcnt lgkmcnt(7)
    v_mfma_f32_16x16x32_bf16 v[40:43], v[136:139], v[112:115], v[40:43]
    ds_read_b64_tr_b16 v[128:129], v7 offset:32
    s_waitcnt lgkmcnt(5)
    v_mfma_f32_16x16x32_bf16 v[40:43], v[140:143], v[120:123], v[40:43]
    ds_read_b64_tr_b16 v[130:131], v7 offset:1312
    v_mfma_f32_16x16x32_bf16 v[60:63], v[140:143], v[124:127], v[60:63]
    ds_read_b64_tr_b16 v[186:187], v12 offset:496
    ds_read_b64_tr_b16 v[132:133], v7 offset:10272
    v_mfma_f32_16x16x32_bf16 v[60:63], v[136:139], v[116:119], v[60:63]
    ds_read_b64_tr_b16 v[134:135], v7 offset:11552
    s_waitcnt lgkmcnt(7)
    v_mfma_f32_16x16x32_bf16 v[44:47], v[144:147], v[112:115], v[44:47]
    ds_read_b64_tr_b16 v[136:137], v9 offset:0
    s_waitcnt lgkmcnt(6)
    v_mfma_f32_16x16x32_bf16 v[44:47], v[148:151], v[120:123], v[44:47]
    ds_read_b64_tr_b16 v[138:139], v9 offset:1280
    v_mfma_f32_16x16x32_bf16 v[64:67], v[148:151], v[124:127], v[64:67]
    ds_read_b64_tr_b16 v[140:141], v9 offset:10240
    v_mfma_f32_16x16x32_bf16 v[64:67], v[144:147], v[116:119], v[64:67]
    ds_read_b64_tr_b16 v[142:143], v9 offset:11520
    s_waitcnt lgkmcnt(7)
    v_mfma_f32_16x16x32_bf16 v[48:51], v[128:131], v[112:115], v[48:51]
    ds_read_b64_tr_b16 v[144:145], v9 offset:40
    s_waitcnt lgkmcnt(5)
    v_mfma_f32_16x16x32_bf16 v[48:51], v[132:135], v[120:123], v[48:51]
    ds_read_b64_tr_b16 v[146:147], v9 offset:1320
    v_mfma_f32_16x16x32_bf16 v[68:71], v[132:135], v[124:127], v[68:71]
    ds_read_b64_tr_b16 v[188:189], v12 offset:656
    ds_read_b64_tr_b16 v[148:149], v9 offset:10280
    v_mfma_f32_16x16x32_bf16 v[68:71], v[128:131], v[116:119], v[68:71]
    ds_read_b64_tr_b16 v[150:151], v9 offset:11560
    s_waitcnt lgkmcnt(7)
    v_mfma_f32_16x16x32_bf16 v[72:75], v[112:115], v[136:139], v[72:75]
    ds_read_b64_tr_b16 v[128:129], v9 offset:80
    s_waitcnt lgkmcnt(6)
    v_mfma_f32_16x16x32_bf16 v[72:75], v[120:123], v[140:143], v[72:75]
    ds_read_b64_tr_b16 v[130:131], v9 offset:1360
    v_mfma_f32_16x16x32_bf16 v[92:95], v[124:127], v[140:143], v[92:95]
    ds_read_b64_tr_b16 v[132:133], v9 offset:10320
    v_mfma_f32_16x16x32_bf16 v[92:95], v[116:119], v[136:139], v[92:95]
    ds_read_b64_tr_b16 v[134:135], v9 offset:11600
    s_waitcnt lgkmcnt(7)
    v_mfma_f32_16x16x32_bf16 v[76:79], v[112:115], v[144:147], v[76:79]
    ds_read_b64_tr_b16 v[136:137], v9 offset:120
    s_waitcnt lgkmcnt(5)
    v_mfma_f32_16x16x32_bf16 v[76:79], v[120:123], v[148:151], v[76:79]
    ds_read_b64_tr_b16 v[138:139], v9 offset:1400
    v_mfma_f32_16x16x32_bf16 v[96:99], v[124:127], v[148:151], v[96:99]
    ds_read_b64_tr_b16 v[190:191], v12 offset:24
    ds_read_b64_tr_b16 v[140:141], v9 offset:10360
    v_mfma_f32_16x16x32_bf16 v[96:99], v[116:119], v[144:147], v[96:99]
    ds_read_b64_tr_b16 v[142:143], v9 offset:11640
    s_waitcnt lgkmcnt(7)
    v_mfma_f32_16x16x32_bf16 v[80:83], v[112:115], v[128:131], v[80:83]
    ds_read_b64_tr_b16 v[144:145], v11 offset:0
    s_waitcnt lgkmcnt(6)
    v_mfma_f32_16x16x32_bf16 v[80:83], v[120:123], v[132:135], v[80:83]
    ds_read_b64_tr_b16 v[146:147], v11 offset:1280
    v_mfma_f32_16x16x32_bf16 v[100:103], v[124:127], v[132:135], v[100:103]
    ds_read_b64_tr_b16 v[148:149], v11 offset:10240
    v_mfma_f32_16x16x32_bf16 v[100:103], v[116:119], v[128:131], v[100:103]
    ds_read_b64_tr_b16 v[150:151], v11 offset:11520
    s_waitcnt lgkmcnt(7)
    v_mfma_f32_16x16x32_bf16 v[84:87], v[112:115], v[136:139], v[84:87]
    s_barrier
    ds_read_b128 v[232:235], v4 offset:0
    ds_read_b128 v[240:243], v5 offset:0
    ds_read_b64_tr_b16 v[128:129], v6 offset:0
    s_waitcnt lgkmcnt(7)
    v_mfma_f32_16x16x32_bf16 v[84:87], v[120:123], v[140:143], v[84:87]
    s_nop 0
    ds_read_b64_tr_b16 v[130:131], v6 offset:1280
    v_mfma_f32_16x16x32_bf16 v[104:107], v[124:127], v[140:143], v[104:107]
    ds_read_b128 v[244:247], v5 offset:2048
    ds_read_b128 v[236:239], v4 offset:2048
    ds_read_b64_tr_b16 v[132:133], v6 offset:10240
    v_mfma_f32_16x16x32_bf16 v[104:107], v[116:119], v[136:139], v[104:107]
    ds_read_b64_tr_b16 v[134:135], v6 offset:11520
    s_waitcnt lgkmcnt(10)
    v_mfma_f32_16x16x32_bf16 v[88:91], v[112:115], v[144:147], v[88:91]
    ds_read_b64_tr_b16 v[136:137], v6 offset:8
    s_waitcnt lgkmcnt(9)
    v_mfma_f32_16x16x32_bf16 v[88:91], v[120:123], v[148:151], v[88:91]
    ds_read_b64_tr_b16 v[138:139], v6 offset:1288
    v_mfma_f32_16x16x32_bf16 v[108:111], v[124:127], v[148:151], v[108:111]
    ds_read_b64_tr_b16 v[140:141], v6 offset:10248
    v_mfma_f32_16x16x32_bf16 v[108:111], v[116:119], v[144:147], v[108:111]
    ds_read_b64_tr_b16 v[142:143], v6 offset:11528
    s_waitcnt lgkmcnt(8)
    v_mfma_f32_16x16x32_bf16 v[32:35], v[128:131], v[232:235], v[32:35]
    ds_read_b64_tr_b16 v[144:145], v6 offset:16
    s_waitcnt lgkmcnt(5)
    v_mfma_f32_16x16x32_bf16 v[32:35], v[132:135], v[240:243], v[32:35]
    ds_read_b64_tr_b16 v[146:147], v6 offset:1296
    v_mfma_f32_16x16x32_bf16 v[52:55], v[132:135], v[244:247], v[52:55]
    ds_read_b64_tr_b16 v[192:193], v12 offset:184
    ds_read_b64_tr_b16 v[148:149], v6 offset:10256
    v_mfma_f32_16x16x32_bf16 v[52:55], v[128:131], v[236:239], v[52:55]
    ds_read_b64_tr_b16 v[150:151], v6 offset:11536
    s_waitcnt lgkmcnt(7)
    v_mfma_f32_16x16x32_bf16 v[36:39], v[136:139], v[232:235], v[36:39]
    ds_read_b64_tr_b16 v[128:129], v6 offset:24
    s_waitcnt lgkmcnt(6)
    v_mfma_f32_16x16x32_bf16 v[36:39], v[140:143], v[240:243], v[36:39]
    ds_read_b64_tr_b16 v[130:131], v6 offset:1304
    v_mfma_f32_16x16x32_bf16 v[56:59], v[140:143], v[244:247], v[56:59]
    ds_read_b64_tr_b16 v[132:133], v6 offset:10264
    v_mfma_f32_16x16x32_bf16 v[56:59], v[136:139], v[236:239], v[56:59]
    ds_read_b64_tr_b16 v[134:135], v6 offset:11544
    s_waitcnt lgkmcnt(7)
    v_mfma_f32_16x16x32_bf16 v[40:43], v[144:147], v[232:235], v[40:43]
    ds_read_b64_tr_b16 v[136:137], v6 offset:32
    s_waitcnt lgkmcnt(5)
    v_mfma_f32_16x16x32_bf16 v[40:43], v[148:151], v[240:243], v[40:43]
    ds_read_b64_tr_b16 v[138:139], v6 offset:1312
    v_mfma_f32_16x16x32_bf16 v[60:63], v[148:151], v[244:247], v[60:63]
    ds_read_b64_tr_b16 v[194:195], v12 offset:344
    ds_read_b64_tr_b16 v[140:141], v6 offset:10272
    v_mfma_f32_16x16x32_bf16 v[60:63], v[144:147], v[236:239], v[60:63]
    ds_read_b64_tr_b16 v[142:143], v6 offset:11552
    s_waitcnt lgkmcnt(7)
    v_mfma_f32_16x16x32_bf16 v[44:47], v[128:131], v[232:235], v[44:47]
    ds_read_b64_tr_b16 v[144:145], v8 offset:0
    s_waitcnt lgkmcnt(6)
    v_mfma_f32_16x16x32_bf16 v[44:47], v[132:135], v[240:243], v[44:47]
    ds_read_b64_tr_b16 v[146:147], v8 offset:1280
    v_mfma_f32_16x16x32_bf16 v[64:67], v[132:135], v[244:247], v[64:67]
    ds_read_b64_tr_b16 v[148:149], v8 offset:10240
    v_mfma_f32_16x16x32_bf16 v[64:67], v[128:131], v[236:239], v[64:67]
    ds_read_b64_tr_b16 v[150:151], v8 offset:11520
    s_waitcnt lgkmcnt(7)
    v_mfma_f32_16x16x32_bf16 v[48:51], v[136:139], v[232:235], v[48:51]
    ds_read_b64_tr_b16 v[128:129], v8 offset:40
    s_waitcnt lgkmcnt(5)
    v_mfma_f32_16x16x32_bf16 v[48:51], v[140:143], v[240:243], v[48:51]
    ds_read_b64_tr_b16 v[130:131], v8 offset:1320
    v_mfma_f32_16x16x32_bf16 v[68:71], v[140:143], v[244:247], v[68:71]
    ds_read_b64_tr_b16 v[196:197], v12 offset:504
    ds_read_b64_tr_b16 v[132:133], v8 offset:10280
    v_mfma_f32_16x16x32_bf16 v[68:71], v[136:139], v[236:239], v[68:71]
    ds_read_b64_tr_b16 v[134:135], v8 offset:11560
    s_waitcnt lgkmcnt(7)
    v_mfma_f32_16x16x32_bf16 v[72:75], v[232:235], v[144:147], v[72:75]
    ds_read_b64_tr_b16 v[136:137], v8 offset:80
    s_waitcnt lgkmcnt(6)
    v_mfma_f32_16x16x32_bf16 v[72:75], v[240:243], v[148:151], v[72:75]
    ds_read_b64_tr_b16 v[138:139], v8 offset:1360
    v_mfma_f32_16x16x32_bf16 v[92:95], v[244:247], v[148:151], v[92:95]
    ds_read_b64_tr_b16 v[140:141], v8 offset:10320
    v_mfma_f32_16x16x32_bf16 v[92:95], v[236:239], v[144:147], v[92:95]
    ds_read_b64_tr_b16 v[142:143], v8 offset:11600
    s_waitcnt lgkmcnt(7)
    v_mfma_f32_16x16x32_bf16 v[76:79], v[232:235], v[128:131], v[76:79]
    ds_read_b64_tr_b16 v[144:145], v8 offset:120
    s_waitcnt lgkmcnt(5)
    v_mfma_f32_16x16x32_bf16 v[76:79], v[240:243], v[132:135], v[76:79]
    ds_read_b64_tr_b16 v[146:147], v8 offset:1400
    v_mfma_f32_16x16x32_bf16 v[96:99], v[244:247], v[132:135], v[96:99]
    ds_read_b64_tr_b16 v[198:199], v12 offset:664
    ds_read_b64_tr_b16 v[148:149], v8 offset:10360
    v_mfma_f32_16x16x32_bf16 v[96:99], v[236:239], v[128:131], v[96:99]
    ds_read_b64_tr_b16 v[150:151], v8 offset:11640
    s_waitcnt lgkmcnt(7)
    v_mfma_f32_16x16x32_bf16 v[80:83], v[232:235], v[136:139], v[80:83]
    ds_read_b64_tr_b16 v[128:129], v10 offset:0
    s_waitcnt lgkmcnt(6)
    v_mfma_f32_16x16x32_bf16 v[80:83], v[240:243], v[140:143], v[80:83]
    ds_read_b64_tr_b16 v[130:131], v10 offset:1280
    v_mfma_f32_16x16x32_bf16 v[100:103], v[244:247], v[140:143], v[100:103]
    ds_read_b64_tr_b16 v[132:133], v10 offset:10240
    v_mfma_f32_16x16x32_bf16 v[100:103], v[236:239], v[136:139], v[100:103]
    ds_read_b64_tr_b16 v[134:135], v10 offset:11520
    s_waitcnt lgkmcnt(7)
    v_mfma_f32_16x16x32_bf16 v[84:87], v[232:235], v[144:147], v[84:87]
    s_barrier
    ds_read_b128 v[112:115], v4 offset:16384
    ds_read_b128 v[120:123], v5 offset:16384
    ds_read_b64_tr_b16 v[136:137], v6 offset:20480
    s_waitcnt lgkmcnt(7)
    v_mfma_f32_16x16x32_bf16 v[84:87], v[240:243], v[148:151], v[84:87]
    s_nop 0
    ds_read_b64_tr_b16 v[138:139], v6 offset:21760
    v_mfma_f32_16x16x32_bf16 v[104:107], v[244:247], v[148:151], v[104:107]
    ds_read_b128 v[124:127], v5 offset:18432
    ds_read_b128 v[116:119], v4 offset:18432
    ds_read_b64_tr_b16 v[140:141], v6 offset:30720
    v_mfma_f32_16x16x32_bf16 v[104:107], v[236:239], v[144:147], v[104:107]
    ds_read_b64_tr_b16 v[142:143], v6 offset:32000
    s_waitcnt lgkmcnt(10)
    v_mfma_f32_16x16x32_bf16 v[88:91], v[232:235], v[128:131], v[88:91]
    ds_read_b64_tr_b16 v[144:145], v6 offset:20488
    s_waitcnt lgkmcnt(9)
    v_mfma_f32_16x16x32_bf16 v[88:91], v[240:243], v[132:135], v[88:91]
    ds_read_b64_tr_b16 v[146:147], v6 offset:21768
    v_mfma_f32_16x16x32_bf16 v[108:111], v[244:247], v[132:135], v[108:111]
    ds_read_b64_tr_b16 v[148:149], v6 offset:30728
    v_mfma_f32_16x16x32_bf16 v[108:111], v[236:239], v[128:131], v[108:111]
    ds_read_b64_tr_b16 v[150:151], v6 offset:32008
    s_waitcnt lgkmcnt(8)
    v_mfma_f32_16x16x32_bf16 v[32:35], v[136:139], v[112:115], v[32:35]
    ds_read_b64_tr_b16 v[128:129], v6 offset:20496
    s_waitcnt lgkmcnt(5)
    v_mfma_f32_16x16x32_bf16 v[32:35], v[140:143], v[120:123], v[32:35]
    ds_read_b64_tr_b16 v[130:131], v6 offset:21776
    v_mfma_f32_16x16x32_bf16 v[52:55], v[140:143], v[124:127], v[52:55]
    ds_read_b64_tr_b16 v[200:201], v12 offset:32
    ds_read_b64_tr_b16 v[132:133], v6 offset:30736
    v_mfma_f32_16x16x32_bf16 v[52:55], v[136:139], v[116:119], v[52:55]
    ds_read_b64_tr_b16 v[134:135], v6 offset:32016
    s_waitcnt lgkmcnt(7)
    v_mfma_f32_16x16x32_bf16 v[36:39], v[144:147], v[112:115], v[36:39]
    ds_read_b64_tr_b16 v[136:137], v6 offset:20504
    s_waitcnt lgkmcnt(6)
    v_mfma_f32_16x16x32_bf16 v[36:39], v[148:151], v[120:123], v[36:39]
    ds_read_b64_tr_b16 v[138:139], v6 offset:21784
    v_mfma_f32_16x16x32_bf16 v[56:59], v[148:151], v[124:127], v[56:59]
    ds_read_b64_tr_b16 v[140:141], v6 offset:30744
    v_mfma_f32_16x16x32_bf16 v[56:59], v[144:147], v[116:119], v[56:59]
    ds_read_b64_tr_b16 v[142:143], v6 offset:32024
    s_waitcnt lgkmcnt(7)
    v_mfma_f32_16x16x32_bf16 v[40:43], v[128:131], v[112:115], v[40:43]
    ds_read_b64_tr_b16 v[144:145], v6 offset:20512
    s_waitcnt lgkmcnt(5)
    v_mfma_f32_16x16x32_bf16 v[40:43], v[132:135], v[120:123], v[40:43]
    ds_read_b64_tr_b16 v[146:147], v6 offset:21792
    v_mfma_f32_16x16x32_bf16 v[60:63], v[132:135], v[124:127], v[60:63]
    ds_read_b64_tr_b16 v[202:203], v12 offset:192
    ds_read_b64_tr_b16 v[148:149], v6 offset:30752
    v_mfma_f32_16x16x32_bf16 v[60:63], v[128:131], v[116:119], v[60:63]
    ds_read_b64_tr_b16 v[150:151], v6 offset:32032
    s_waitcnt lgkmcnt(7)
    v_mfma_f32_16x16x32_bf16 v[44:47], v[136:139], v[112:115], v[44:47]
    ds_read_b64_tr_b16 v[128:129], v8 offset:20480
    s_waitcnt lgkmcnt(6)
    v_mfma_f32_16x16x32_bf16 v[44:47], v[140:143], v[120:123], v[44:47]
    ds_read_b64_tr_b16 v[130:131], v8 offset:21760
    v_mfma_f32_16x16x32_bf16 v[64:67], v[140:143], v[124:127], v[64:67]
    ds_read_b64_tr_b16 v[132:133], v8 offset:30720
    v_mfma_f32_16x16x32_bf16 v[64:67], v[136:139], v[116:119], v[64:67]
    ds_read_b64_tr_b16 v[134:135], v8 offset:32000
    s_waitcnt lgkmcnt(7)
    v_mfma_f32_16x16x32_bf16 v[48:51], v[144:147], v[112:115], v[48:51]
    ds_read_b64_tr_b16 v[136:137], v8 offset:20520
    s_waitcnt lgkmcnt(5)
    v_mfma_f32_16x16x32_bf16 v[48:51], v[148:151], v[120:123], v[48:51]
    ds_read_b64_tr_b16 v[138:139], v8 offset:21800
    v_mfma_f32_16x16x32_bf16 v[68:71], v[148:151], v[124:127], v[68:71]
    ds_read_b64_tr_b16 v[204:205], v12 offset:352
    ds_read_b64_tr_b16 v[140:141], v8 offset:30760
    v_mfma_f32_16x16x32_bf16 v[68:71], v[144:147], v[116:119], v[68:71]
    ds_read_b64_tr_b16 v[142:143], v8 offset:32040
    s_waitcnt lgkmcnt(7)
    v_mfma_f32_16x16x32_bf16 v[72:75], v[112:115], v[128:131], v[72:75]
    ds_read_b64_tr_b16 v[144:145], v8 offset:20560
    s_waitcnt lgkmcnt(6)
    v_mfma_f32_16x16x32_bf16 v[72:75], v[120:123], v[132:135], v[72:75]
    ds_read_b64_tr_b16 v[146:147], v8 offset:21840
    v_mfma_f32_16x16x32_bf16 v[92:95], v[124:127], v[132:135], v[92:95]
    ds_read_b64_tr_b16 v[148:149], v8 offset:30800
    v_mfma_f32_16x16x32_bf16 v[92:95], v[116:119], v[128:131], v[92:95]
    ds_read_b64_tr_b16 v[150:151], v8 offset:32080
    s_waitcnt lgkmcnt(7)
    v_mfma_f32_16x16x32_bf16 v[76:79], v[112:115], v[136:139], v[76:79]
    ds_read_b64_tr_b16 v[128:129], v8 offset:20600
    s_waitcnt lgkmcnt(5)
    v_mfma_f32_16x16x32_bf16 v[76:79], v[120:123], v[140:143], v[76:79]
    ds_read_b64_tr_b16 v[130:131], v8 offset:21880
    v_mfma_f32_16x16x32_bf16 v[96:99], v[124:127], v[140:143], v[96:99]
    ds_read_b64_tr_b16 v[206:207], v12 offset:512
    ds_read_b64_tr_b16 v[132:133], v8 offset:30840
    v_mfma_f32_16x16x32_bf16 v[96:99], v[116:119], v[136:139], v[96:99]
    ds_read_b64_tr_b16 v[134:135], v8 offset:32120
    s_waitcnt lgkmcnt(7)
    v_mfma_f32_16x16x32_bf16 v[80:83], v[112:115], v[144:147], v[80:83]
    ds_read_b64_tr_b16 v[136:137], v10 offset:20480
    s_waitcnt lgkmcnt(6)
    v_mfma_f32_16x16x32_bf16 v[80:83], v[120:123], v[148:151], v[80:83]
    ds_read_b64_tr_b16 v[138:139], v10 offset:21760
    v_mfma_f32_16x16x32_bf16 v[100:103], v[124:127], v[148:151], v[100:103]
    ds_read_b64_tr_b16 v[140:141], v10 offset:30720
    v_mfma_f32_16x16x32_bf16 v[100:103], v[116:119], v[144:147], v[100:103]
    ds_read_b64_tr_b16 v[142:143], v10 offset:32000
    s_waitcnt lgkmcnt(7)
    v_mfma_f32_16x16x32_bf16 v[84:87], v[112:115], v[128:131], v[84:87]
    s_barrier
    ds_read_b128 v[232:235], v4 offset:32768
    ds_read_b128 v[240:243], v5 offset:32768
    ds_read_b64_tr_b16 v[144:145], v6 offset:40960
    s_waitcnt lgkmcnt(7)
    v_mfma_f32_16x16x32_bf16 v[84:87], v[120:123], v[132:135], v[84:87]
    s_nop 0
    ds_read_b64_tr_b16 v[146:147], v6 offset:42240
    v_mfma_f32_16x16x32_bf16 v[104:107], v[124:127], v[132:135], v[104:107]
    ds_read_b128 v[244:247], v5 offset:34816
    ds_read_b128 v[236:239], v4 offset:34816
    ds_read_b64_tr_b16 v[148:149], v6 offset:51200
    v_mfma_f32_16x16x32_bf16 v[104:107], v[116:119], v[128:131], v[104:107]
    ds_read_b64_tr_b16 v[150:151], v6 offset:52480
    s_waitcnt lgkmcnt(10)
    v_mfma_f32_16x16x32_bf16 v[88:91], v[112:115], v[136:139], v[88:91]
    ds_read_b64_tr_b16 v[128:129], v6 offset:40968
    s_waitcnt lgkmcnt(9)
    v_mfma_f32_16x16x32_bf16 v[88:91], v[120:123], v[140:143], v[88:91]
    s_branch L_over_kv_3
L_warm_kv_3:
    s_branch L_warm_kv_4
L_over_kv_3:
    ds_read_b64_tr_b16 v[130:131], v6 offset:42248
    v_mfma_f32_16x16x32_bf16 v[108:111], v[124:127], v[140:143], v[108:111]
    ds_read_b64_tr_b16 v[132:133], v6 offset:51208
    v_mfma_f32_16x16x32_bf16 v[108:111], v[116:119], v[136:139], v[108:111]
    ds_read_b64_tr_b16 v[134:135], v6 offset:52488
    s_waitcnt lgkmcnt(8)
    v_mfma_f32_16x16x32_bf16 v[32:35], v[144:147], v[232:235], v[32:35]
    ds_read_b64_tr_b16 v[136:137], v6 offset:40976
    s_waitcnt lgkmcnt(5)
    v_mfma_f32_16x16x32_bf16 v[32:35], v[148:151], v[240:243], v[32:35]
    ds_read_b64_tr_b16 v[138:139], v6 offset:42256
    v_mfma_f32_16x16x32_bf16 v[52:55], v[148:151], v[244:247], v[52:55]
    ds_read_b64_tr_b16 v[208:209], v12 offset:672
    ds_read_b64_tr_b16 v[140:141], v6 offset:51216
    v_mfma_f32_16x16x32_bf16 v[52:55], v[144:147], v[236:239], v[52:55]
    ds_read_b64_tr_b16 v[142:143], v6 offset:52496
    s_waitcnt lgkmcnt(7)
    v_mfma_f32_16x16x32_bf16 v[36:39], v[128:131], v[232:235], v[36:39]
    ds_read_b64_tr_b16 v[144:145], v6 offset:40984
    s_waitcnt lgkmcnt(6)
    v_mfma_f32_16x16x32_bf16 v[36:39], v[132:135], v[240:243], v[36:39]
    ds_read_b64_tr_b16 v[146:147], v6 offset:42264
    v_mfma_f32_16x16x32_bf16 v[56:59], v[132:135], v[244:247], v[56:59]
    ds_read_b64_tr_b16 v[148:149], v6 offset:51224
    v_mfma_f32_16x16x32_bf16 v[56:59], v[128:131], v[236:239], v[56:59]
    ds_read_b64_tr_b16 v[150:151], v6 offset:52504
    s_waitcnt lgkmcnt(7)
    v_mfma_f32_16x16x32_bf16 v[40:43], v[136:139], v[232:235], v[40:43]
    ds_read_b64_tr_b16 v[128:129], v6 offset:40992
    s_waitcnt lgkmcnt(5)
    v_mfma_f32_16x16x32_bf16 v[40:43], v[140:143], v[240:243], v[40:43]
    ds_read_b64_tr_b16 v[130:131], v6 offset:42272
    v_mfma_f32_16x16x32_bf16 v[60:63], v[140:143], v[244:247], v[60:63]
    ds_read_b64_tr_b16 v[132:133], v6 offset:51232
    v_mfma_f32_16x16x32_bf16 v[60:63], v[136:139], v[236:239], v[60:63]
    ds_read_b64_tr_b16 v[134:135], v6 offset:52512
    s_waitcnt lgkmcnt(6)
    v_mfma_f32_16x16x32_bf16 v[44:47], v[144:147], v[232:235], v[44:47]
    ds_read_b64_tr_b16 v[136:137], v8 offset:40960
    s_waitcnt lgkmcnt(5)
    v_mfma_f32_16x16x32_bf16 v[44:47], v[148:151], v[240:243], v[44:47]
    ds_read_b64_tr_b16 v[138:139], v8 offset:42240
    v_mfma_f32_16x16x32_bf16 v[64:67], v[148:151], v[244:247], v[64:67]
    ds_read_b64_tr_b16 v[140:141], v8 offset:51200
    v_mfma_f32_16x16x32_bf16 v[64:67], v[144:147], v[236:239], v[64:67]
    ds_read_b64_tr_b16 v[142:143], v8 offset:52480
    s_waitcnt lgkmcnt(6)
    v_mfma_f32_16x16x32_bf16 v[48:51], v[128:131], v[232:235], v[48:51]
    ds_read_b64_tr_b16 v[144:145], v8 offset:41000
    s_waitcnt lgkmcnt(5)
    v_mfma_f32_16x16x32_bf16 v[48:51], v[132:135], v[240:243], v[48:51]
    ds_read_b64_tr_b16 v[146:147], v8 offset:42280
    v_mfma_f32_16x16x32_bf16 v[68:71], v[132:135], v[244:247], v[68:71]
    ds_read_b64_tr_b16 v[148:149], v8 offset:51240
    v_mfma_f32_16x16x32_bf16 v[68:71], v[128:131], v[236:239], v[68:71]
    ds_read_b64_tr_b16 v[150:151], v8 offset:52520
    s_waitcnt lgkmcnt(6)
    v_mfma_f32_16x16x32_bf16 v[72:75], v[232:235], v[136:139], v[72:75]
    ds_read_b64_tr_b16 v[128:129], v8 offset:41040
    s_waitcnt lgkmcnt(5)
    v_mfma_f32_16x16x32_bf16 v[72:75], v[240:243], v[140:143], v[72:75]
    ds_read_b64_tr_b16 v[130:131], v8 offset:42320
    v_mfma_f32_16x16x32_bf16 v[92:95], v[244:247], v[140:143], v[92:95]
    ds_read_b64_tr_b16 v[132:133], v8 offset:51280
    v_mfma_f32_16x16x32_bf16 v[92:95], v[236:239], v[136:139], v[92:95]
    ds_read_b64_tr_b16 v[134:135], v8 offset:52560
    s_waitcnt lgkmcnt(6)
    v_mfma_f32_16x16x32_bf16 v[76:79], v[232:235], v[144:147], v[76:79]
    ds_read_b64_tr_b16 v[136:137], v8 offset:41080
    s_waitcnt lgkmcnt(5)
    v_mfma_f32_16x16x32_bf16 v[76:79], v[240:243], v[148:151], v[76:79]
    ds_read_b64_tr_b16 v[138:139], v8 offset:42360
    v_mfma_f32_16x16x32_bf16 v[96:99], v[244:247], v[148:151], v[96:99]
    ds_read_b64_tr_b16 v[140:141], v8 offset:51320
    v_mfma_f32_16x16x32_bf16 v[96:99], v[236:239], v[144:147], v[96:99]
    ds_read_b64_tr_b16 v[142:143], v8 offset:52600
    s_waitcnt lgkmcnt(6)
    v_mfma_f32_16x16x32_bf16 v[80:83], v[232:235], v[128:131], v[80:83]
    ds_read_b64_tr_b16 v[144:145], v10 offset:40960
    s_waitcnt lgkmcnt(5)
    v_mfma_f32_16x16x32_bf16 v[80:83], v[240:243], v[132:135], v[80:83]
    ds_read_b64_tr_b16 v[146:147], v10 offset:42240
    v_mfma_f32_16x16x32_bf16 v[100:103], v[244:247], v[132:135], v[100:103]
    ds_read_b64_tr_b16 v[148:149], v10 offset:51200
    v_mfma_f32_16x16x32_bf16 v[100:103], v[236:239], v[128:131], v[100:103]
    ds_read_b64_tr_b16 v[150:151], v10 offset:52480
    s_waitcnt lgkmcnt(6)
    v_mfma_f32_16x16x32_bf16 v[84:87], v[232:235], v[136:139], v[84:87]
    s_barrier
    ds_read_b128 v[112:115], v4 offset:49152
    ds_read_b128 v[120:123], v5 offset:49152
    ds_read_b64_tr_b16 v[128:129], v7 offset:0
    s_waitcnt lgkmcnt(7)
    v_mfma_f32_16x16x32_bf16 v[84:87], v[240:243], v[140:143], v[84:87]
    s_nop 0
    ds_read_b64_tr_b16 v[130:131], v7 offset:1280
    v_mfma_f32_16x16x32_bf16 v[104:107], v[244:247], v[140:143], v[104:107]
    ds_read_b128 v[124:127], v5 offset:51200
    ds_read_b128 v[116:119], v4 offset:51200
    ds_read_b64_tr_b16 v[132:133], v7 offset:10240
    v_mfma_f32_16x16x32_bf16 v[104:107], v[236:239], v[136:139], v[104:107]
    ds_read_b64_tr_b16 v[134:135], v7 offset:11520
    s_waitcnt lgkmcnt(10)
    v_mfma_f32_16x16x32_bf16 v[88:91], v[232:235], v[144:147], v[88:91]
    ds_read_b64_tr_b16 v[136:137], v7 offset:8
    s_waitcnt lgkmcnt(9)
    v_mfma_f32_16x16x32_bf16 v[88:91], v[240:243], v[148:151], v[88:91]
    ds_read_b64_tr_b16 v[138:139], v7 offset:1288
    v_mfma_f32_16x16x32_bf16 v[108:111], v[244:247], v[148:151], v[108:111]
    ds_read_b64_tr_b16 v[140:141], v7 offset:10248
    v_mfma_f32_16x16x32_bf16 v[108:111], v[236:239], v[144:147], v[108:111]
    ds_read_b64_tr_b16 v[142:143], v7 offset:11528
    s_waitcnt lgkmcnt(8)
    v_mfma_f32_16x16x32_bf16 v[32:35], v[128:131], v[112:115], v[32:35]
    ds_read_b64_tr_b16 v[144:145], v7 offset:16
    s_waitcnt lgkmcnt(5)
    v_mfma_f32_16x16x32_bf16 v[32:35], v[132:135], v[120:123], v[32:35]
    ds_read_b64_tr_b16 v[146:147], v7 offset:1296
    v_mfma_f32_16x16x32_bf16 v[52:55], v[132:135], v[124:127], v[52:55]
    ds_read_b32 v226, v226
    ds_read_b64_tr_b16 v[148:149], v7 offset:10256
    v_mfma_f32_16x16x32_bf16 v[52:55], v[128:131], v[116:119], v[52:55]
    ds_read_b64_tr_b16 v[150:151], v7 offset:11536
    s_waitcnt lgkmcnt(7)
    v_mfma_f32_16x16x32_bf16 v[36:39], v[136:139], v[112:115], v[36:39]
    ds_read_b64_tr_b16 v[128:129], v7 offset:24
    s_waitcnt lgkmcnt(6)
    v_mfma_f32_16x16x32_bf16 v[36:39], v[140:143], v[120:123], v[36:39]
    ds_read_b64_tr_b16 v[130:131], v7 offset:1304
    v_mfma_f32_16x16x32_bf16 v[56:59], v[140:143], v[124:127], v[56:59]
    ds_read_b64_tr_b16 v[132:133], v7 offset:10264
    v_mfma_f32_16x16x32_bf16 v[56:59], v[136:139], v[116:119], v[56:59]
    ds_read_b64_tr_b16 v[134:135], v7 offset:11544
    s_waitcnt lgkmcnt(7)
    v_mfma_f32_16x16x32_bf16 v[40:43], v[144:147], v[112:115], v[40:43]
    ds_read_b64_tr_b16 v[136:137], v7 offset:32
    s_waitcnt lgkmcnt(5)
    v_mfma_f32_16x16x32_bf16 v[40:43], v[148:151], v[120:123], v[40:43]
    ds_read_b64_tr_b16 v[138:139], v7 offset:1312
    v_mfma_f32_16x16x32_bf16 v[60:63], v[148:151], v[124:127], v[60:63]
    ds_read_b64_tr_b16 v[140:141], v7 offset:10272
    v_mfma_f32_16x16x32_bf16 v[60:63], v[144:147], v[116:119], v[60:63]
    ds_read_b64_tr_b16 v[142:143], v7 offset:11552
    s_waitcnt lgkmcnt(6)
    v_mfma_f32_16x16x32_bf16 v[44:47], v[128:131], v[112:115], v[44:47]
    ds_read_b64_tr_b16 v[144:145], v9 offset:0
    s_waitcnt lgkmcnt(5)
    v_mfma_f32_16x16x32_bf16 v[44:47], v[132:135], v[120:123], v[44:47]
    ds_read_b64_tr_b16 v[146:147], v9 offset:1280
    v_mfma_f32_16x16x32_bf16 v[64:67], v[132:135], v[124:127], v[64:67]
    ds_read_b64_tr_b16 v[148:149], v9 offset:10240
    v_mfma_f32_16x16x32_bf16 v[64:67], v[128:131], v[116:119], v[64:67]
    ds_read_b64_tr_b16 v[150:151], v9 offset:11520
    s_waitcnt lgkmcnt(6)
    v_mfma_f32_16x16x32_bf16 v[48:51], v[136:139], v[112:115], v[48:51]
    ds_read_b64_tr_b16 v[128:129], v9 offset:40
    s_waitcnt lgkmcnt(5)
    v_mfma_f32_16x16x32_bf16 v[48:51], v[140:143], v[120:123], v[48:51]
    ds_read_b64_tr_b16 v[130:131], v9 offset:1320
    v_mfma_f32_16x16x32_bf16 v[68:71], v[140:143], v[124:127], v[68:71]
    v_readfirstlane_b32 s68, v226
    ds_read_b64_tr_b16 v[132:133], v9 offset:10280
    v_mfma_f32_16x16x32_bf16 v[68:71], v[136:139], v[116:119], v[68:71]
    ds_read_b64_tr_b16 v[134:135], v9 offset:11560
    s_waitcnt lgkmcnt(6)
    v_mfma_f32_16x16x32_bf16 v[72:75], v[112:115], v[144:147], v[72:75]
    ds_read_b64_tr_b16 v[136:137], v9 offset:80
    v_cvt_pk_bf16_f32 v232, v32, v33
    s_waitcnt lgkmcnt(5)
    v_mfma_f32_16x16x32_bf16 v[72:75], v[120:123], v[148:151], v[72:75]
    s_nop 0
    ds_read_b64_tr_b16 v[138:139], v9 offset:1360
    v_cvt_pk_bf16_f32 v244, v52, v53
    v_mfma_f32_16x16x32_bf16 v[92:95], v[124:127], v[148:151], v[92:95]
    ds_read_b64_tr_b16 v[140:141], v9 offset:10320
    v_cvt_pk_bf16_f32 v233, v34, v35
    v_mfma_f32_16x16x32_bf16 v[92:95], v[116:119], v[144:147], v[92:95]
    ds_read_b64_tr_b16 v[142:143], v9 offset:11600
    v_cvt_pk_bf16_f32 v245, v54, v55
    s_waitcnt lgkmcnt(6)
    v_mfma_f32_16x16x32_bf16 v[76:79], v[112:115], v[128:131], v[76:79]
    ds_read_b64_tr_b16 v[144:145], v9 offset:120
    v_cvt_pk_bf16_f32 v234, v36, v37
    s_waitcnt lgkmcnt(5)
    v_mfma_f32_16x16x32_bf16 v[76:79], v[120:123], v[132:135], v[76:79]
    ds_read_b64_tr_b16 v[146:147], v9 offset:1400
    v_cvt_pk_bf16_f32 v246, v56, v57
    v_mfma_f32_16x16x32_bf16 v[96:99], v[124:127], v[132:135], v[96:99]
    ds_read_b64_tr_b16 v[148:149], v9 offset:10360
    v_cvt_pk_bf16_f32 v235, v38, v39
    v_mfma_f32_16x16x32_bf16 v[96:99], v[116:119], v[128:131], v[96:99]
    ds_read_b64_tr_b16 v[150:151], v9 offset:11640
    v_cvt_pk_bf16_f32 v247, v58, v59
    s_waitcnt lgkmcnt(6)
    v_mfma_f32_16x16x32_bf16 v[80:83], v[112:115], v[136:139], v[80:83]
    ds_read_b64_tr_b16 v[128:129], v11 offset:0
    v_cvt_pk_bf16_f32 v236, v40, v41
    s_waitcnt lgkmcnt(5)
    v_mfma_f32_16x16x32_bf16 v[80:83], v[120:123], v[140:143], v[80:83]
    ds_read_b64_tr_b16 v[130:131], v11 offset:1280
    v_cvt_pk_bf16_f32 v248, v60, v61
    v_mfma_f32_16x16x32_bf16 v[100:103], v[124:127], v[140:143], v[100:103]
    ds_read_b64_tr_b16 v[132:133], v11 offset:10240
    v_cvt_pk_bf16_f32 v237, v42, v43
    v_mfma_f32_16x16x32_bf16 v[100:103], v[116:119], v[136:139], v[100:103]
    ds_read_b64_tr_b16 v[134:135], v11 offset:11520
    v_cvt_pk_bf16_f32 v249, v62, v63
    s_waitcnt lgkmcnt(6)
    v_mfma_f32_16x16x32_bf16 v[84:87], v[112:115], v[144:147], v[84:87]
    v_cvt_pk_bf16_f32 v238, v44, v45
    s_waitcnt lgkmcnt(4)
    v_mfma_f32_16x16x32_bf16 v[84:87], v[120:123], v[148:151], v[84:87]
    v_cvt_pk_bf16_f32 v250, v64, v65
    v_mfma_f32_16x16x32_bf16 v[104:107], v[124:127], v[148:151], v[104:107]
    v_cvt_pk_bf16_f32 v239, v46, v47
    v_mfma_f32_16x16x32_bf16 v[104:107], v[116:119], v[144:147], v[104:107]
    v_cvt_pk_bf16_f32 v251, v66, v67
    s_waitcnt lgkmcnt(2)
    v_mfma_f32_16x16x32_bf16 v[88:91], v[112:115], v[128:131], v[88:91]
    v_cvt_pk_bf16_f32 v240, v48, v49
    s_waitcnt lgkmcnt(0)
    v_mfma_f32_16x16x32_bf16 v[88:91], v[120:123], v[132:135], v[88:91]
    v_cvt_pk_bf16_f32 v252, v68, v69
    v_mfma_f32_16x16x32_bf16 v[108:111], v[124:127], v[132:135], v[108:111]
    s_waitcnt lgkmcnt(0)
    s_barrier
    v_cvt_pk_bf16_f32 v241, v50, v51
    v_mfma_f32_16x16x32_bf16 v[108:111], v[116:119], v[128:131], v[108:111]
    v_cvt_pk_bf16_f32 v253, v70, v71
    v_mfma_f32_16x16x16_bf16 v[32:35], v[168:169], v[240:241], 0
    v_mfma_f32_16x16x16_bf16 v[36:39], v[178:179], v[240:241], 0
    v_cvt_pk_bf16_f32 v24, v72, v73
    v_mfma_f32_16x16x16_bf16 v[40:43], v[188:189], v[240:241], 0
    v_cvt_pk_bf16_f32 v25, v74, v75
    v_cvt_pk_bf16_f32 v26, v92, v93
    v_mfma_f32_16x16x16_bf16 v[44:47], v[198:199], v[240:241], 0
    v_cvt_pk_bf16_f32 v27, v94, v95
    ds_write_b128 v212, v[24:27] offset:0
    v_mfma_f32_16x16x16_bf16 v[48:51], v[208:209], v[240:241], 0
    v_cvt_pk_bf16_f32 v28, v76, v77
    v_cvt_pk_bf16_f32 v29, v78, v79
    v_mfma_f32_16x16x32_bf16 v[32:35], v[160:163], v[232:235], v[32:35]
    v_cvt_pk_bf16_f32 v30, v96, v97
    v_cvt_pk_bf16_f32 v31, v98, v99
    v_mfma_f32_16x16x32_bf16 v[32:35], v[164:167], v[236:239], v[32:35]
    ds_write_b128 v212, v[28:31] offset:1024
    v_cvt_pk_bf16_f32 v24, v80, v81
    v_mfma_f32_16x16x32_bf16 v[36:39], v[170:173], v[232:235], v[36:39]
    v_cvt_pk_bf16_f32 v25, v82, v83
    v_mfma_f32_16x16x32_bf16 v[36:39], v[174:177], v[236:239], v[36:39]
    v_cvt_pk_bf16_f32 v26, v100, v101
    v_cvt_pk_bf16_f32 v27, v102, v103
    v_mfma_f32_16x16x32_bf16 v[40:43], v[180:183], v[232:235], v[40:43]
    ds_write_b128 v212, v[24:27] offset:2048
    v_cvt_pk_bf16_f32 v28, v84, v85
    v_mfma_f32_16x16x32_bf16 v[40:43], v[184:187], v[236:239], v[40:43]
    v_cvt_pk_bf16_f32 v29, v86, v87
    v_cvt_pk_bf16_f32 v30, v104, v105
    v_mfma_f32_16x16x32_bf16 v[44:47], v[190:193], v[232:235], v[44:47]
    v_cvt_pk_bf16_f32 v31, v106, v107
    ds_write_b128 v212, v[28:31] offset:3072
    v_mfma_f32_16x16x32_bf16 v[44:47], v[194:197], v[236:239], v[44:47]
    v_cvt_pk_bf16_f32 v24, v88, v89
    v_cvt_pk_bf16_f32 v25, v90, v91
    v_mfma_f32_16x16x32_bf16 v[48:51], v[200:203], v[232:235], v[48:51]
    v_cvt_pk_bf16_f32 v26, v108, v109
    v_cvt_pk_bf16_f32 v27, v110, v111
    v_mfma_f32_16x16x32_bf16 v[48:51], v[204:207], v[236:239], v[48:51]
    ds_write_b128 v212, v[24:27] offset:4096
    v_exp_f32_e64 v112, v32
    v_mfma_f32_16x16x16_bf16 v[52:55], v[168:169], v[252:253], 0
    v_exp_f32 v132, -v32
    v_mfma_f32_16x16x16_bf16 v[56:59], v[178:179], v[252:253], 0
    v_exp_f32_e64 v113, v33
    v_mfma_f32_16x16x16_bf16 v[60:63], v[188:189], v[252:253], 0
    v_exp_f32 v133, -v33
    v_mfma_f32_16x16x16_bf16 v[64:67], v[198:199], v[252:253], 0
    v_exp_f32_e64 v114, v34
    v_mfma_f32_16x16x16_bf16 v[68:71], v[208:209], v[252:253], 0
    v_exp_f32 v134, -v34
    v_mfma_f32_16x16x32_bf16 v[52:55], v[160:163], v[244:247], v[52:55]
    v_exp_f32_e64 v115, v35
    v_mfma_f32_16x16x32_bf16 v[52:55], v[164:167], v[248:251], v[52:55]
    v_exp_f32 v135, -v35
    v_mfma_f32_16x16x32_bf16 v[56:59], v[170:173], v[244:247], v[56:59]
    v_exp_f32_e64 v116, v36
    v_mfma_f32_16x16x32_bf16 v[56:59], v[174:177], v[248:251], v[56:59]
    v_exp_f32 v136, -v36
    v_mfma_f32_16x16x32_bf16 v[60:63], v[180:183], v[244:247], v[60:63]
    v_exp_f32_e64 v117, v37
    v_mfma_f32_16x16x32_bf16 v[60:63], v[184:187], v[248:251], v[60:63]
    v_exp_f32 v137, -v37
    v_mfma_f32_16x16x32_bf16 v[64:67], v[190:193], v[244:247], v[64:67]
    v_exp_f32_e64 v118, v38
    v_mfma_f32_16x16x32_bf16 v[64:67], v[194:197], v[248:251], v[64:67]
    v_exp_f32 v138, -v38
    v_mfma_f32_16x16x32_bf16 v[68:71], v[200:203], v[244:247], v[68:71]
    v_exp_f32_e64 v119, v39
    v_mfma_f32_16x16x32_bf16 v[68:71], v[204:207], v[248:251], v[68:71]
    v_exp_f32 v139, -v39
    v_exp_f32_e64 v120, v40
    v_exp_f32 v140, -v40
    v_exp_f32_e64 v121, v41
    v_exp_f32 v141, -v41
    v_exp_f32_e64 v122, v42
    v_exp_f32 v142, -v42
    v_exp_f32_e64 v123, v43
    v_exp_f32 v143, -v43
    v_exp_f32_e64 v124, v44
    v_exp_f32 v144, -v44
    v_exp_f32_e64 v125, v45
    v_exp_f32 v145, -v45
    v_exp_f32_e64 v126, v46
    v_exp_f32 v146, -v46
    v_exp_f32_e64 v127, v47
    v_exp_f32 v147, -v47
    v_exp_f32_e64 v128, v48
    v_exp_f32 v148, -v48
    v_exp_f32_e64 v129, v49
    v_exp_f32 v149, -v49
    v_exp_f32_e64 v130, v50
    v_exp_f32 v150, -v50
    v_exp_f32_e64 v131, v51
    v_exp_f32 v151, -v51
    v_exp_f32_e64 v72, v52
    v_exp_f32 v92, -v52
    v_exp_f32_e64 v73, v53
    v_exp_f32 v93, -v53
    v_exp_f32_e64 v74, v54
    v_exp_f32 v94, -v54
    v_exp_f32_e64 v75, v55
    v_exp_f32 v95, -v55
    v_exp_f32_e64 v76, v56
    v_exp_f32 v96, -v56
    v_exp_f32_e64 v77, v57
    v_exp_f32 v97, -v57
    v_exp_f32_e64 v78, v58
    v_exp_f32 v98, -v58
    v_exp_f32_e64 v79, v59
    v_exp_f32 v99, -v59
    v_exp_f32_e64 v80, v60
    v_exp_f32 v100, -v60
    v_exp_f32_e64 v81, v61
    v_exp_f32 v101, -v61
    v_exp_f32_e64 v82, v62
    v_exp_f32 v102, -v62
    v_exp_f32_e64 v83, v63
    v_exp_f32 v103, -v63
    v_exp_f32_e64 v84, v64
    v_exp_f32 v104, -v64
    v_exp_f32_e64 v85, v65
    v_exp_f32 v105, -v65
    v_exp_f32_e64 v86, v66
    v_exp_f32 v106, -v66
    v_exp_f32_e64 v87, v67
    v_exp_f32 v107, -v67
    v_exp_f32_e64 v88, v68
    v_exp_f32 v108, -v68
    v_exp_f32_e64 v89, v69
    v_exp_f32 v109, -v69
    v_exp_f32_e64 v90, v70
    v_exp_f32 v110, -v70
    v_exp_f32_e64 v91, v71
    v_exp_f32 v111, -v71
    v_pk_add_f32 v[16:17], v[112:113], v[114:115]
    v_pk_add_f32 v[18:19], v[132:133], v[134:135]
    v_pk_add_f32 v[16:17], v[16:17], v[116:117]
    v_pk_add_f32 v[18:19], v[18:19], v[136:137]
    v_pk_add_f32 v[16:17], v[16:17], v[118:119]
    v_pk_add_f32 v[18:19], v[18:19], v[138:139]
    v_pk_add_f32 v[16:17], v[16:17], v[120:121]
    v_pk_add_f32 v[18:19], v[18:19], v[140:141]
    v_pk_add_f32 v[16:17], v[16:17], v[122:123]
    v_pk_add_f32 v[18:19], v[18:19], v[142:143]
    v_pk_add_f32 v[16:17], v[16:17], v[124:125]
    v_pk_add_f32 v[18:19], v[18:19], v[144:145]
    v_pk_add_f32 v[16:17], v[16:17], v[126:127]
    v_pk_add_f32 v[18:19], v[18:19], v[146:147]
    v_pk_add_f32 v[16:17], v[16:17], v[128:129]
    v_pk_add_f32 v[18:19], v[18:19], v[148:149]
    v_pk_add_f32 v[16:17], v[16:17], v[130:131]
    v_pk_add_f32 v[18:19], v[18:19], v[150:151]
    v_add_f32 v16, v16, v17
    v_add_f32 v18, v18, v19
    v_pk_add_f32 v[20:21], v[72:73], v[74:75]
    v_pk_add_f32 v[22:23], v[92:93], v[94:95]
    v_pk_add_f32 v[20:21], v[20:21], v[76:77]
    v_pk_add_f32 v[22:23], v[22:23], v[96:97]
    v_pk_add_f32 v[20:21], v[20:21], v[78:79]
    v_pk_add_f32 v[22:23], v[22:23], v[98:99]
    v_pk_add_f32 v[20:21], v[20:21], v[80:81]
    v_pk_add_f32 v[22:23], v[22:23], v[100:101]
    v_pk_add_f32 v[20:21], v[20:21], v[82:83]
    v_pk_add_f32 v[22:23], v[22:23], v[102:103]
    v_pk_add_f32 v[20:21], v[20:21], v[84:85]
    v_pk_add_f32 v[22:23], v[22:23], v[104:105]
    v_pk_add_f32 v[20:21], v[20:21], v[86:87]
    v_pk_add_f32 v[22:23], v[22:23], v[106:107]
    v_pk_add_f32 v[20:21], v[20:21], v[88:89]
    v_pk_add_f32 v[22:23], v[22:23], v[108:109]
    v_pk_add_f32 v[20:21], v[20:21], v[90:91]
    v_pk_add_f32 v[22:23], v[22:23], v[110:111]
    v_add_f32 v20, v20, v21
    v_add_f32 v22, v22, v23
    v_max3_f32 v17, v16, v18, v20
    v_max_f32_e64 v17, v17, v22
    v_cmp_lt_f32 vcc, 0x5d800000, v17
    s_nop 0
    s_cbranch_vccnz L_kslow_47
L_kback_48:
    v_rcp_f32 v16, v16
    v_rcp_f32 v18, v18
    v_rcp_f32 v20, v20
    v_rcp_f32 v22, v22
    v_pk_mul_f32 v[112:113], v[112:113], v[16:17] op_sel_hi:[1,0]
    v_pk_mul_f32 v[114:115], v[114:115], v[16:17] op_sel_hi:[1,0]
    v_pk_mul_f32 v[116:117], v[116:117], v[16:17] op_sel_hi:[1,0]
    v_pk_mul_f32 v[118:119], v[118:119], v[16:17] op_sel_hi:[1,0]
    v_cvt_pk_bf16_f32 v24, v112, v113
    v_cvt_pk_bf16_f32 v25, v114, v115
    v_cvt_pk_bf16_f32 v26, v116, v117
    v_cvt_pk_bf16_f32 v27, v118, v119
    ds_write_b128 v213, v[24:27] offset:0
    v_pk_mul_f32 v[120:121], v[120:121], v[16:17] op_sel_hi:[1,0]
    v_pk_mul_f32 v[122:123], v[122:123], v[16:17] op_sel_hi:[1,0]
    v_pk_mul_f32 v[124:125], v[124:125], v[16:17] op_sel_hi:[1,0]
    v_pk_mul_f32 v[126:127], v[126:127], v[16:17] op_sel_hi:[1,0]
    v_cvt_pk_bf16_f32 v28, v120, v121
    v_cvt_pk_bf16_f32 v29, v122, v123
    v_cvt_pk_bf16_f32 v30, v124, v125
    v_cvt_pk_bf16_f32 v31, v126, v127
    ds_write_b128 v220, v[28:31] offset:0
    v_pk_mul_f32 v[132:133], v[132:133], v[18:19] op_sel_hi:[1,0]
    v_pk_mul_f32 v[134:135], v[134:135], v[18:19] op_sel_hi:[1,0]
    v_pk_mul_f32 v[136:137], v[136:137], v[18:19] op_sel_hi:[1,0]
    v_pk_mul_f32 v[138:139], v[138:139], v[18:19] op_sel_hi:[1,0]
    v_cvt_pk_bf16_f32 v24, v132, v133
    v_cvt_pk_bf16_f32 v25, v134, v135
    v_cvt_pk_bf16_f32 v26, v136, v137
    v_cvt_pk_bf16_f32 v27, v138, v139
    ds_write_b128 v213, v[24:27] offset:4096
    v_pk_mul_f32 v[140:141], v[140:141], v[18:19] op_sel_hi:[1,0]
    v_pk_mul_f32 v[142:143], v[142:143], v[18:19] op_sel_hi:[1,0]
    v_pk_mul_f32 v[144:145], v[144:145], v[18:19] op_sel_hi:[1,0]
    v_pk_mul_f32 v[146:147], v[146:147], v[18:19] op_sel_hi:[1,0]
    v_cvt_pk_bf16_f32 v28, v140, v141
    v_cvt_pk_bf16_f32 v29, v142, v143
    v_cvt_pk_bf16_f32 v30, v144, v145
    v_cvt_pk_bf16_f32 v31, v146, v147
    ds_write_b128 v220, v[28:31] offset:4096
    v_pk_mul_f32 v[128:129], v[128:129], v[16:17] op_sel_hi:[1,0]
    v_pk_mul_f32 v[130:131], v[130:131], v[16:17] op_sel_hi:[1,0]
    v_pk_mul_f32 v[148:149], v[148:149], v[18:19] op_sel_hi:[1,0]
    v_pk_mul_f32 v[150:151], v[150:151], v[18:19] op_sel_hi:[1,0]
    v_cvt_pk_bf16_f32 v24, v128, v129
    v_cvt_pk_bf16_f32 v25, v130, v131
    v_cvt_pk_bf16_f32 v26, v148, v149
    v_cvt_pk_bf16_f32 v27, v150, v151
    ds_write_b128 v221, v[24:27] offset:8192
    v_pk_mul_f32 v[72:73], v[72:73], v[20:21] op_sel_hi:[1,0]
    v_pk_mul_f32 v[74:75], v[74:75], v[20:21] op_sel_hi:[1,0]
    v_pk_mul_f32 v[76:77], v[76:77], v[20:21] op_sel_hi:[1,0]
    v_pk_mul_f32 v[78:79], v[78:79], v[20:21] op_sel_hi:[1,0]
    v_cvt_pk_bf16_f32 v24, v72, v73
    v_cvt_pk_bf16_f32 v25, v74, v75
    v_cvt_pk_bf16_f32 v26, v76, v77
    v_cvt_pk_bf16_f32 v27, v78, v79
    ds_write_b128 v213, v[24:27] offset:512
    v_pk_mul_f32 v[80:81], v[80:81], v[20:21] op_sel_hi:[1,0]
    v_pk_mul_f32 v[82:83], v[82:83], v[20:21] op_sel_hi:[1,0]
    v_pk_mul_f32 v[84:85], v[84:85], v[20:21] op_sel_hi:[1,0]
    v_pk_mul_f32 v[86:87], v[86:87], v[20:21] op_sel_hi:[1,0]
    v_cvt_pk_bf16_f32 v28, v80, v81
    v_cvt_pk_bf16_f32 v29, v82, v83
    v_cvt_pk_bf16_f32 v30, v84, v85
    v_cvt_pk_bf16_f32 v31, v86, v87
    ds_write_b128 v220, v[28:31] offset:512
    v_pk_mul_f32 v[92:93], v[92:93], v[22:23] op_sel_hi:[1,0]
    v_pk_mul_f32 v[94:95], v[94:95], v[22:23] op_sel_hi:[1,0]
    v_pk_mul_f32 v[96:97], v[96:97], v[22:23] op_sel_hi:[1,0]
    v_pk_mul_f32 v[98:99], v[98:99], v[22:23] op_sel_hi:[1,0]
    v_cvt_pk_bf16_f32 v24, v92, v93
    v_cvt_pk_bf16_f32 v25, v94, v95
    v_cvt_pk_bf16_f32 v26, v96, v97
    v_cvt_pk_bf16_f32 v27, v98, v99
    ds_write_b128 v213, v[24:27] offset:4608
    v_pk_mul_f32 v[100:101], v[100:101], v[22:23] op_sel_hi:[1,0]
    v_pk_mul_f32 v[102:103], v[102:103], v[22:23] op_sel_hi:[1,0]
    v_pk_mul_f32 v[104:105], v[104:105], v[22:23] op_sel_hi:[1,0]
    v_pk_mul_f32 v[106:107], v[106:107], v[22:23] op_sel_hi:[1,0]
    v_cvt_pk_bf16_f32 v28, v100, v101
    v_cvt_pk_bf16_f32 v29, v102, v103
    v_cvt_pk_bf16_f32 v30, v104, v105
    v_cvt_pk_bf16_f32 v31, v106, v107
    ds_write_b128 v220, v[28:31] offset:4608
    v_pk_mul_f32 v[88:89], v[88:89], v[20:21] op_sel_hi:[1,0]
    v_pk_mul_f32 v[90:91], v[90:91], v[20:21] op_sel_hi:[1,0]
    v_pk_mul_f32 v[108:109], v[108:109], v[22:23] op_sel_hi:[1,0]
    v_pk_mul_f32 v[110:111], v[110:111], v[22:23] op_sel_hi:[1,0]
    v_cvt_pk_bf16_f32 v24, v88, v89
    v_cvt_pk_bf16_f32 v25, v90, v91
    v_cvt_pk_bf16_f32 v26, v108, v109
    v_cvt_pk_bf16_f32 v27, v110, v111
    ds_write_b128 v221, v[24:27] offset:8448
    v_mov_b32 v16, 0x3f803f80
    v_mov_b32 v17, 1
    s_waitcnt lgkmcnt(0)
    s_setprio 3
    s_barrier
    ds_read_b128 v[80:83], v216 offset:0
    ds_read_b64_tr_b16 v[32:33], v214 offset:0
    ds_read_b64_tr_b16 v[34:35], v214 offset:512
    ds_read_b128 v[84:87], v217 offset:0
    ds_read_b64_tr_b16 v[36:37], v214 offset:4096
    ds_read_b64_tr_b16 v[38:39], v214 offset:4608
    ds_read_b64_tr_b16 v[40:41], v215 offset:8192
    ds_read_b64_tr_b16 v[42:43], v215 offset:8448
    ds_read_b128 v[88:91], v216 offset:5120
    ds_read_b64_tr_b16 v[44:45], v214 offset:1024
    ds_read_b64_tr_b16 v[46:47], v214 offset:1536
    ds_read_b128 v[92:95], v217 offset:5120
    s_waitcnt lgkmcnt(9)
    v_mfma_f32_16x16x32_bf16 v[112:115], v[32:35], v[80:83], 0
    ds_read_b64_tr_b16 v[48:49], v214 offset:5120
    s_waitcnt lgkmcnt(9)
    v_cndmask_b32 v84, v16, v84, s[48:49]
    ds_read_b64_tr_b16 v[50:51], v214 offset:5632
    v_cndmask_b32 v85, v16, v85, s[48:49]
    ds_read_b64_tr_b16 v[52:53], v215 offset:8704
    s_waitcnt lgkmcnt(9)
    s_nop 0
    v_mfma_f32_16x16x32_bf16 v[116:119], v[36:39], v[80:83], 0
    ds_read_b64_tr_b16 v[54:55], v215 offset:8960
    v_cndmask_b32 v86, v16, v86, s[48:49]
    v_cndmask_b32 v87, v16, v87, s[48:49]
    ds_read_b128 v[96:99], v216 offset:10240
    s_waitcnt lgkmcnt(9)
    v_mfma_f32_16x16x32_bf16 v[120:123], v[40:43], v[80:83], 0
    ds_read_b64_tr_b16 v[56:57], v214 offset:2048
    v_mfma_f32_16x16x32_bf16 v[124:127], v[32:35], v[84:87], 0
    ds_read_b64_tr_b16 v[58:59], v214 offset:2560
    v_mfma_f32_16x16x32_bf16 v[128:131], v[36:39], v[84:87], 0
    ds_read_b128 v[100:103], v217 offset:10240
    v_mfma_f32_16x16x32_bf16 v[132:135], v[40:43], v[84:87], 0
    s_waitcnt lgkmcnt(9)
    s_branch L_over_kv_4
L_warm_kv_4:
    s_branch L_warmed_kv
L_over_kv_4:
    v_mfma_f32_16x16x32_bf16 v[112:115], v[44:47], v[88:91], v[112:115]
    ds_read_b64_tr_b16 v[60:61], v214 offset:6144
    s_waitcnt lgkmcnt(9)
    v_cndmask_b32 v92, v16, v92, s[48:49]
    ds_read_b64_tr_b16 v[62:63], v214 offset:6656
    v_cndmask_b32 v93, v16, v93, s[48:49]
    ds_read_b64_tr_b16 v[64:65], v215 offset:9216
    s_waitcnt lgkmcnt(9)
    v_mfma_f32_16x16x32_bf16 v[116:119], v[48:51], v[88:91], v[116:119]
    ds_read_b64_tr_b16 v[66:67], v215 offset:9472
    v_cndmask_b32 v94, v16, v94, s[48:49]
    v_cndmask_b32 v95, v16, v95, s[48:49]
    ds_read_b128 v[104:107], v216 offset:15360
    s_waitcnt lgkmcnt(9)
    v_mfma_f32_16x16x32_bf16 v[120:123], v[52:55], v[88:91], v[120:123]
    ds_read_b64_tr_b16 v[68:69], v214 offset:3072
    v_mfma_f32_16x16x32_bf16 v[124:127], v[44:47], v[92:95], v[124:127]
    ds_read_b64_tr_b16 v[70:71], v214 offset:3584
    v_mfma_f32_16x16x32_bf16 v[128:131], v[48:51], v[92:95], v[128:131]
    ds_read_b128 v[108:111], v217 offset:15360
    v_mfma_f32_16x16x32_bf16 v[132:135], v[52:55], v[92:95], v[132:135]
    s_waitcnt lgkmcnt(9)
    v_mfma_f32_16x16x32_bf16 v[112:115], v[56:59], v[96:99], v[112:115]
    ds_read_b64_tr_b16 v[72:73], v214 offset:7168
    s_waitcnt lgkmcnt(9)
    v_cndmask_b32 v100, v16, v100, s[48:49]
    v_cndmask_b32 v101, v16, v101, s[48:49]
    s_waitcnt lgkmcnt(7)
    v_mfma_f32_16x16x32_bf16 v[116:119], v[60:63], v[96:99], v[116:119]
    ds_read_b64_tr_b16 v[74:75], v214 offset:7680
    v_cndmask_b32 v102, v16, v102, s[48:49]
    v_cndmask_b32 v103, v16, v103, s[48:49]
    ds_read_b64_tr_b16 v[76:77], v215 offset:9728
    s_waitcnt lgkmcnt(7)
    v_mfma_f32_16x16x32_bf16 v[120:123], v[64:67], v[96:99], v[120:123]
    v_mfma_f32_16x16x32_bf16 v[124:127], v[56:59], v[100:103], v[124:127]
    v_mfma_f32_16x16x32_bf16 v[128:131], v[60:63], v[100:103], v[128:131]
    ds_read_b64_tr_b16 v[78:79], v215 offset:9984
    v_mfma_f32_16x16x32_bf16 v[132:135], v[64:67], v[100:103], v[132:135]
    s_waitcnt lgkmcnt(5)
    v_mfma_f32_16x16x32_bf16 v[112:115], v[68:71], v[104:107], v[112:115]
    s_waitcnt lgkmcnt(4)
    v_cndmask_b32 v108, v16, v108, s[48:49]
    v_cndmask_b32 v109, v16, v109, s[48:49]
    s_waitcnt lgkmcnt(2)
    v_mfma_f32_16x16x32_bf16 v[116:119], v[72:75], v[104:107], v[116:119]
    v_cndmask_b32 v110, v16, v110, s[48:49]
    v_cndmask_b32 v111, v16, v111, s[48:49]
    s_waitcnt lgkmcnt(0)
    v_mfma_f32_16x16x32_bf16 v[120:123], v[76:79], v[104:107], v[120:123]
    v_mfma_f32_16x16x32_bf16 v[124:127], v[68:71], v[108:111], v[124:127]
    v_mfma_f32_16x16x32_bf16 v[128:131], v[72:75], v[108:111], v[128:131]
    v_mfma_f32_16x16x32_bf16 v[132:135], v[76:79], v[108:111], v[132:135]
    s_cmp_eq_u32 s68, 0
    s_cbranch_scc1 L_glob_49
    s_nop 0
    v_cvt_pk_bf16_f32 v136, v112, v113
    v_cvt_pk_bf16_f32 v137, v114, v115
    v_cvt_pk_bf16_f32 v138, v116, v117
    v_cvt_pk_bf16_f32 v139, v118, v119
    global_store_dwordx4 v218, v[136:139], s[20:21] nt
    v_cvt_pk_bf16_f32 v144, v120, v121
    v_cvt_pk_bf16_f32 v145, v122, v123
    v_cvt_pk_bf16_f32 v140, v124, v125
    v_cvt_pk_bf16_f32 v141, v126, v127
    v_cvt_pk_bf16_f32 v142, v128, v129
    v_cvt_pk_bf16_f32 v143, v130, v131
    v_cvt_pk_bf16_f32 v146, v132, v133
    v_cvt_pk_bf16_f32 v147, v134, v135
    s_mov_b32 exec_lo, 0x00ff00ff
    s_mov_b32 exec_hi, 0x00ff00ff
    global_store_dwordx4 v219, v[140:143], s[20:21] offset:1024 nt
    s_mov_b32 exec_lo, -1
    s_mov_b32 exec_hi, 0
    global_store_dwordx4 v218, v[144:147], s[20:21] offset:1536 nt
    s_mov_b64 exec, 1
    s_waitcnt vmcnt(0)
    global_store_dword v222, v17, s[20:21] nt
    s_mov_b64 exec, -1
    s_branch L_mode_50
L_glob_49:
    s_nop 7
    s_nop 0
    v_cvt_pk_bf16_f32 v136, v112, v113
    v_cvt_pk_bf16_f32 v137, v114, v115
    v_cvt_pk_bf16_f32 v138, v116, v117
    v_cvt_pk_bf16_f32 v139, v118, v119
    global_store_dwordx4 v218, v[136:139], s[20:21] sc1
    v_cvt_pk_bf16_f32 v144, v120, v121
    v_cvt_pk_bf16_f32 v145, v122, v123
    v_cvt_pk_bf16_f32 v140, v124, v125
    v_cvt_pk_bf16_f32 v141, v126, v127
    v_cvt_pk_bf16_f32 v142, v128, v129
    v_cvt_pk_bf16_f32 v143, v130, v131
    v_cvt_pk_bf16_f32 v146, v132, v133
    v_cvt_pk_bf16_f32 v147, v134, v135
    s_mov_b32 exec_lo, 0x00ff00ff
    s_mov_b32 exec_hi, 0x00ff00ff
    global_store_dwordx4 v219, v[140:143], s[20:21] offset:1024 sc1
    s_mov_b32 exec_lo, -1
    s_mov_b32 exec_hi, 0
    global_store_dwordx4 v218, v[144:147], s[20:21] offset:1536 sc1
    s_mov_b64 exec, 1
    s_waitcnt vmcnt(0)
    global_store_dword v222, v17, s[20:21] sc1
    s_mov_b64 exec, -1
L_mode_50:
    s_mov_b64 exec, 65535
    s_mov_b32 s27, 0
L_poll_51:
    global_load_dword v18, v223, s[20:21] sc1
    s_waitcnt vmcnt(0)
    v_cmp_ne_u32_e64 vcc, 1, v18
    s_nop 0
    s_cbranch_vccz L_polled_52
    s_add_u32 s27, s27, 1
    s_cmp_lt_u32 s27, 262144
    s_cbranch_scc1 L_poll_51
L_polled_52:
    s_mov_b64 exec, -1
    global_load_dwordx4 v[36:39], v224, s[20:21] offset:0 sc1
    global_load_dwordx4 v[40:43], v224, s[20:21] offset:256 sc1
    v_add_u32 v224, 8192, v224
    global_load_dwordx4 v[44:47], v224, s[20:21] offset:0 sc1
    global_load_dwordx4 v[48:51], v224, s[20:21] offset:256 sc1
    v_add_u32 v224, 8192, v224
    global_load_dwordx4 v[52:55], v224, s[20:21] offset:0 sc1
    global_load_dwordx4 v[56:59], v224, s[20:21] offset:256 sc1
    v_add_u32 v224, 8192, v224
    global_load_dwordx4 v[60:63], v224, s[20:21] offset:0 sc1
    global_load_dwordx4 v[64:67], v224, s[20:21] offset:256 sc1
    s_waitcnt vmcnt(7)
    v_mfma_f32_16x16x32_bf16 v[32:35], v[152:155], v[36:39], 0
    s_waitcnt vmcnt(6)
    v_mfma_f32_16x16x32_bf16 v[32:35], v[156:159], v[40:43], v[32:35]
    s_waitcnt vmcnt(5)
    v_mfma_f32_16x16x32_bf16 v[32:35], v[152:155], v[44:47], v[32:35]
    s_waitcnt vmcnt(4)
    v_mfma_f32_16x16x32_bf16 v[32:35], v[156:159], v[48:51], v[32:35]
    s_waitcnt vmcnt(3)
    v_mfma_f32_16x16x32_bf16 v[32:35], v[152:155], v[52:55], v[32:35]
    s_waitcnt vmcnt(2)
    v_mfma_f32_16x16x32_bf16 v[32:35], v[156:159], v[56:59], v[32:35]
    s_waitcnt vmcnt(1)
    v_mfma_f32_16x16x32_bf16 v[32:35], v[152:155], v[60:63], v[32:35]
    s_waitcnt vmcnt(0)
    v_mfma_f32_16x16x32_bf16 v[32:35], v[156:159], v[64:67], v[32:35]
    s_nop 7
    v_cvt_pk_bf16_f32 v32, v32, v33
    v_cvt_pk_bf16_f32 v33, v34, v35
    ds_write_b64 v225, v[32:33]
    s_setprio 0
    s_waitcnt lgkmcnt(0)
    s_barrier
L_fcompute:
    v_and_b32 v1, 63, v0
    v_and_b32 v2, 15, v0
    v_bfe_u32 v3, v0, 4, 2
    s_and_b32 s40, s24, 1
    s_lshr_b32 s41, s24, 1
    s_lshl_b32 s42, s69, 1
    s_add_u32 s42, s42, s40
    s_lshl_b32 s42, s42, 1
    s_add_u32 s42, s42, s41
    s_mul_i32 s42, s42, 20480
    s_add_u32 s42, s42, 12587008
    v_lshl_add_u32 v14, v1, 4, s42
    v_mul_u32_u24 v15, 1280, v3
    v_lshl_add_u32 v15, v2, 4, v15
    v_add_u32 v15, s42, v15
    s_lshl_b32 s43, s40, 1
    s_add_u32 s43, s43, s41
    s_lshl_b32 s44, s69, 2
    s_add_u32 s44, s44, s43
    s_lshl_b32 s45, s69, 2
    s_add_u32 s45, s45, s24
    s_lshl_b32 s45, s45, 7
    s_add_u32 s45, s45, 16449536
    v_mov_b32 v17, s45
    v_mov_b32_e64 v19, 0
    s_mov_b32 s32, s20
    s_and_b32 s33, s21, 0xffff
    s_mov_b32 s34, 16252928
    s_mov_b32 s35, 0x20000
    s_branch L_fpage
.p2align 12
L_fpage:
    s_waitcnt vmcnt(0)
    s_barrier
    s_mov_b64 exec, 1
    s_mov_b32 s27, 0
    global_atomic_add v18, v17, v19, s[20:21] sc0 sc1
    s_mov_b64 exec, -1
    v_lshrrev_b32 v8, 2, v2
    v_and_b32 v9, 3, v2
    v_mul_u32_u24 v10, 40, v9
    s_mul_i32 s45, s41, 51200
    v_lshl_add_u32 v11, v3, 2, v8
    v_mul_u32_u24 v11, 160, v11
    v_add3_u32 v4, v11, v10, s45
    v_mul_u32_u24 v11, 20, v3
    v_add_u32 v11, v11, v8
    v_mul_u32_u24 v12, 160, v11
    v_add3_u32 v5, v12, v10, s45
    s_lshr_b32 s46, s24, 1
    s_add_u32 s46, s46, s23
    s_add_u32 s46, s46, 2
    s_and_b32 s46, s46, 3
    s_lshl_b32 s46, s46, 1
    s_and_b32 s39, s24, 1
    s_add_u32 s46, s46, s39
    s_mul_i32 s46, s46, 5120
    s_add_u32 s46, s46, 102400
    v_lshl_add_u32 v6, v1, 4, s46
    s_mul_i32 s45, s24, 2560
    s_add_u32 s45, s45, s71
    s_lshl_b32 s46, s43, 6
    s_add_u32 s45, s45, s46
    v_lshl_add_u32 v16, v2, 2, s45
    s_mul_i32 s45, s24, 5120
    s_add_u32 s45, s45, 143360
    v_lshl_add_u32 v7, v1, 4, s45
    s_xor_b32 s47, s24, 2
    s_mul_i32 s47, s47, 5120
    s_add_u32 s47, s47, 143360
    v_lshl_add_u32 v8, v1, 4, s47
    v_mul_u32_u24 v9, 176, v2
    v_mul_u32_u24 v10, 40, v3
    v_add3_u32 v9, v9, v10, s47
    s_mul_i32 s45, s44, 20480
    s_mul_i32 s46, s70, 160
    s_add_u32 s45, s45, s46
    s_movk_i32 s46, 1120
    v_mul_u32_u24 v10, 6554, v1
    v_lshrrev_b32_e64 v11, 16, v10
    v_lshl_add_u32 v248, v11, 4, v8
    v_lshl_add_u32 v12, v1, 4, s45
    v_mad_u32_u24 v252, v11, s46, v12
    v_add_u32 v10, 419456, v10
    s_add_u32 s45, s45, 1024
    v_lshrrev_b32_e64 v11, 16, v10
    v_lshl_add_u32 v249, v11, 4, v8
    v_lshl_add_u32 v12, v1, 4, s45
    v_mad_u32_u24 v253, v11, s46, v12
    v_add_u32 v10, 419456, v10
    s_add_u32 s45, s45, 1024
    v_lshrrev_b32_e64 v11, 16, v10
    v_lshl_add_u32 v250, v11, 4, v8
    v_lshl_add_u32 v12, v1, 4, s45
    v_mad_u32_u24 v254, v11, s46, v12
    v_add_u32 v5, 2560, v5
    s_and_b32 s47, s70, 2
    s_and_b32 s53, s70, 1
    s_and_b32 s45, s23, 3
    s_mul_i32 s45, s45, 2560
    s_add_u32 s45, s45, s24
    s_lshl_b32 s45, s45, 2
    s_add_u32 s45, s45, 106496
    v_mov_b32 v13, s45
    s_mov_b64 exec, 1
    s_branch L_pollw_55
L_poll_53:
    global_atomic_add v18, v17, v19, s[20:21] sc0 sc1
L_pollw_55:
    s_waitcnt vmcnt(0)
    v_readfirstlane_b32 s52, v18
    s_nop 0
    s_lshr_b32 s45, s52, 16
    s_and_b32 s52, s52, s45
    s_and_b32 s52, s52, 0x0404
    s_cmp_eq_u32 s52, 0
    s_cselect_b64 vcc, 1, 0
    s_cbranch_vccz L_polled_54
    s_add_u32 s27, s27, 1
    s_cmp_lt_u32 s27, 262144
    s_cbranch_scc1 L_poll_53
L_polled_54:
    s_mov_b32 s38, 0
L_fagain:
    s_mov_b64 exec, -1
    s_lshr_b32 s45, s52, 10
    s_cmp_eq_u32 s52, 0x0404
    s_cselect_b32 s45, s53, s45
    s_or_b32 s45, s45, s47
    s_nop 0
    s_mul_i32 s48, s45, 5120
    s_mul_i32 s46, s45, 12800
    buffer_load_dwordx4 v[112:115], v14, s[32:35], s48 offen offset:0 sc1
    buffer_load_dwordx4 v[116:119], v14, s[32:35], s48 offen offset:1280 sc1
    buffer_load_dwordx4 v[120:123], v14, s[32:35], s48 offen offset:2560 sc1
    buffer_load_dwordx4 v[124:127], v14, s[32:35], s48 offen offset:3840 sc1
    s_cmp_eq_u32 s52, 0x0404
    s_cbranch_scc1 L_cp_56
        s_mov_b64 exec, 1
        global_atomic_add v18, v17, v19, s[20:21] sc0 sc1
        s_mov_b64 exec, -1
L_cp_56:
    v_add_u32 v192, s46, v4
    v_add_u32 v196, s46, v5
    s_xor_b32 s45, s45, 2
    s_mul_i32 s49, s45, 5120
    s_mul_i32 s46, s45, 12800
    buffer_load_dwordx4 v[128:131], v14, s[32:35], s49 offen offset:0 sc1
    buffer_load_dwordx4 v[132:135], v14, s[32:35], s49 offen offset:1280 sc1
    buffer_load_dwordx4 v[136:139], v14, s[32:35], s49 offen offset:2560 sc1
    buffer_load_dwordx4 v[140:143], v14, s[32:35], s49 offen offset:3840 sc1
    buffer_load_dwordx4 v[144:147], v15, s[32:35], s48 offen offset:1024 sc1
    buffer_load_dwordx4 v[148:151], v15, s[32:35], s49 offen offset:1024 sc1
    v_add_u32 v193, s46, v4
    v_add_u32_e64 v197, s46, v5
    s_xor_b32 s45, s45, 3
    s_mul_i32 s50, s45, 5120
    s_mul_i32 s46, s45, 12800
    v_add_u32 v194, s46, v4
    v_add_u32_e64 v198, s46, v5
    s_xor_b32 s45, s45, 2
    s_mul_i32 s51, s45, 5120
    s_mul_i32 s46, s45, 12800
    v_add_u32 v195, s46, v4
    v_add_u32 v199, s46, v5
    ds_read_b64_tr_b16 v[64:65], v192 offset:0
    ds_read_b64_tr_b16 v[66:67], v192 offset:3200
    ds_read_b64_tr_b16 v[68:69], v192 offset:8
    ds_read_b64_tr_b16 v[70:71], v192 offset:3208
    ds_read_b64_tr_b16 v[72:73], v192 offset:16
    ds_read_b64_tr_b16 v[74:75], v192 offset:3216
    ds_read_b64_tr_b16 v[76:77], v192 offset:24
    ds_read_b64_tr_b16 v[78:79], v192 offset:3224
    ds_read_b64_tr_b16 v[80:81], v192 offset:32
    ds_read_b64_tr_b16 v[82:83], v192 offset:3232
    ds_read_b64_tr_b16 v[84:85], v192 offset:6400
    ds_read_b64_tr_b16 v[86:87], v192 offset:9600
    ds_read_b64_tr_b16 v[88:89], v192 offset:6408
    ds_read_b64_tr_b16 v[90:91], v192 offset:9608
    ds_read_b64_tr_b16 v[92:93], v192 offset:6416
    ds_read_b64_tr_b16 v[94:95], v192 offset:9616
    s_waitcnt vmcnt(8)
    v_swap_b32 v114, v116
    v_swap_b32 v115, v117
    s_waitcnt lgkmcnt(14)
    s_nop 0
    v_mfma_f32_16x16x32_bf16 v[200:203], v[64:67], v[112:115], 0
    ds_read_b64_tr_b16 v[96:97], v192 offset:6424
    v_mfma_f32_16x16x32_bf16 v[220:223], v[64:67], v[116:119], 0
    ds_read_b64_tr_b16 v[98:99], v192 offset:9624
    ds_write_b32 v13, v13
    s_waitcnt lgkmcnt(15)
    v_mfma_f32_16x16x32_bf16 v[204:207], v[68:71], v[112:115], 0
    ds_read_b64_tr_b16 v[100:101], v192 offset:6432
    v_mfma_f32_16x16x32_bf16 v[224:227], v[68:71], v[116:119], 0
    ds_read_b64_tr_b16 v[102:103], v192 offset:9632
    s_waitcnt lgkmcnt(15)
    v_mfma_f32_16x16x32_bf16 v[208:211], v[72:75], v[112:115], 0
    ds_read_b64_tr_b16 v[64:65], v193 offset:0
    v_mfma_f32_16x16x32_bf16 v[228:231], v[72:75], v[116:119], 0
    ds_read_b64_tr_b16 v[66:67], v193 offset:3200
    s_waitcnt lgkmcnt(15)
    v_mfma_f32_16x16x32_bf16 v[212:215], v[76:79], v[112:115], 0
    ds_read_b64_tr_b16 v[68:69], v193 offset:8
    v_mfma_f32_16x16x32_bf16 v[232:235], v[76:79], v[116:119], 0
    ds_read_b64_tr_b16 v[70:71], v193 offset:3208
    s_waitcnt vmcnt(6)
    v_swap_b32 v122, v124
    v_swap_b32 v123, v125
    v_readfirstlane_b32 s55, v18
    s_nop 0
    s_and_b32 s55, s55, 0x04040404
    s_cmp_eq_u32 s55, 0x04040404
    s_cbranch_scc0 L_fslow
    s_waitcnt lgkmcnt(15)
    v_mfma_f32_16x16x32_bf16 v[216:219], v[80:83], v[112:115], 0
    ds_read_b64_tr_b16 v[72:73], v193 offset:16
    buffer_load_dwordx4 v[152:155], v14, s[32:35], s50 offen offset:0 sc1
    v_mfma_f32_16x16x32_bf16 v[236:239], v[80:83], v[116:119], 0
    ds_read_b64_tr_b16 v[74:75], v193 offset:3216
    s_waitcnt lgkmcnt(15)
    v_mfma_f32_16x16x32_bf16 v[200:203], v[84:87], v[120:123], v[200:203]
    ds_read_b64_tr_b16 v[76:77], v193 offset:24
    v_mfma_f32_16x16x32_bf16 v[220:223], v[84:87], v[124:127], v[220:223]
    ds_read_b64_tr_b16 v[78:79], v193 offset:3224
    s_waitcnt lgkmcnt(15)
    v_mfma_f32_16x16x32_bf16 v[204:207], v[88:91], v[120:123], v[204:207]
    ds_read_b64_tr_b16 v[80:81], v193 offset:32
    buffer_load_dwordx4 v[156:159], v14, s[32:35], s50 offen offset:1280 sc1
    v_mfma_f32_16x16x32_bf16 v[224:227], v[88:91], v[124:127], v[224:227]
    ds_read_b64_tr_b16 v[82:83], v193 offset:3232
    s_waitcnt lgkmcnt(15)
    v_mfma_f32_16x16x32_bf16 v[208:211], v[92:95], v[120:123], v[208:211]
    ds_read_b64_tr_b16 v[84:85], v193 offset:6400
    v_mfma_f32_16x16x32_bf16 v[228:231], v[92:95], v[124:127], v[228:231]
    ds_read_b64_tr_b16 v[86:87], v193 offset:9600
    s_waitcnt lgkmcnt(15)
    v_mfma_f32_16x16x32_bf16 v[212:215], v[96:99], v[120:123], v[212:215]
    ds_read_b64_tr_b16 v[88:89], v193 offset:6408
    buffer_load_dwordx4 v[160:163], v14, s[32:35], s50 offen offset:2560 sc1
    v_mfma_f32_16x16x32_bf16 v[232:235], v[96:99], v[124:127], v[232:235]
    ds_read_b64_tr_b16 v[90:91], v193 offset:9608
    s_waitcnt vmcnt(7)
    v_swap_b32 v130, v132
    v_swap_b32 v131, v133
    s_waitcnt lgkmcnt(14)
    v_mfma_f32_16x16x32_bf16 v[216:219], v[100:103], v[120:123], v[216:219]
    ds_read_b64_tr_b16 v[92:93], v193 offset:6416
    v_mfma_f32_16x16x32_bf16 v[236:239], v[100:103], v[124:127], v[236:239]
    ds_read_b64_tr_b16 v[94:95], v193 offset:9616
    s_waitcnt lgkmcnt(14)
    v_mfma_f32_16x16x32_bf16 v[200:203], v[64:67], v[128:131], v[200:203]
    ds_read_b64_tr_b16 v[96:97], v193 offset:6424
    buffer_load_dwordx4 v[164:167], v14, s[32:35], s50 offen offset:3840 sc1
    v_mfma_f32_16x16x32_bf16 v[220:223], v[64:67], v[132:135], v[220:223]
    ds_read_b64_tr_b16 v[98:99], v193 offset:9624
    s_waitcnt lgkmcnt(14)
    v_mfma_f32_16x16x32_bf16 v[204:207], v[68:71], v[128:131], v[204:207]
    ds_read_b64_tr_b16 v[100:101], v193 offset:6432
    v_mfma_f32_16x16x32_bf16 v[224:227], v[68:71], v[132:135], v[224:227]
    ds_read_b64_tr_b16 v[102:103], v193 offset:9632
    s_waitcnt lgkmcnt(14)
    v_mfma_f32_16x16x32_bf16 v[208:211], v[72:75], v[128:131], v[208:211]
    ds_read_b64_tr_b16 v[64:65], v196 offset:0
    buffer_load_dwordx4 v[168:171], v14, s[32:35], s51 offen offset:0 sc1
    v_mfma_f32_16x16x32_bf16 v[228:231], v[72:75], v[132:135], v[228:231]
    ds_read_b64_tr_b16 v[66:67], v197 offset:0
    s_waitcnt lgkmcnt(14)
    v_mfma_f32_16x16x32_bf16 v[212:215], v[76:79], v[128:131], v[212:215]
    ds_read_b64_tr_b16 v[68:69], v196 offset:8
    v_mfma_f32_16x16x32_bf16 v[232:235], v[76:79], v[132:135], v[232:235]
    ds_read_b64_tr_b16 v[70:71], v197 offset:8
    s_waitcnt vmcnt(7)
    v_swap_b32 v138, v140
    v_swap_b32 v139, v141
    s_waitcnt lgkmcnt(14)
    v_mfma_f32_16x16x32_bf16 v[216:219], v[80:83], v[128:131], v[216:219]
    ds_read_b64_tr_b16 v[72:73], v196 offset:16
    buffer_load_dwordx4 v[172:175], v14, s[32:35], s51 offen offset:1280 sc1
    v_mfma_f32_16x16x32_bf16 v[236:239], v[80:83], v[132:135], v[236:239]
    ds_read_b64_tr_b16 v[74:75], v197 offset:16
    s_waitcnt lgkmcnt(14)
    v_mfma_f32_16x16x32_bf16 v[200:203], v[84:87], v[136:139], v[200:203]
    ds_read_b64_tr_b16 v[76:77], v196 offset:24
    v_mfma_f32_16x16x32_bf16 v[220:223], v[84:87], v[140:143], v[220:223]
    ds_read_b64_tr_b16 v[78:79], v197 offset:24
    s_waitcnt lgkmcnt(14)
    v_mfma_f32_16x16x32_bf16 v[204:207], v[88:91], v[136:139], v[204:207]
    ds_read_b64_tr_b16 v[80:81], v196 offset:32
    buffer_load_dwordx4 v[176:179], v14, s[32:35], s51 offen offset:2560 sc1
    v_mfma_f32_16x16x32_bf16 v[224:227], v[88:91], v[140:143], v[224:227]
    ds_read_b64_tr_b16 v[82:83], v197 offset:32
    s_waitcnt lgkmcnt(14)
    v_mfma_f32_16x16x32_bf16 v[208:211], v[92:95], v[136:139], v[208:211]
    ds_read_b64_tr_b16 v[84:85], v194 offset:0
    v_mfma_f32_16x16x32_bf16 v[228:231], v[92:95], v[140:143], v[228:231]
    ds_read_b64_tr_b16 v[86:87], v194 offset:3200
    s_waitcnt lgkmcnt(14)
    v_mfma_f32_16x16x32_bf16 v[212:215], v[96:99], v[136:139], v[212:215]
    ds_read_b64_tr_b16 v[88:89], v194 offset:8
    buffer_load_dwordx4 v[180:183], v14, s[32:35], s51 offen offset:3840 sc1
    v_mfma_f32_16x16x32_bf16 v[232:235], v[96:99], v[140:143], v[232:235]
    ds_read_b64_tr_b16 v[90:91], v194 offset:3208
    s_waitcnt vmcnt(8)
    v_swap_b32 v146, v148
    v_swap_b32 v147, v149
    s_waitcnt lgkmcnt(14)
    v_mfma_f32_16x16x32_bf16 v[216:219], v[100:103], v[136:139], v[216:219]
    ds_read_b64_tr_b16 v[92:93], v194 offset:16
    v_mfma_f32_16x16x32_bf16 v[236:239], v[100:103], v[140:143], v[236:239]
    ds_read_b64_tr_b16 v[94:95], v194 offset:3216
    s_waitcnt lgkmcnt(14)
    v_mfma_f32_16x16x32_bf16 v[200:203], v[64:67], v[144:147], v[200:203]
    ds_read_b64_tr_b16 v[96:97], v194 offset:24
    buffer_load_dwordx4 v[184:187], v15, s[32:35], s50 offen offset:1024 sc1
    v_mfma_f32_16x16x32_bf16 v[220:223], v[64:67], v[148:151], v[220:223]
    ds_read_b64_tr_b16 v[98:99], v194 offset:3224
    s_waitcnt lgkmcnt(14)
    v_mfma_f32_16x16x32_bf16 v[204:207], v[68:71], v[144:147], v[204:207]
    ds_read_b64_tr_b16 v[100:101], v194 offset:32
    v_mfma_f32_16x16x32_bf16 v[224:227], v[68:71], v[148:151], v[224:227]
    ds_read_b64_tr_b16 v[102:103], v194 offset:3232
    s_waitcnt lgkmcnt(14)
    v_mfma_f32_16x16x32_bf16 v[208:211], v[72:75], v[144:147], v[208:211]
    ds_read_b64_tr_b16 v[64:65], v194 offset:6400
    buffer_load_dwordx4 v[188:191], v15, s[32:35], s51 offen offset:1024 sc1
    v_mfma_f32_16x16x32_bf16 v[228:231], v[72:75], v[148:151], v[228:231]
    ds_read_b64_tr_b16 v[66:67], v194 offset:9600
    s_waitcnt lgkmcnt(14)
    v_mfma_f32_16x16x32_bf16 v[212:215], v[76:79], v[144:147], v[212:215]
    ds_read_b64_tr_b16 v[68:69], v194 offset:6408
    v_mfma_f32_16x16x32_bf16 v[232:235], v[76:79], v[148:151], v[232:235]
    ds_read_b64_tr_b16 v[70:71], v194 offset:9608
    s_waitcnt vmcnt(8)
    v_swap_b32 v154, v156
    v_swap_b32 v155, v157
    s_waitcnt lgkmcnt(14)
    v_mfma_f32_16x16x32_bf16 v[216:219], v[80:83], v[144:147], v[216:219]
    ds_read_b64_tr_b16 v[72:73], v194 offset:6416
    v_mfma_f32_16x16x32_bf16 v[236:239], v[80:83], v[148:151], v[236:239]
    ds_read_b64_tr_b16 v[74:75], v194 offset:9616
L_fjoin:
    s_waitcnt lgkmcnt(14)
    v_mfma_f32_16x16x32_bf16 v[24:27], v[84:87], v[152:155], 0
    ds_read_b64_tr_b16 v[76:77], v194 offset:6424
    v_mfma_f32_16x16x32_bf16 v[44:47], v[84:87], v[156:159], 0
    ds_read_b64_tr_b16 v[78:79], v194 offset:9624
    s_waitcnt lgkmcnt(14)
    v_mfma_f32_16x16x32_bf16 v[28:31], v[88:91], v[152:155], 0
    ds_read_b64_tr_b16 v[80:81], v194 offset:6432
    v_mfma_f32_16x16x32_bf16 v[48:51], v[88:91], v[156:159], 0
    ds_read_b64_tr_b16 v[82:83], v194 offset:9632
    s_waitcnt lgkmcnt(14)
    v_mfma_f32_16x16x32_bf16 v[32:35], v[92:95], v[152:155], 0
    ds_read_b64_tr_b16 v[84:85], v195 offset:0
    v_mfma_f32_16x16x32_bf16 v[52:55], v[92:95], v[156:159], 0
    ds_read_b64_tr_b16 v[86:87], v195 offset:3200
    s_waitcnt lgkmcnt(14)
    v_mfma_f32_16x16x32_bf16 v[36:39], v[96:99], v[152:155], 0
    ds_read_b64_tr_b16 v[88:89], v195 offset:8
    v_mfma_f32_16x16x32_bf16 v[56:59], v[96:99], v[156:159], 0
    ds_read_b64_tr_b16 v[90:91], v195 offset:3208
    s_waitcnt vmcnt(6)
    v_swap_b32 v162, v164
    v_swap_b32 v163, v165
    s_waitcnt lgkmcnt(14)
    v_mfma_f32_16x16x32_bf16 v[40:43], v[100:103], v[152:155], 0
    ds_read_b64_tr_b16 v[92:93], v195 offset:16
    v_mfma_f32_16x16x32_bf16 v[60:63], v[100:103], v[156:159], 0
    ds_read_b64_tr_b16 v[94:95], v195 offset:3216
    s_waitcnt lgkmcnt(14)
    v_mfma_f32_16x16x32_bf16 v[24:27], v[64:67], v[160:163], v[24:27]
    ds_read_b64_tr_b16 v[96:97], v195 offset:24
    v_mfma_f32_16x16x32_bf16 v[44:47], v[64:67], v[164:167], v[44:47]
    ds_read_b64_tr_b16 v[98:99], v195 offset:3224
    s_waitcnt lgkmcnt(14)
    v_mfma_f32_16x16x32_bf16 v[28:31], v[68:71], v[160:163], v[28:31]
    ds_read_b64_tr_b16 v[100:101], v195 offset:32
    v_mfma_f32_16x16x32_bf16 v[48:51], v[68:71], v[164:167], v[48:51]
    ds_read_b64_tr_b16 v[102:103], v195 offset:3232
    s_waitcnt lgkmcnt(14)
    v_mfma_f32_16x16x32_bf16 v[32:35], v[72:75], v[160:163], v[32:35]
    ds_read_b64_tr_b16 v[64:65], v195 offset:6400
    v_mfma_f32_16x16x32_bf16 v[52:55], v[72:75], v[164:167], v[52:55]
    ds_read_b64_tr_b16 v[66:67], v195 offset:9600
    s_waitcnt lgkmcnt(14)
    v_mfma_f32_16x16x32_bf16 v[36:39], v[76:79], v[160:163], v[36:39]
    ds_read_b64_tr_b16 v[68:69], v198 offset:0
    v_mfma_f32_16x16x32_bf16 v[56:59], v[76:79], v[164:167], v[56:59]
    ds_read_b64_tr_b16 v[70:71], v199 offset:0
    s_waitcnt vmcnt(4)
    v_swap_b32 v170, v172
    v_swap_b32 v171, v173
    s_waitcnt lgkmcnt(14)
    v_mfma_f32_16x16x32_bf16 v[40:43], v[80:83], v[160:163], v[40:43]
    ds_read_b64_tr_b16 v[72:73], v195 offset:6408
    v_mfma_f32_16x16x32_bf16 v[60:63], v[80:83], v[164:167], v[60:63]
    ds_read_b64_tr_b16 v[74:75], v195 offset:9608
    s_waitcnt lgkmcnt(14)
    v_mfma_f32_16x16x32_bf16 v[24:27], v[84:87], v[168:171], v[24:27]
    ds_read_b64_tr_b16 v[76:77], v198 offset:8
    v_mfma_f32_16x16x32_bf16 v[44:47], v[84:87], v[172:175], v[44:47]
    ds_read_b64_tr_b16 v[78:79], v199 offset:8
    s_waitcnt lgkmcnt(14)
    v_mfma_f32_16x16x32_bf16 v[28:31], v[88:91], v[168:171], v[28:31]
    ds_read_b64_tr_b16 v[80:81], v195 offset:6416
    v_mfma_f32_16x16x32_bf16 v[48:51], v[88:91], v[172:175], v[48:51]
    ds_read_b64_tr_b16 v[82:83], v195 offset:9616
    s_waitcnt lgkmcnt(14)
    v_mfma_f32_16x16x32_bf16 v[32:35], v[92:95], v[168:171], v[32:35]
    ds_read_b64_tr_b16 v[84:85], v198 offset:16
    v_mfma_f32_16x16x32_bf16 v[52:55], v[92:95], v[172:175], v[52:55]
    ds_read_b64_tr_b16 v[86:87], v199 offset:16
    s_waitcnt vmcnt(2)
    v_swap_b32 v178, v180
    v_swap_b32 v179, v181
    s_waitcnt lgkmcnt(14)
    v_mfma_f32_16x16x32_bf16 v[36:39], v[96:99], v[168:171], v[36:39]
    ds_read_b64_tr_b16 v[88:89], v195 offset:6424
    v_mfma_f32_16x16x32_bf16 v[56:59], v[96:99], v[172:175], v[56:59]
    ds_read_b64_tr_b16 v[90:91], v195 offset:9624
    s_waitcnt vmcnt(0)
    v_swap_b32 v186, v188
    v_swap_b32 v187, v189
    s_waitcnt lgkmcnt(14)
    v_mfma_f32_16x16x32_bf16 v[40:43], v[100:103], v[168:171], v[40:43]
    ds_read_b64_tr_b16 v[92:93], v198 offset:24
    v_mfma_f32_16x16x32_bf16 v[60:63], v[100:103], v[172:175], v[60:63]
    ds_read_b64_tr_b16 v[94:95], v199 offset:24
    s_waitcnt lgkmcnt(14)
    v_mfma_f32_16x16x32_bf16 v[44:47], v[64:67], v[180:183], v[44:47]
    ds_read_b64_tr_b16 v[96:97], v195 offset:6432
    s_waitcnt lgkmcnt(13)
    v_mfma_f32_16x16x32_bf16 v[44:47], v[68:71], v[188:191], v[44:47]
    ds_read_b64_tr_b16 v[98:99], v195 offset:9632
    s_waitcnt lgkmcnt(12)
    v_mfma_f32_16x16x32_bf16 v[48:51], v[72:75], v[180:183], v[48:51]
    ds_read_b64_tr_b16 v[100:101], v198 offset:32
    s_waitcnt lgkmcnt(11)
    v_mfma_f32_16x16x32_bf16 v[48:51], v[76:79], v[188:191], v[48:51]
    ds_read_b64_tr_b16 v[102:103], v199 offset:32
    s_waitcnt lgkmcnt(10)
    v_mfma_f32_16x16x32_bf16 v[52:55], v[80:83], v[180:183], v[52:55]
    v_add_f32 v44, v44, v220
    v_add_f32 v45, v45, v221
    s_waitcnt lgkmcnt(8)
    v_mfma_f32_16x16x32_bf16 v[52:55], v[84:87], v[188:191], v[52:55]
    v_add_f32 v46, v46, v222
    v_add_f32_e64 v47, v47, v223
    s_waitcnt lgkmcnt(6)
    v_mfma_f32_16x16x32_bf16 v[56:59], v[88:91], v[180:183], v[56:59]
    ds_write_b128 v7, v[44:47] offset:0
    s_waitcnt lgkmcnt(5)
    v_mfma_f32_16x16x32_bf16 v[56:59], v[92:95], v[188:191], v[56:59]
    v_add_f32 v48, v48, v224
    v_add_f32 v49, v49, v225
    s_waitcnt lgkmcnt(3)
    v_mfma_f32_16x16x32_bf16 v[60:63], v[96:99], v[180:183], v[60:63]
    v_add_f32 v50, v50, v226
    v_add_f32_e64 v51, v51, v227
    s_waitcnt lgkmcnt(1)
    v_mfma_f32_16x16x32_bf16 v[60:63], v[100:103], v[188:191], v[60:63]
    ds_write_b128 v7, v[48:51] offset:1024
    v_mfma_f32_16x16x32_bf16 v[24:27], v[64:67], v[176:179], v[24:27]
    v_add_f32 v52, v52, v228
    v_add_f32 v53, v53, v229
    v_mfma_f32_16x16x32_bf16 v[24:27], v[68:71], v[184:187], v[24:27]
    v_add_f32 v54, v54, v230
    v_add_f32 v55, v55, v231
    v_mfma_f32_16x16x32_bf16 v[28:31], v[72:75], v[176:179], v[28:31]
    ds_write_b128 v7, v[52:55] offset:2048
    v_mfma_f32_16x16x32_bf16 v[28:31], v[76:79], v[184:187], v[28:31]
    v_add_f32 v56, v56, v232
    v_add_f32 v57, v57, v233
    v_mfma_f32_16x16x32_bf16 v[32:35], v[80:83], v[176:179], v[32:35]
    v_add_f32 v58, v58, v234
    v_add_f32 v59, v59, v235
    v_mfma_f32_16x16x32_bf16 v[32:35], v[84:87], v[184:187], v[32:35]
    ds_write_b128 v7, v[56:59] offset:3072
    v_mfma_f32_16x16x32_bf16 v[36:39], v[88:91], v[176:179], v[36:39]
    v_add_f32 v60, v60, v236
    v_add_f32 v61, v61, v237
    v_mfma_f32_16x16x32_bf16 v[36:39], v[92:95], v[184:187], v[36:39]
    v_add_f32 v62, v62, v238
    v_add_f32 v63, v63, v239
    v_mfma_f32_16x16x32_bf16 v[40:43], v[96:99], v[176:179], v[40:43]
    ds_write_b128 v7, v[60:63] offset:4096
    v_mfma_f32_16x16x32_bf16 v[40:43], v[100:103], v[184:187], v[40:43]
    v_cmp_u_f32 s[36:37], v44, v200
    v_cmp_u_f32_e64 vcc, v24, v24
    s_waitcnt lgkmcnt(0)
    s_or_b64 vcc, vcc, s[36:37]
    s_cbranch_scc1 L_fredo
L_fok:
    s_barrier
    ds_read_b32 v22, v16
    ds_read_b128 v[112:115], v8 offset:0
    ds_read_b128 v[132:135], v6 offset:0
    v_pk_add_f32 v[24:25], v[24:25], v[200:201]
    v_pk_add_f32 v[26:27], v[26:27], v[202:203]
    ds_read_b128 v[116:119], v8 offset:1024
    ds_read_b128 v[136:139], v6 offset:1024
    v_pk_add_f32 v[28:29], v[28:29], v[204:205]
    v_pk_add_f32 v[30:31], v[30:31], v[206:207]
    ds_read_b128 v[120:123], v8 offset:2048
    ds_read_b128 v[140:143], v6 offset:2048
    v_pk_add_f32 v[32:33], v[32:33], v[208:209]
    v_pk_add_f32 v[34:35], v[34:35], v[210:211]
    ds_read_b128 v[124:127], v8 offset:3072
    ds_read_b128 v[144:147], v6 offset:3072
    v_pk_add_f32 v[36:37], v[36:37], v[212:213]
    v_pk_add_f32 v[38:39], v[38:39], v[214:215]
    ds_read_b128 v[128:131], v8 offset:4096
    ds_read_b128 v[148:151], v6 offset:4096
    v_pk_add_f32 v[40:41], v[40:41], v[216:217]
    v_pk_add_f32 v[42:43], v[42:43], v[218:219]
    s_waitcnt lgkmcnt(9)
    v_pk_add_f32 v[24:25], v[24:25], v[112:113]
    s_waitcnt lgkmcnt(8)
    v_pk_fma_f32 v[132:133], v[24:25], v[22:23], v[132:133] op_sel_hi:[1,0,1]
    v_cvt_pk_bf16_f32 v152, v132, v133
    v_pk_add_f32 v[26:27], v[26:27], v[114:115]
    v_pk_fma_f32 v[134:135], v[26:27], v[22:23], v[134:135] op_sel_hi:[1,0,1]
    v_cvt_pk_bf16_f32 v153, v134, v135
    s_waitcnt lgkmcnt(7)
    v_pk_add_f32 v[28:29], v[28:29], v[116:117]
    s_waitcnt lgkmcnt(6)
    v_pk_fma_f32 v[136:137], v[28:29], v[22:23], v[136:137] op_sel_hi:[1,0,1]
    v_cvt_pk_bf16_f32 v154, v136, v137
    v_pk_add_f32 v[30:31], v[30:31], v[118:119]
    v_pk_fma_f32 v[138:139], v[30:31], v[22:23], v[138:139] op_sel_hi:[1,0,1]
    v_cvt_pk_bf16_f32 v155, v138, v139
    ds_write2_b64 v9, v[152:153], v[154:155] offset0:0 offset1:1
    s_waitcnt lgkmcnt(6)
    v_pk_add_f32 v[32:33], v[32:33], v[120:121]
    s_waitcnt lgkmcnt(5)
    v_pk_fma_f32 v[140:141], v[32:33], v[22:23], v[140:141] op_sel_hi:[1,0,1]
    v_cvt_pk_bf16_f32 v156, v140, v141
    v_pk_add_f32 v[34:35], v[34:35], v[122:123]
    v_pk_fma_f32 v[142:143], v[34:35], v[22:23], v[142:143] op_sel_hi:[1,0,1]
    v_cvt_pk_bf16_f32 v157, v142, v143
    s_waitcnt lgkmcnt(4)
    v_pk_add_f32 v[36:37], v[36:37], v[124:125]
    s_waitcnt lgkmcnt(3)
    v_pk_fma_f32 v[144:145], v[36:37], v[22:23], v[144:145] op_sel_hi:[1,0,1]
    v_cvt_pk_bf16_f32 v158, v144, v145
    v_pk_add_f32 v[38:39], v[38:39], v[126:127]
    v_pk_fma_f32 v[146:147], v[38:39], v[22:23], v[146:147] op_sel_hi:[1,0,1]
    v_cvt_pk_bf16_f32 v159, v146, v147
    ds_write2_b64 v9, v[156:157], v[158:159] offset0:2 offset1:3
    s_waitcnt lgkmcnt(3)
    v_pk_add_f32 v[40:41], v[40:41], v[128:129]
    s_waitcnt lgkmcnt(2)
    v_pk_fma_f32 v[148:149], v[40:41], v[22:23], v[148:149] op_sel_hi:[1,0,1]
    v_cvt_pk_bf16_f32 v160, v148, v149
    v_pk_add_f32 v[42:43], v[42:43], v[130:131]
    v_pk_fma_f32 v[150:151], v[42:43], v[22:23], v[150:151] op_sel_hi:[1,0,1]
    v_cvt_pk_bf16_f32 v161, v150, v151
    ds_write_b64 v9, v[160:161] offset:32
    ds_read_b128 v[112:115], v248 offset:0
    ds_read_b128 v[116:119], v249 offset:1024
    ds_read_b128 v[120:123], v250 offset:2048
    s_waitcnt lgkmcnt(2)
    global_store_dwordx4 v252, v[112:115], s[64:65]
    s_waitcnt lgkmcnt(1)
    global_store_dwordx4 v253, v[116:119], s[64:65]
    s_mov_b32 exec_hi, 0
    s_waitcnt lgkmcnt(0)
    global_store_dwordx4 v254, v[120:123], s[64:65]
    s_mov_b32 exec_hi, -1
    s_endpgm
L_fslow:
        s_mov_b64 exec, 1
        global_atomic_add v18, v17, v19, s[20:21] sc0 sc1
        s_mov_b64 exec, -1
    s_waitcnt lgkmcnt(15)
    v_mfma_f32_16x16x32_bf16 v[216:219], v[80:83], v[112:115], 0
    ds_read_b64_tr_b16 v[72:73], v193 offset:16
    v_mfma_f32_16x16x32_bf16 v[236:239], v[80:83], v[116:119], 0
    ds_read_b64_tr_b16 v[74:75], v193 offset:3216
    s_waitcnt lgkmcnt(15)
    v_mfma_f32_16x16x32_bf16 v[200:203], v[84:87], v[120:123], v[200:203]
    ds_read_b64_tr_b16 v[76:77], v193 offset:24
    v_mfma_f32_16x16x32_bf16 v[220:223], v[84:87], v[124:127], v[220:223]
    ds_read_b64_tr_b16 v[78:79], v193 offset:3224
    s_waitcnt lgkmcnt(15)
    v_mfma_f32_16x16x32_bf16 v[204:207], v[88:91], v[120:123], v[204:207]
    ds_read_b64_tr_b16 v[80:81], v193 offset:32
    v_mfma_f32_16x16x32_bf16 v[224:227], v[88:91], v[124:127], v[224:227]
    ds_read_b64_tr_b16 v[82:83], v193 offset:3232
    s_waitcnt lgkmcnt(15)
    v_mfma_f32_16x16x32_bf16 v[208:211], v[92:95], v[120:123], v[208:211]
    ds_read_b64_tr_b16 v[84:85], v193 offset:6400
    v_mfma_f32_16x16x32_bf16 v[228:231], v[92:95], v[124:127], v[228:231]
    ds_read_b64_tr_b16 v[86:87], v193 offset:9600
    s_waitcnt lgkmcnt(15)
    v_mfma_f32_16x16x32_bf16 v[212:215], v[96:99], v[120:123], v[212:215]
    ds_read_b64_tr_b16 v[88:89], v193 offset:6408
    v_mfma_f32_16x16x32_bf16 v[232:235], v[96:99], v[124:127], v[232:235]
    ds_read_b64_tr_b16 v[90:91], v193 offset:9608
    s_waitcnt vmcnt(4)
    v_swap_b32 v130, v132
    v_swap_b32 v131, v133
    s_waitcnt lgkmcnt(14)
    v_mfma_f32_16x16x32_bf16 v[216:219], v[100:103], v[120:123], v[216:219]
    ds_read_b64_tr_b16 v[92:93], v193 offset:6416
    v_mfma_f32_16x16x32_bf16 v[236:239], v[100:103], v[124:127], v[236:239]
    ds_read_b64_tr_b16 v[94:95], v193 offset:9616
    s_waitcnt lgkmcnt(14)
    v_mfma_f32_16x16x32_bf16 v[200:203], v[64:67], v[128:131], v[200:203]
    ds_read_b64_tr_b16 v[96:97], v193 offset:6424
    v_mfma_f32_16x16x32_bf16 v[220:223], v[64:67], v[132:135], v[220:223]
    ds_read_b64_tr_b16 v[98:99], v193 offset:9624
    s_waitcnt lgkmcnt(14)
    v_mfma_f32_16x16x32_bf16 v[204:207], v[68:71], v[128:131], v[204:207]
    ds_read_b64_tr_b16 v[100:101], v193 offset:6432
    v_mfma_f32_16x16x32_bf16 v[224:227], v[68:71], v[132:135], v[224:227]
    ds_read_b64_tr_b16 v[102:103], v193 offset:9632
    s_waitcnt lgkmcnt(14)
    v_mfma_f32_16x16x32_bf16 v[208:211], v[72:75], v[128:131], v[208:211]
    ds_read_b64_tr_b16 v[64:65], v196 offset:0
    v_mfma_f32_16x16x32_bf16 v[228:231], v[72:75], v[132:135], v[228:231]
    ds_read_b64_tr_b16 v[66:67], v197 offset:0
    s_waitcnt lgkmcnt(14)
    v_mfma_f32_16x16x32_bf16 v[212:215], v[76:79], v[128:131], v[212:215]
    ds_read_b64_tr_b16 v[68:69], v196 offset:8
    v_mfma_f32_16x16x32_bf16 v[232:235], v[76:79], v[132:135], v[232:235]
    ds_read_b64_tr_b16 v[70:71], v197 offset:8
    s_waitcnt vmcnt(2)
    v_swap_b32 v138, v140
    v_swap_b32 v139, v141
    s_waitcnt lgkmcnt(14)
    v_mfma_f32_16x16x32_bf16 v[216:219], v[80:83], v[128:131], v[216:219]
    ds_read_b64_tr_b16 v[72:73], v196 offset:16
    v_mfma_f32_16x16x32_bf16 v[236:239], v[80:83], v[132:135], v[236:239]
    ds_read_b64_tr_b16 v[74:75], v197 offset:16
    s_waitcnt vmcnt(0)
    v_readfirstlane_b32 s55, v18
    s_nop 0
    s_and_b32 s55, s55, 0x04040404
    s_cmp_lg_u32 s55, 0x04040404
    s_cbranch_scc1 L_cp_57
    s_nop 0
        buffer_load_dwordx4 v[152:155], v14, s[32:35], s50 offen offset:0 sc1
        buffer_load_dwordx4 v[156:159], v14, s[32:35], s50 offen offset:1280 sc1
        buffer_load_dwordx4 v[160:163], v14, s[32:35], s50 offen offset:2560 sc1
        buffer_load_dwordx4 v[164:167], v14, s[32:35], s50 offen offset:3840 sc1
        buffer_load_dwordx4 v[168:171], v14, s[32:35], s51 offen offset:0 sc1
        buffer_load_dwordx4 v[172:175], v14, s[32:35], s51 offen offset:1280 sc1
        buffer_load_dwordx4 v[176:179], v14, s[32:35], s51 offen offset:2560 sc1
        buffer_load_dwordx4 v[180:183], v14, s[32:35], s51 offen offset:3840 sc1
        buffer_load_dwordx4 v[184:187], v15, s[32:35], s50 offen offset:1024 sc1
        buffer_load_dwordx4 v[188:191], v15, s[32:35], s51 offen offset:1024 sc1
L_cp_57:
    s_waitcnt lgkmcnt(14)
    v_mfma_f32_16x16x32_bf16 v[200:203], v[84:87], v[136:139], v[200:203]
    ds_read_b64_tr_b16 v[76:77], v196 offset:24
    v_mfma_f32_16x16x32_bf16 v[220:223], v[84:87], v[140:143], v[220:223]
    ds_read_b64_tr_b16 v[78:79], v197 offset:24
    s_waitcnt lgkmcnt(14)
    v_mfma_f32_16x16x32_bf16 v[204:207], v[88:91], v[136:139], v[204:207]
    ds_read_b64_tr_b16 v[80:81], v196 offset:32
    v_mfma_f32_16x16x32_bf16 v[224:227], v[88:91], v[140:143], v[224:227]
    ds_read_b64_tr_b16 v[82:83], v197 offset:32
    s_waitcnt lgkmcnt(14)
    v_mfma_f32_16x16x32_bf16 v[208:211], v[92:95], v[136:139], v[208:211]
    ds_read_b64_tr_b16 v[84:85], v194 offset:0
    v_mfma_f32_16x16x32_bf16 v[228:231], v[92:95], v[140:143], v[228:231]
    ds_read_b64_tr_b16 v[86:87], v194 offset:3200
    s_waitcnt lgkmcnt(14)
    v_mfma_f32_16x16x32_bf16 v[212:215], v[96:99], v[136:139], v[212:215]
    ds_read_b64_tr_b16 v[88:89], v194 offset:8
    v_mfma_f32_16x16x32_bf16 v[232:235], v[96:99], v[140:143], v[232:235]
    ds_read_b64_tr_b16 v[90:91], v194 offset:3208
    v_swap_b32 v146, v148
    v_swap_b32 v147, v149
    s_waitcnt lgkmcnt(14)
    v_mfma_f32_16x16x32_bf16 v[216:219], v[100:103], v[136:139], v[216:219]
    ds_read_b64_tr_b16 v[92:93], v194 offset:16
    v_mfma_f32_16x16x32_bf16 v[236:239], v[100:103], v[140:143], v[236:239]
    ds_read_b64_tr_b16 v[94:95], v194 offset:3216
    s_waitcnt lgkmcnt(14)
    v_mfma_f32_16x16x32_bf16 v[200:203], v[64:67], v[144:147], v[200:203]
    ds_read_b64_tr_b16 v[96:97], v194 offset:24
    v_mfma_f32_16x16x32_bf16 v[220:223], v[64:67], v[148:151], v[220:223]
    ds_read_b64_tr_b16 v[98:99], v194 offset:3224
    s_waitcnt lgkmcnt(14)
    v_mfma_f32_16x16x32_bf16 v[204:207], v[68:71], v[144:147], v[204:207]
    ds_read_b64_tr_b16 v[100:101], v194 offset:32
    v_mfma_f32_16x16x32_bf16 v[224:227], v[68:71], v[148:151], v[224:227]
    ds_read_b64_tr_b16 v[102:103], v194 offset:3232
    s_waitcnt lgkmcnt(14)
    v_mfma_f32_16x16x32_bf16 v[208:211], v[72:75], v[144:147], v[208:211]
    ds_read_b64_tr_b16 v[64:65], v194 offset:6400
    v_mfma_f32_16x16x32_bf16 v[228:231], v[72:75], v[148:151], v[228:231]
    ds_read_b64_tr_b16 v[66:67], v194 offset:9600
    s_waitcnt lgkmcnt(14)
    v_mfma_f32_16x16x32_bf16 v[212:215], v[76:79], v[144:147], v[212:215]
    ds_read_b64_tr_b16 v[68:69], v194 offset:6408
    v_mfma_f32_16x16x32_bf16 v[232:235], v[76:79], v[148:151], v[232:235]
    ds_read_b64_tr_b16 v[70:71], v194 offset:9608
    s_waitcnt lgkmcnt(14)
    v_mfma_f32_16x16x32_bf16 v[216:219], v[80:83], v[144:147], v[216:219]
    ds_read_b64_tr_b16 v[72:73], v194 offset:6416
    v_mfma_f32_16x16x32_bf16 v[236:239], v[80:83], v[148:151], v[236:239]
    ds_read_b64_tr_b16 v[74:75], v194 offset:9616
    s_cmp_eq_u32 s55, 0x04040404
    s_cbranch_scc1 L_cp_58
    s_mov_b64 exec, 1
    s_mov_b32 s27, 0
L_poll_59:
    global_atomic_add v18, v17, v19, s[20:21] sc0 sc1
    s_waitcnt vmcnt(0)
    v_and_b32 v21, 0x04040404, v18
    v_cmp_ne_u32 vcc, 0x04040404, v21
    s_nop 0
    s_cbranch_vccz L_polled_60
    s_add_u32 s27, s27, 1
    s_cmp_lt_u32 s27, 262144
    s_cbranch_scc1 L_poll_59
L_polled_60:
    s_mov_b64 exec, -1
    s_nop 0
    buffer_load_dwordx4 v[152:155], v14, s[32:35], s50 offen offset:0 sc1
    buffer_load_dwordx4 v[156:159], v14, s[32:35], s50 offen offset:1280 sc1
    buffer_load_dwordx4 v[160:163], v14, s[32:35], s50 offen offset:2560 sc1
    buffer_load_dwordx4 v[164:167], v14, s[32:35], s50 offen offset:3840 sc1
    buffer_load_dwordx4 v[168:171], v14, s[32:35], s51 offen offset:0 sc1
    buffer_load_dwordx4 v[172:175], v14, s[32:35], s51 offen offset:1280 sc1
    buffer_load_dwordx4 v[176:179], v14, s[32:35], s51 offen offset:2560 sc1
    buffer_load_dwordx4 v[180:183], v14, s[32:35], s51 offen offset:3840 sc1
    buffer_load_dwordx4 v[184:187], v15, s[32:35], s50 offen offset:1024 sc1
    buffer_load_dwordx4 v[188:191], v15, s[32:35], s51 offen offset:1024 sc1
L_cp_58:
    s_waitcnt vmcnt(8)
    v_swap_b32 v154, v156
    v_swap_b32 v155, v157
    s_nop 1
    s_branch L_fjoin
.p2align 12
L_conv:
    s_cmpk_ge_u32 s2, 256
    s_cbranch_scc1 L_end
    s_load_dwordx16 s[4:19], s[0:1], 0
    s_load_dwordx8 s[56:63], s[0:1], 64
    s_load_dwordx4 s[64:67], s[0:1], 96
    s_load_dwordx2 s[20:21], s[0:1], 112
    s_lshr_b32 s24, s24, 6
    s_and_b32 s22, s2, 7
    s_lshr_b32 s23, s2, 3
    s_and_b32 s26, s24, 3
    s_sub_u32 s25, s23, 22
    s_lshl_b32 s54, s25, 3
    s_add_u32 s54, s54, s22
    v_and_b32_e64 v1, 63, v0
    s_lshl_b32 s52, s54, 3
    s_add_u32 s52, s52, s24
    s_lshl_b32 s53, s52, 8
    v_lshl_add_u32 v4, v1, 2, s53
    s_lshl_b32 s53, s52, 1
    v_mov_b32_e64 v5, s53
    s_waitcnt lgkmcnt(0)
    global_load_ushort v8, v5, s[14:15]
    global_load_dword v9, v4, s[6:7]
    global_load_dword v10, v4, s[8:9]
    global_load_dword v11, v4, s[10:11]
    global_load_dword v12, v4, s[12:13]
    global_load_ushort v13, v5, s[16:17]
    s_sub_u32 s50, s23, 22
    s_lshl_b32 s51, s50, 3
    s_add_u32 s51, s51, s24
    v_and_b32 v6, 7, v1
    v_mul_u32_u24 v6, 3840, v6
    v_lshrrev_b32 v7, 3, v1
    v_min_u32 v7, 5, v7
    v_lshrrev_b32_e64 v16, 1, v7
    v_mul_u32_u24 v16, 1024, v16
    v_lshl_add_u32 v7, v7, 7, v16
    s_mul_i32 s43, s51, 30720
    s_mul_i32 s44, s22, 160
    s_andn2_b32 s44, s44, 127
    s_add_u32 s43, s43, s44
    v_add3_u32 v6, v6, v7, s43
    s_mov_b32 exec_hi, 0xffff
    global_load_dword v252, v6, s[56:57]
    s_mov_b32 exec_hi, -1
    s_add_u32 s25, s25, 8
    s_mul_i32 s40, s25, 26
    s_lshr_b32 s40, s40, 8
    s_mul_i32 s40, s40, 10
    s_sub_u32 s25, s25, s40
    s_lshl_b32 s25, s25, 2
    s_add_u32 s25, s25, 3
    s_mul_i32 s25, s25, 52
    s_lshr_b32 s25, s25, 8
    s_and_b32 s73, s22, 7
    s_sub_u32 s25, s25, s73
    s_mul_i32 s43, s54, 205
    s_lshr_b32 s43, s43, 11
    s_lshl_b32 s43, s43, 10
    s_add_u32 s43, s43, 16384000
    v_lshl_add_u32 v250, v1, 7, s43
    s_sub_u32 s53, s25, s24
    s_and_b32 s46, s53, 7
    s_xor_b32 s49, s46, 4
    s_lshl_b32 s47, s54, 4
    v_mul_u32_u24 v15, 5120, v1
    v_add_u32 v15, s47, v15
    s_mul_i32 s53, s49, 327680
    v_add_u32_e64 v249, s53, v15
    s_mul_i32 s53, s46, 327680
    v_add_u32 v15, s53, v15
    s_getreg_b32 s72, hwreg(HW_REG_XCC_ID, 0, 4)
    s_or_b32 s72, s72, 0x80
    s_mul_i32 s72, s72, 0x01010101
    s_lshl_b32 s69, s22, 2
    s_lshr_b32 s73, s23, 3
    s_add_u32 s69, s69, s73
    s_and_b32 s70, s23, 7
    s_add_u32 s73, s23, 1
    s_and_b32 s73, s73, 3
    s_mul_i32 s73, s73, 10240
    s_add_u32 s71, s73, 102400
    v_and_b32_e64 v2, 15, v0
    v_bfe_u32 v3, v0, 4, 2
    s_mul_i32 s55, s24, 12800
    v_mov_b32 v16, 0
    v_mov_b32 v17, 0
    v_mov_b32 v18, 0
    v_mov_b32 v19, 0
    v_lshl_add_u32 v6, v1, 4, s55
    s_barrier
    s_cmp_lg_u32 s24, 0
    s_cbranch_scc1 L_us_61
    s_nop 0
        global_load_dwordx4 v[184:187], v15, s[4:5] offset:0
        global_load_dwordx4 v[188:191], v15, s[4:5] offset:1280
        global_load_dwordx4 v[192:195], v15, s[4:5] offset:2560
        global_load_dwordx4 v[196:199], v15, s[4:5] offset:3840
L_us_61:
    ds_write_b128 v6, v[16:19] offset:8704
    ds_write_b128 v6, v[16:19] offset:9728
    ds_write_b128 v6, v[16:19] offset:10752
    ds_write_b128 v6, v[16:19] offset:11776
    s_mul_i32 s42, s24, 4608
    s_add_u32 s42, s42, 102400
    v_lshl_add_u32 v6, v1, 3, s42
    ds_write_b64 v6, v[16:17]
    s_lshl_b32 s43, s24, 2
    s_lshr_b32 s44, 0x233579, s43
    s_lshr_b32 s45, 0xcb3654, s43
    s_and_b32 s44, s44, 15
    s_and_b32 s45, s45, 15
    s_bfm_b32 s45, s44, s45
    s_cmp_eq_u32 s24, 5
    s_mov_b32 s44, 0xffff
    s_cselect_b32 s44, s44, 0x3f80
    v_lshlrev_b32 v7, 3, v3
    v_lshlrev_b32 v20, v2, s45
    v_bfe_u32 v20, v20, v7, 8
    v_lshl_or_b32 v20, v20, 15, v20
    v_and_b32 v24, 0x10001, v20
    v_mul_u32_u24 v24, s44, v24
    v_lshrrev_b32 v20, 2, v20
    v_and_b32 v25, 0x10001, v20
    v_mul_u32_u24 v25, s44, v25
    v_lshrrev_b32 v20, 2, v20
    v_and_b32 v26, 0x10001, v20
    v_mul_u32_u24 v26, s44, v26
    v_lshrrev_b32 v20, 2, v20
    v_and_b32 v27, 0x10001, v20
    v_mul_u32_u24 v27, s44, v27
    v_lshlrev_b32 v248, 4, v1
    v_add_u32 v248, 139264, v248
    s_lshl_b32 s43, s24, 10
    v_add_u32 v21, s43, v248
    ds_write_b128 v21, v[24:27]
    v_lshl_add_u32 v228, v1, 3, s55
    v_add_u32 v229, 2176, v228
    v_add_u32 v230, 4352, v228
    v_add_u32 v231, 6528, v228
    v_mul_u32_u24 v232, 544, v2
    v_lshl_add_u32 v232, v3, 4, v232
    v_add_u32_e64 v232, s55, v232
    s_add_u32 s48, s55, 2048
    v_lshlrev_b32_e64 v20, 8, v3
    v_lshl_add_u32 v20, v2, 4, v20
    v_sub_u32 v233, s48, v20
    v_lshlrev_b32 v20, 7, v3
    v_lshl_add_u32 v20, v2, 2, v20
    v_sub_u32 v234, s48, v20
    v_and_b32 v22, 1, v3
    v_lshrrev_b32 v23, 1, v3
    v_lshlrev_b32 v20, 3, v22
    v_lshl_add_u32 v20, v2, 4, v20
    v_lshl_add_u32 v20, v23, 8, v20
    v_sub_u32 v235, s48, v20
    v_lshlrev_b32 v21, 5, v2
    v_lshl_add_u32 v20, v3, 3, v21
    v_sub_u32_e64 v236, s48, v20
    v_lshl_add_u32 v21, v3, 4, v21
    v_add_u32 v241, s42, v21
    v_and_b32 v20, 1, v2
    v_mul_u32_u24 v20, 1218, v20
    v_lshlrev_b32 v21, 1, v2
    v_sub_u32 v20, v20, v21
    v_lshl_add_u32 v20, v3, 4, v20
    v_add_u32_e64 v20, s55, v20
    v_add_u32 v238, 8732, v20
    v_add_u32 v237, 8796, v20
    v_lshlrev_b32 v20, 2, v3
    v_sub_u32 v20, v20, v2
    v_lshl_add_u32 v239, v20, 3, s48
    s_add_u32 s43, s55, 11644
    v_lshl_add_u32 v240, v20, 2, s43
    s_lshl_b32 s53, s52, 7
    v_lshrrev_b32 v21, 2, v2
    v_lshl_add_u32 v21, v22, 2, v21
    v_mul_u32_u24 v21, 82048, v21
    v_lshl_add_u32 v20, v23, 6, s53
    v_add_u32 v20, v20, v21
    v_and_b32 v21, 3, v2
    v_lshl_add_u32 v242, v21, 4, v20
    s_lshl_b32 s47, s46, 9
    s_add_u32 s47, s47, 102912
    v_lshl_add_u32 v243, v1, 3, s47
    s_lshl_b32 s47, s49, 9
    s_add_u32 s47, s47, 102912
    v_lshl_add_u32 v244, v1, 3, s47
    s_cmp_lt_u32 s24, 1
    s_cbranch_scc1 L_pw_62
        s_waitcnt vmcnt(1)
L_pw_62:
        s_waitcnt vmcnt(5)
    s_cmp_lg_u32 s24, 1
    s_cbranch_scc1 L_us_63
        global_load_dwordx4 v[184:187], v15, s[4:5] offset:0
        global_load_dwordx4 v[188:191], v15, s[4:5] offset:1280
        global_load_dwordx4 v[192:195], v15, s[4:5] offset:2560
        global_load_dwordx4 v[196:199], v15, s[4:5] offset:3840
L_us_63:
    s_mov_b32 s43, 0x3fb8aa3b
    s_mov_b32 s44, 0xffff0000
    s_mov_b32 s45, 0x3e22f983
    v_lshlrev_b32 v14, 16, v8
    v_mul_f32 v14, s43, v14
    v_exp_f32 v14, v14
    v_lshlrev_b32 v16, 16, v9
    v_and_b32 v17, s44, v9
    v_cvt_pk_bf16_f32 v14, v14, v14
    v_mul_f32 v16, s43, v16
    v_mul_f32 v17, s43, v17
    v_and_b32 v14, s44, v14
    v_exp_f32 v16, v16
    v_exp_f32 v17, v17
    v_lshlrev_b32 v18, 16, v10
    v_and_b32_e64 v19, s44, v10
    v_cvt_pk_bf16_f32 v17, v16, v17
    v_mul_f32 v18, v14, v18
    v_mul_f32 v19, v14, v19
    v_lshlrev_b32 v16, 16, v17
    v_and_b32 v17, s44, v17
    v_mul_f32 v18, s45, v18
    v_mul_f32 v19, s45, v19
    v_mul_f32 v16, v14, v16
    v_mul_f32 v17, v14, v17
    v_mul_f32 v16, s43, v16
    v_mul_f32 v17, s43, v17
    s_mov_b32 s47, 0x43000000
    v_fract_f32 v42, v18
    v_fract_f32 v43, v19
    v_exp_f32 v40, -v16
    v_exp_f32 v41, -v17
    v_cos_f32 v20, v42
    v_sin_f32 v21, v42
    v_cos_f32 v22, v43
    v_sin_f32 v23, v43
    v_mul_f32 v20, v40, v20
    v_mul_f32 v21, v40, v21
    v_mul_f32 v22, v41, v22
    v_mul_f32 v23, v41, v23
    v_pk_mul_f32 v[36:37], v[20:21], v[20:21] op_sel:[0,0] op_sel_hi:[0,1]
    v_pk_mul_f32 v[38:39], v[22:23], v[22:23] op_sel:[0,0] op_sel_hi:[0,1]
    v_pk_fma_f32 v[32:33], v[20:21], v[20:21], v[36:37] op_sel:[1,1,0] op_sel_hi:[1,0,1] neg_lo:[1,0,0]
    v_pk_fma_f32 v[34:35], v[22:23], v[22:23], v[38:39] op_sel:[1,1,0] op_sel_hi:[1,0,1] neg_lo:[1,0,0]
    v_pk_mul_f32 v[36:37], v[32:33], v[32:33] op_sel:[0,0] op_sel_hi:[0,1]
    v_pk_mul_f32 v[38:39], v[34:35], v[34:35] op_sel:[0,0] op_sel_hi:[0,1]
    v_pk_fma_f32 v[32:33], v[32:33], v[32:33], v[36:37] op_sel:[1,1,0] op_sel_hi:[1,0,1] neg_lo:[1,0,0]
    v_pk_fma_f32 v[34:35], v[34:35], v[34:35], v[38:39] op_sel:[1,1,0] op_sel_hi:[1,0,1] neg_lo:[1,0,0]
    v_pk_mul_f32 v[36:37], v[32:33], v[32:33] op_sel:[0,0] op_sel_hi:[0,1]
    v_pk_mul_f32 v[38:39], v[34:35], v[34:35] op_sel:[0,0] op_sel_hi:[0,1]
    v_pk_fma_f32 v[32:33], v[32:33], v[32:33], v[36:37] op_sel:[1,1,0] op_sel_hi:[1,0,1] neg_lo:[1,0,0]
    v_pk_fma_f32 v[34:35], v[34:35], v[34:35], v[38:39] op_sel:[1,1,0] op_sel_hi:[1,0,1] neg_lo:[1,0,0]
    v_mul_f32 v40, s47, v16
    v_mul_f32 v42, s47, v18
    v_mul_f32 v41, s47, v17
    v_mul_f32 v43, s47, v19
    v_fract_f32 v42, v42
    v_fract_f32 v43, v43
    v_exp_f32 v40, -v40
    v_exp_f32 v41, -v41
    v_cos_f32 v24, v42
    v_sin_f32 v25, v42
    v_cos_f32 v26, v43
    v_sin_f32 v27, v43
    v_mul_f32 v24, v40, v24
    v_mul_f32 v25, v40, v25
    v_mul_f32 v26, v41, v26
    v_mul_f32 v27, v41, v27
    v_add_f32 v14, v14, v14
    v_lshlrev_b32 v28, 16, v11
    v_and_b32 v30, s44, v11
    v_lshlrev_b32 v29, 16, v12
    v_and_b32 v31, s44, v12
    v_mul_f32 v28, v14, v28
    v_mul_f32 v29, v14, v29
    v_mul_f32 v30, v14, v30
    v_mul_f32 v31, v14, v31
    s_waitcnt lgkmcnt(0)
    v_mov_b32 v40, 0x3f80
    v_mov_b32 v41, 0x3f80
    s_cmp_lg_u32 s24, 2
    s_cbranch_scc1 L_us_64
        global_load_dwordx4 v[184:187], v15, s[4:5] offset:0
        global_load_dwordx4 v[188:191], v15, s[4:5] offset:1280
        global_load_dwordx4 v[192:195], v15, s[4:5] offset:2560
        global_load_dwordx4 v[196:199], v15, s[4:5] offset:3840
L_us_64:
    v_cvt_pk_bf16_f32 v42, v32, -v33
    v_cvt_pk_bf16_f32 v43, v34, -v35
    ds_write2_b64 v228, v[40:41], v[42:43] offset0:0 offset1:68
    v_pk_mul_f32 v[36:37], v[32:33], v[32:33] op_sel:[0,0] op_sel_hi:[0,1]
    v_pk_mul_f32 v[38:39], v[34:35], v[34:35] op_sel:[0,0] op_sel_hi:[0,1]
    v_pk_fma_f32 v[48:49], v[32:33], v[32:33], v[36:37] op_sel:[1,1,0] op_sel_hi:[1,0,1] neg_lo:[1,0,0]
    v_pk_fma_f32 v[50:51], v[34:35], v[34:35], v[38:39] op_sel:[1,1,0] op_sel_hi:[1,0,1] neg_lo:[1,0,0]
    v_cvt_pk_bf16_f32 v44, v48, -v49
    v_cvt_pk_bf16_f32 v45, v50, -v51
    v_pk_mul_f32 v[36:37], v[32:33], v[48:49] op_sel:[0,0] op_sel_hi:[0,1]
    v_pk_mul_f32 v[38:39], v[34:35], v[50:51] op_sel:[0,0] op_sel_hi:[0,1]
    v_pk_fma_f32 v[56:57], v[32:33], v[48:49], v[36:37] op_sel:[1,1,0] op_sel_hi:[1,0,1] neg_lo:[1,0,0]
    v_pk_fma_f32 v[58:59], v[34:35], v[50:51], v[38:39] op_sel:[1,1,0] op_sel_hi:[1,0,1] neg_lo:[1,0,0]
    v_cvt_pk_bf16_f32 v46, v56, -v57
    v_cvt_pk_bf16_f32 v47, v58, -v59
    ds_write2_b64 v228, v[44:45], v[46:47] offset0:136 offset1:204
    v_pk_mul_f32 v[36:37], v[48:49], v[48:49] op_sel:[0,0] op_sel_hi:[0,1]
    v_pk_mul_f32 v[38:39], v[50:51], v[50:51] op_sel:[0,0] op_sel_hi:[0,1]
    v_pk_fma_f32 v[52:53], v[48:49], v[48:49], v[36:37] op_sel:[1,1,0] op_sel_hi:[1,0,1] neg_lo:[1,0,0]
    v_pk_fma_f32 v[54:55], v[50:51], v[50:51], v[38:39] op_sel:[1,1,0] op_sel_hi:[1,0,1] neg_lo:[1,0,0]
    v_cvt_pk_bf16_f32 v4, v52, -v53
    v_cvt_pk_bf16_f32 v5, v54, -v55
    v_pk_mul_f32 v[36:37], v[56:57], v[48:49] op_sel:[0,0] op_sel_hi:[0,1]
    v_pk_mul_f32 v[38:39], v[58:59], v[50:51] op_sel:[0,0] op_sel_hi:[0,1]
    v_pk_fma_f32 v[56:57], v[56:57], v[48:49], v[36:37] op_sel:[1,1,0] op_sel_hi:[1,0,1] neg_lo:[1,0,0]
    v_pk_fma_f32 v[58:59], v[58:59], v[50:51], v[38:39] op_sel:[1,1,0] op_sel_hi:[1,0,1] neg_lo:[1,0,0]
    v_cvt_pk_bf16_f32 v6, v56, -v57
    v_cvt_pk_bf16_f32 v7, v58, -v59
    ds_write2_b64 v229, v[4:5], v[6:7] offset0:0 offset1:68
    s_cmp_lg_u32 s24, 3
    s_cbranch_scc1 L_us_65
        global_load_dwordx4 v[184:187], v15, s[4:5] offset:0
        global_load_dwordx4 v[188:191], v15, s[4:5] offset:1280
        global_load_dwordx4 v[192:195], v15, s[4:5] offset:2560
        global_load_dwordx4 v[196:199], v15, s[4:5] offset:3840
L_us_65:
    v_pk_mul_f32 v[36:37], v[52:53], v[48:49] op_sel:[0,0] op_sel_hi:[0,1]
    v_pk_mul_f32 v[38:39], v[54:55], v[50:51] op_sel:[0,0] op_sel_hi:[0,1]
    v_pk_fma_f32 v[52:53], v[52:53], v[48:49], v[36:37] op_sel:[1,1,0] op_sel_hi:[1,0,1] neg_lo:[1,0,0]
    v_pk_fma_f32 v[54:55], v[54:55], v[50:51], v[38:39] op_sel:[1,1,0] op_sel_hi:[1,0,1] neg_lo:[1,0,0]
    v_cvt_pk_bf16_f32 v40, v52, -v53
    v_cvt_pk_bf16_f32 v41, v54, -v55
    v_pk_mul_f32 v[36:37], v[56:57], v[48:49] op_sel:[0,0] op_sel_hi:[0,1]
    v_pk_mul_f32 v[38:39], v[58:59], v[50:51] op_sel:[0,0] op_sel_hi:[0,1]
    v_pk_fma_f32 v[56:57], v[56:57], v[48:49], v[36:37] op_sel:[1,1,0] op_sel_hi:[1,0,1] neg_lo:[1,0,0]
    v_pk_fma_f32 v[58:59], v[58:59], v[50:51], v[38:39] op_sel:[1,1,0] op_sel_hi:[1,0,1] neg_lo:[1,0,0]
    v_cvt_pk_bf16_f32 v42, v56, -v57
    v_cvt_pk_bf16_f32 v43, v58, -v59
    ds_write2_b64 v229, v[40:41], v[42:43] offset0:136 offset1:204
    v_pk_mul_f32 v[36:37], v[52:53], v[48:49] op_sel:[0,0] op_sel_hi:[0,1]
    v_pk_mul_f32 v[38:39], v[54:55], v[50:51] op_sel:[0,0] op_sel_hi:[0,1]
    v_pk_fma_f32 v[52:53], v[52:53], v[48:49], v[36:37] op_sel:[1,1,0] op_sel_hi:[1,0,1] neg_lo:[1,0,0]
    v_pk_fma_f32 v[54:55], v[54:55], v[50:51], v[38:39] op_sel:[1,1,0] op_sel_hi:[1,0,1] neg_lo:[1,0,0]
    v_cvt_pk_bf16_f32 v44, v52, -v53
    v_cvt_pk_bf16_f32 v45, v54, -v55
    v_pk_mul_f32 v[36:37], v[56:57], v[48:49] op_sel:[0,0] op_sel_hi:[0,1]
    v_pk_mul_f32 v[38:39], v[58:59], v[50:51] op_sel:[0,0] op_sel_hi:[0,1]
    v_pk_fma_f32 v[56:57], v[56:57], v[48:49], v[36:37] op_sel:[1,1,0] op_sel_hi:[1,0,1] neg_lo:[1,0,0]
    v_pk_fma_f32 v[58:59], v[58:59], v[50:51], v[38:39] op_sel:[1,1,0] op_sel_hi:[1,0,1] neg_lo:[1,0,0]
    v_cvt_pk_bf16_f32 v46, v56, -v57
    v_cvt_pk_bf16_f32 v47, v58, -v59
    ds_write2_b64 v230, v[44:45], v[46:47] offset0:0 offset1:68
    v_pk_mul_f32 v[36:37], v[52:53], v[48:49] op_sel:[0,0] op_sel_hi:[0,1]
    v_pk_mul_f32 v[38:39], v[54:55], v[50:51] op_sel:[0,0] op_sel_hi:[0,1]
    v_pk_fma_f32 v[52:53], v[52:53], v[48:49], v[36:37] op_sel:[1,1,0] op_sel_hi:[1,0,1] neg_lo:[1,0,0]
    v_pk_fma_f32 v[54:55], v[54:55], v[50:51], v[38:39] op_sel:[1,1,0] op_sel_hi:[1,0,1] neg_lo:[1,0,0]
    v_cvt_pk_bf16_f32 v4, v52, -v53
    v_cvt_pk_bf16_f32 v5, v54, -v55
    v_pk_mul_f32 v[36:37], v[56:57], v[48:49] op_sel:[0,0] op_sel_hi:[0,1]
    v_pk_mul_f32 v[38:39], v[58:59], v[50:51] op_sel:[0,0] op_sel_hi:[0,1]
    v_pk_fma_f32 v[56:57], v[56:57], v[48:49], v[36:37] op_sel:[1,1,0] op_sel_hi:[1,0,1] neg_lo:[1,0,0]
    v_pk_fma_f32 v[58:59], v[58:59], v[50:51], v[38:39] op_sel:[1,1,0] op_sel_hi:[1,0,1] neg_lo:[1,0,0]
    v_cvt_pk_bf16_f32 v6, v56, -v57
    v_cvt_pk_bf16_f32 v7, v58, -v59
    ds_write2_b64 v230, v[4:5], v[6:7] offset0:136 offset1:204
    v_pk_mul_f32 v[36:37], v[52:53], v[48:49] op_sel:[0,0] op_sel_hi:[0,1]
    v_pk_mul_f32 v[38:39], v[54:55], v[50:51] op_sel:[0,0] op_sel_hi:[0,1]
    v_pk_fma_f32 v[52:53], v[52:53], v[48:49], v[36:37] op_sel:[1,1,0] op_sel_hi:[1,0,1] neg_lo:[1,0,0]
    v_pk_fma_f32 v[54:55], v[54:55], v[50:51], v[38:39] op_sel:[1,1,0] op_sel_hi:[1,0,1] neg_lo:[1,0,0]
    v_cvt_pk_bf16_f32 v40, v52, -v53
    v_cvt_pk_bf16_f32 v41, v54, -v55
    v_pk_mul_f32 v[36:37], v[56:57], v[48:49] op_sel:[0,0] op_sel_hi:[0,1]
    v_pk_mul_f32 v[38:39], v[58:59], v[50:51] op_sel:[0,0] op_sel_hi:[0,1]
    v_pk_fma_f32 v[56:57], v[56:57], v[48:49], v[36:37] op_sel:[1,1,0] op_sel_hi:[1,0,1] neg_lo:[1,0,0]
    v_pk_fma_f32 v[58:59], v[58:59], v[50:51], v[38:39] op_sel:[1,1,0] op_sel_hi:[1,0,1] neg_lo:[1,0,0]
    v_cvt_pk_bf16_f32 v42, v56, -v57
    v_cvt_pk_bf16_f32 v43, v58, -v59
    ds_write2_b64 v231, v[40:41], v[42:43] offset0:0 offset1:68
    s_cmp_lg_u32 s24, 0
    s_cbranch_scc1 L_us_66
        global_load_dwordx4 v[200:203], v249, s[4:5] offset:0
        global_load_dwordx4 v[204:207], v249, s[4:5] offset:1280
        global_load_dwordx4 v[208:211], v249, s[4:5] offset:2560
        global_load_dwordx4 v[212:215], v249, s[4:5] offset:3840
L_us_66:
    v_pk_mul_f32 v[36:37], v[52:53], v[48:49] op_sel:[0,0] op_sel_hi:[0,1]
    v_pk_mul_f32 v[38:39], v[54:55], v[50:51] op_sel:[0,0] op_sel_hi:[0,1]
    v_pk_fma_f32 v[52:53], v[52:53], v[48:49], v[36:37] op_sel:[1,1,0] op_sel_hi:[1,0,1] neg_lo:[1,0,0]
    v_pk_fma_f32 v[54:55], v[54:55], v[50:51], v[38:39] op_sel:[1,1,0] op_sel_hi:[1,0,1] neg_lo:[1,0,0]
    v_cvt_pk_bf16_f32 v44, v52, -v53
    v_cvt_pk_bf16_f32 v45, v54, -v55
    v_pk_mul_f32 v[36:37], v[56:57], v[48:49] op_sel:[0,0] op_sel_hi:[0,1]
    v_pk_mul_f32 v[38:39], v[58:59], v[50:51] op_sel:[0,0] op_sel_hi:[0,1]
    v_pk_fma_f32 v[56:57], v[56:57], v[48:49], v[36:37] op_sel:[1,1,0] op_sel_hi:[1,0,1] neg_lo:[1,0,0]
    v_pk_fma_f32 v[58:59], v[58:59], v[50:51], v[38:39] op_sel:[1,1,0] op_sel_hi:[1,0,1] neg_lo:[1,0,0]
    v_cvt_pk_bf16_f32 v46, v56, -v57
    v_cvt_pk_bf16_f32 v47, v58, -v59
    ds_write2_b64 v231, v[44:45], v[46:47] offset0:136 offset1:204
    ds_read_b128 v[88:91], v232 offset:0
    ds_read_b128 v[92:95], v232 offset:64
    ds_read_b128 v[96:99], v232 offset:128
    ds_read_b128 v[100:103], v232 offset:192
    ds_read_b128 v[104:107], v232 offset:256
    ds_read_b128 v[108:111], v232 offset:320
    ds_read_b128 v[112:115], v232 offset:384
    ds_read_b128 v[116:119], v232 offset:448
    v_cvt_pk_bf16_f32 v4, v28, v29
    v_cvt_pk_bf16_f32 v5, v30, v31
    v_pk_mul_f32 v[36:37], v[28:29], v[24:25] op_sel:[0,0] op_sel_hi:[0,1]
    v_pk_mul_f32 v[38:39], v[30:31], v[26:27] op_sel:[0,0] op_sel_hi:[0,1]
    v_pk_fma_f32 v[48:49], v[28:29], v[24:25], v[36:37] op_sel:[1,1,0] op_sel_hi:[1,0,1] neg_lo:[1,0,0]
    v_pk_fma_f32 v[50:51], v[30:31], v[26:27], v[38:39] op_sel:[1,1,0] op_sel_hi:[1,0,1] neg_lo:[1,0,0]
    v_cvt_pk_bf16_f32 v40, v48, v49
    v_cvt_pk_bf16_f32 v41, v50, v51
    v_pk_mul_f32 v[36:37], v[28:29], v[20:21] op_sel:[0,0] op_sel_hi:[0,1]
    v_pk_mul_f32 v[38:39], v[30:31], v[22:23] op_sel:[0,0] op_sel_hi:[0,1]
    v_pk_fma_f32 v[80:81], v[28:29], v[20:21], v[36:37] op_sel:[1,1,0] op_sel_hi:[1,0,1] neg_lo:[1,0,0]
    v_pk_fma_f32 v[82:83], v[30:31], v[22:23], v[38:39] op_sel:[1,1,0] op_sel_hi:[1,0,1] neg_lo:[1,0,0]
    v_cvt_pk_bf16_f32 v6, v80, v81
    v_cvt_pk_bf16_f32 v7, v82, v83
    ds_write2_b64 v228, v[4:5], v[6:7] offset0:0 offset1:68
    v_pk_mul_f32 v[36:37], v[80:81], v[24:25] op_sel:[0,0] op_sel_hi:[0,1]
    v_pk_mul_f32 v[38:39], v[82:83], v[26:27] op_sel:[0,0] op_sel_hi:[0,1]
    v_pk_fma_f32 v[52:53], v[80:81], v[24:25], v[36:37] op_sel:[1,1,0] op_sel_hi:[1,0,1] neg_lo:[1,0,0]
    v_pk_fma_f32 v[54:55], v[82:83], v[26:27], v[38:39] op_sel:[1,1,0] op_sel_hi:[1,0,1] neg_lo:[1,0,0]
    v_cvt_pk_bf16_f32 v42, v52, v53
    v_cvt_pk_bf16_f32 v43, v54, v55
    ds_write2_b64 v230, v[40:41], v[42:43] offset0:0 offset1:68
    v_pk_mul_f32 v[36:37], v[80:81], v[20:21] op_sel:[0,0] op_sel_hi:[0,1]
    v_pk_mul_f32 v[38:39], v[82:83], v[22:23] op_sel:[0,0] op_sel_hi:[0,1]
    v_pk_fma_f32 v[84:85], v[80:81], v[20:21], v[36:37] op_sel:[1,1,0] op_sel_hi:[1,0,1] neg_lo:[1,0,0]
    v_pk_fma_f32 v[86:87], v[82:83], v[22:23], v[38:39] op_sel:[1,1,0] op_sel_hi:[1,0,1] neg_lo:[1,0,0]
    v_cvt_pk_bf16_f32 v44, v84, v85
    v_cvt_pk_bf16_f32 v45, v86, v87
    v_pk_mul_f32 v[36:37], v[84:85], v[24:25] op_sel:[0,0] op_sel_hi:[0,1]
    v_pk_mul_f32 v[38:39], v[86:87], v[26:27] op_sel:[0,0] op_sel_hi:[0,1]
    v_pk_fma_f32 v[56:57], v[84:85], v[24:25], v[36:37] op_sel:[1,1,0] op_sel_hi:[1,0,1] neg_lo:[1,0,0]
    v_pk_fma_f32 v[58:59], v[86:87], v[26:27], v[38:39] op_sel:[1,1,0] op_sel_hi:[1,0,1] neg_lo:[1,0,0]
    v_cvt_pk_bf16_f32 v4, v56, v57
    v_cvt_pk_bf16_f32 v5, v58, v59
    v_pk_mul_f32 v[36:37], v[84:85], v[20:21] op_sel:[0,0] op_sel_hi:[0,1]
    v_pk_mul_f32 v[38:39], v[86:87], v[22:23] op_sel:[0,0] op_sel_hi:[0,1]
    v_pk_fma_f32 v[80:81], v[84:85], v[20:21], v[36:37] op_sel:[1,1,0] op_sel_hi:[1,0,1] neg_lo:[1,0,0]
    v_pk_fma_f32 v[82:83], v[86:87], v[22:23], v[38:39] op_sel:[1,1,0] op_sel_hi:[1,0,1] neg_lo:[1,0,0]
    v_cvt_pk_bf16_f32 v46, v80, v81
    v_cvt_pk_bf16_f32 v47, v82, v83
    ds_write2_b64 v228, v[44:45], v[46:47] offset0:136 offset1:204
    v_pk_mul_f32 v[36:37], v[80:81], v[24:25] op_sel:[0,0] op_sel_hi:[0,1]
    v_pk_mul_f32 v[38:39], v[82:83], v[26:27] op_sel:[0,0] op_sel_hi:[0,1]
    v_pk_fma_f32 v[60:61], v[80:81], v[24:25], v[36:37] op_sel:[1,1,0] op_sel_hi:[1,0,1] neg_lo:[1,0,0]
    v_pk_fma_f32 v[62:63], v[82:83], v[26:27], v[38:39] op_sel:[1,1,0] op_sel_hi:[1,0,1] neg_lo:[1,0,0]
    v_cvt_pk_bf16_f32 v6, v60, v61
    v_cvt_pk_bf16_f32 v7, v62, v63
    ds_write2_b64 v230, v[4:5], v[6:7] offset0:136 offset1:204
    s_cmp_lg_u32 s24, 1
    s_cbranch_scc1 L_us_67
        global_load_dwordx4 v[200:203], v249, s[4:5] offset:0
        global_load_dwordx4 v[204:207], v249, s[4:5] offset:1280
        global_load_dwordx4 v[208:211], v249, s[4:5] offset:2560
        global_load_dwordx4 v[212:215], v249, s[4:5] offset:3840
L_us_67:
    v_pk_mul_f32 v[36:37], v[80:81], v[20:21] op_sel:[0,0] op_sel_hi:[0,1]
    v_pk_mul_f32 v[38:39], v[82:83], v[22:23] op_sel:[0,0] op_sel_hi:[0,1]
    v_pk_fma_f32 v[84:85], v[80:81], v[20:21], v[36:37] op_sel:[1,1,0] op_sel_hi:[1,0,1] neg_lo:[1,0,0]
    v_pk_fma_f32 v[86:87], v[82:83], v[22:23], v[38:39] op_sel:[1,1,0] op_sel_hi:[1,0,1] neg_lo:[1,0,0]
    v_cvt_pk_bf16_f32 v40, v84, v85
    v_cvt_pk_bf16_f32 v41, v86, v87
    v_pk_mul_f32 v[36:37], v[84:85], v[24:25] op_sel:[0,0] op_sel_hi:[0,1]
    v_pk_mul_f32 v[38:39], v[86:87], v[26:27] op_sel:[0,0] op_sel_hi:[0,1]
    v_pk_fma_f32 v[64:65], v[84:85], v[24:25], v[36:37] op_sel:[1,1,0] op_sel_hi:[1,0,1] neg_lo:[1,0,0]
    v_pk_fma_f32 v[66:67], v[86:87], v[26:27], v[38:39] op_sel:[1,1,0] op_sel_hi:[1,0,1] neg_lo:[1,0,0]
    v_cvt_pk_bf16_f32 v44, v64, v65
    v_cvt_pk_bf16_f32 v45, v66, v67
    v_pk_mul_f32 v[36:37], v[84:85], v[20:21] op_sel:[0,0] op_sel_hi:[0,1]
    v_pk_mul_f32 v[38:39], v[86:87], v[22:23] op_sel:[0,0] op_sel_hi:[0,1]
    v_pk_fma_f32 v[80:81], v[84:85], v[20:21], v[36:37] op_sel:[1,1,0] op_sel_hi:[1,0,1] neg_lo:[1,0,0]
    v_pk_fma_f32 v[82:83], v[86:87], v[22:23], v[38:39] op_sel:[1,1,0] op_sel_hi:[1,0,1] neg_lo:[1,0,0]
    v_cvt_pk_bf16_f32 v42, v80, v81
    v_cvt_pk_bf16_f32 v43, v82, v83
    ds_write2_b64 v229, v[40:41], v[42:43] offset0:0 offset1:68
    v_pk_mul_f32 v[36:37], v[80:81], v[24:25] op_sel:[0,0] op_sel_hi:[0,1]
    v_pk_mul_f32 v[38:39], v[82:83], v[26:27] op_sel:[0,0] op_sel_hi:[0,1]
    v_pk_fma_f32 v[68:69], v[80:81], v[24:25], v[36:37] op_sel:[1,1,0] op_sel_hi:[1,0,1] neg_lo:[1,0,0]
    v_pk_fma_f32 v[70:71], v[82:83], v[26:27], v[38:39] op_sel:[1,1,0] op_sel_hi:[1,0,1] neg_lo:[1,0,0]
    v_cvt_pk_bf16_f32 v46, v68, v69
    v_cvt_pk_bf16_f32 v47, v70, v71
    ds_write2_b64 v231, v[44:45], v[46:47] offset0:0 offset1:68
    v_pk_mul_f32 v[36:37], v[80:81], v[20:21] op_sel:[0,0] op_sel_hi:[0,1]
    v_pk_mul_f32 v[38:39], v[82:83], v[22:23] op_sel:[0,0] op_sel_hi:[0,1]
    v_pk_fma_f32 v[84:85], v[80:81], v[20:21], v[36:37] op_sel:[1,1,0] op_sel_hi:[1,0,1] neg_lo:[1,0,0]
    v_pk_fma_f32 v[86:87], v[82:83], v[22:23], v[38:39] op_sel:[1,1,0] op_sel_hi:[1,0,1] neg_lo:[1,0,0]
    v_cvt_pk_bf16_f32 v4, v84, v85
    v_cvt_pk_bf16_f32 v5, v86, v87
    v_pk_mul_f32 v[36:37], v[84:85], v[24:25] op_sel:[0,0] op_sel_hi:[0,1]
    v_pk_mul_f32 v[38:39], v[86:87], v[26:27] op_sel:[0,0] op_sel_hi:[0,1]
    v_pk_fma_f32 v[72:73], v[84:85], v[24:25], v[36:37] op_sel:[1,1,0] op_sel_hi:[1,0,1] neg_lo:[1,0,0]
    v_pk_fma_f32 v[74:75], v[86:87], v[26:27], v[38:39] op_sel:[1,1,0] op_sel_hi:[1,0,1] neg_lo:[1,0,0]
    v_cvt_pk_bf16_f32 v40, v72, v73
    v_cvt_pk_bf16_f32 v41, v74, v75
    v_pk_mul_f32 v[36:37], v[84:85], v[20:21] op_sel:[0,0] op_sel_hi:[0,1]
    v_pk_mul_f32 v[38:39], v[86:87], v[22:23] op_sel:[0,0] op_sel_hi:[0,1]
    v_pk_fma_f32 v[80:81], v[84:85], v[20:21], v[36:37] op_sel:[1,1,0] op_sel_hi:[1,0,1] neg_lo:[1,0,0]
    v_pk_fma_f32 v[82:83], v[86:87], v[22:23], v[38:39] op_sel:[1,1,0] op_sel_hi:[1,0,1] neg_lo:[1,0,0]
    v_cvt_pk_bf16_f32 v6, v80, v81
    v_cvt_pk_bf16_f32 v7, v82, v83
    ds_write2_b64 v229, v[4:5], v[6:7] offset0:136 offset1:204
    v_pk_mul_f32 v[36:37], v[80:81], v[24:25] op_sel:[0,0] op_sel_hi:[0,1]
    v_pk_mul_f32 v[38:39], v[82:83], v[26:27] op_sel:[0,0] op_sel_hi:[0,1]
    v_pk_fma_f32 v[76:77], v[80:81], v[24:25], v[36:37] op_sel:[1,1,0] op_sel_hi:[1,0,1] neg_lo:[1,0,0]
    v_pk_fma_f32 v[78:79], v[82:83], v[26:27], v[38:39] op_sel:[1,1,0] op_sel_hi:[1,0,1] neg_lo:[1,0,0]
    v_cvt_pk_bf16_f32 v42, v76, v77
    v_cvt_pk_bf16_f32 v43, v78, v79
    ds_write2_b64 v231, v[40:41], v[42:43] offset0:136 offset1:204
    ds_read_b128 v[120:123], v232 offset:0
    ds_read_b128 v[124:127], v232 offset:64
    ds_read_b128 v[128:131], v232 offset:128
    ds_read_b128 v[132:135], v232 offset:192
    ds_read_b128 v[136:139], v232 offset:256
    ds_read_b128 v[140:143], v232 offset:320
    ds_read_b128 v[144:147], v232 offset:384
    ds_read_b128 v[148:151], v232 offset:448
    v_pk_mul_f32 v[36:37], v[48:49], v[24:25] op_sel:[0,0] op_sel_hi:[0,1]
    v_pk_mul_f32 v[38:39], v[50:51], v[26:27] op_sel:[0,0] op_sel_hi:[0,1]
    v_pk_fma_f32 v[48:49], v[48:49], v[24:25], v[36:37] op_sel:[1,1,0] op_sel_hi:[1,0,1] neg_lo:[1,0,0]
    v_pk_fma_f32 v[50:51], v[50:51], v[26:27], v[38:39] op_sel:[1,1,0] op_sel_hi:[1,0,1] neg_lo:[1,0,0]
    v_cvt_pk_bf16_f32 v44, v48, v49
    v_cvt_pk_bf16_f32 v45, v50, v51
    v_pk_mul_f32 v[36:37], v[56:57], v[24:25] op_sel:[0,0] op_sel_hi:[0,1]
    v_pk_mul_f32 v[38:39], v[58:59], v[26:27] op_sel:[0,0] op_sel_hi:[0,1]
    v_pk_fma_f32 v[56:57], v[56:57], v[24:25], v[36:37] op_sel:[1,1,0] op_sel_hi:[1,0,1] neg_lo:[1,0,0]
    v_pk_fma_f32 v[58:59], v[58:59], v[26:27], v[38:39] op_sel:[1,1,0] op_sel_hi:[1,0,1] neg_lo:[1,0,0]
    v_cvt_pk_bf16_f32 v46, v56, v57
    v_cvt_pk_bf16_f32 v47, v58, v59
    ds_write2_b64 v228, v[44:45], v[46:47] offset0:0 offset1:68
    s_cmp_lg_u32 s24, 2
    s_cbranch_scc1 L_us_68
        global_load_dwordx4 v[200:203], v249, s[4:5] offset:0
        global_load_dwordx4 v[204:207], v249, s[4:5] offset:1280
        global_load_dwordx4 v[208:211], v249, s[4:5] offset:2560
        global_load_dwordx4 v[212:215], v249, s[4:5] offset:3840
L_us_68:
    v_pk_mul_f32 v[36:37], v[64:65], v[24:25] op_sel:[0,0] op_sel_hi:[0,1]
    v_pk_mul_f32 v[38:39], v[66:67], v[26:27] op_sel:[0,0] op_sel_hi:[0,1]
    v_pk_fma_f32 v[64:65], v[64:65], v[24:25], v[36:37] op_sel:[1,1,0] op_sel_hi:[1,0,1] neg_lo:[1,0,0]
    v_pk_fma_f32 v[66:67], v[66:67], v[26:27], v[38:39] op_sel:[1,1,0] op_sel_hi:[1,0,1] neg_lo:[1,0,0]
    v_cvt_pk_bf16_f32 v4, v64, v65
    v_cvt_pk_bf16_f32 v5, v66, v67
    v_pk_mul_f32 v[36:37], v[72:73], v[24:25] op_sel:[0,0] op_sel_hi:[0,1]
    v_pk_mul_f32 v[38:39], v[74:75], v[26:27] op_sel:[0,0] op_sel_hi:[0,1]
    v_pk_fma_f32 v[72:73], v[72:73], v[24:25], v[36:37] op_sel:[1,1,0] op_sel_hi:[1,0,1] neg_lo:[1,0,0]
    v_pk_fma_f32 v[74:75], v[74:75], v[26:27], v[38:39] op_sel:[1,1,0] op_sel_hi:[1,0,1] neg_lo:[1,0,0]
    v_cvt_pk_bf16_f32 v6, v72, v73
    v_cvt_pk_bf16_f32 v7, v74, v75
    ds_write2_b64 v228, v[4:5], v[6:7] offset0:136 offset1:204
    v_pk_mul_f32 v[36:37], v[48:49], v[24:25] op_sel:[0,0] op_sel_hi:[0,1]
    v_pk_mul_f32 v[38:39], v[50:51], v[26:27] op_sel:[0,0] op_sel_hi:[0,1]
    v_pk_fma_f32 v[48:49], v[48:49], v[24:25], v[36:37] op_sel:[1,1,0] op_sel_hi:[1,0,1] neg_lo:[1,0,0]
    v_pk_fma_f32 v[50:51], v[50:51], v[26:27], v[38:39] op_sel:[1,1,0] op_sel_hi:[1,0,1] neg_lo:[1,0,0]
    v_cvt_pk_bf16_f32 v40, v48, v49
    v_cvt_pk_bf16_f32 v41, v50, v51
    v_pk_mul_f32 v[36:37], v[56:57], v[24:25] op_sel:[0,0] op_sel_hi:[0,1]
    v_pk_mul_f32 v[38:39], v[58:59], v[26:27] op_sel:[0,0] op_sel_hi:[0,1]
    v_pk_fma_f32 v[56:57], v[56:57], v[24:25], v[36:37] op_sel:[1,1,0] op_sel_hi:[1,0,1] neg_lo:[1,0,0]
    v_pk_fma_f32 v[58:59], v[58:59], v[26:27], v[38:39] op_sel:[1,1,0] op_sel_hi:[1,0,1] neg_lo:[1,0,0]
    v_cvt_pk_bf16_f32 v42, v56, v57
    v_cvt_pk_bf16_f32 v43, v58, v59
    ds_write2_b64 v229, v[40:41], v[42:43] offset0:0 offset1:68
    v_pk_mul_f32 v[36:37], v[64:65], v[24:25] op_sel:[0,0] op_sel_hi:[0,1]
    v_pk_mul_f32 v[38:39], v[66:67], v[26:27] op_sel:[0,0] op_sel_hi:[0,1]
    v_pk_fma_f32 v[64:65], v[64:65], v[24:25], v[36:37] op_sel:[1,1,0] op_sel_hi:[1,0,1] neg_lo:[1,0,0]
    v_pk_fma_f32 v[66:67], v[66:67], v[26:27], v[38:39] op_sel:[1,1,0] op_sel_hi:[1,0,1] neg_lo:[1,0,0]
    v_cvt_pk_bf16_f32 v44, v64, v65
    v_cvt_pk_bf16_f32 v45, v66, v67
    v_pk_mul_f32 v[36:37], v[72:73], v[24:25] op_sel:[0,0] op_sel_hi:[0,1]
    v_pk_mul_f32 v[38:39], v[74:75], v[26:27] op_sel:[0,0] op_sel_hi:[0,1]
    v_pk_fma_f32 v[72:73], v[72:73], v[24:25], v[36:37] op_sel:[1,1,0] op_sel_hi:[1,0,1] neg_lo:[1,0,0]
    v_pk_fma_f32 v[74:75], v[74:75], v[26:27], v[38:39] op_sel:[1,1,0] op_sel_hi:[1,0,1] neg_lo:[1,0,0]
    v_cvt_pk_bf16_f32 v46, v72, v73
    v_cvt_pk_bf16_f32 v47, v74, v75
    ds_write2_b64 v229, v[44:45], v[46:47] offset0:136 offset1:204
    v_pk_mul_f32 v[36:37], v[48:49], v[24:25] op_sel:[0,0] op_sel_hi:[0,1]
    v_pk_mul_f32 v[38:39], v[50:51], v[26:27] op_sel:[0,0] op_sel_hi:[0,1]
    v_pk_fma_f32 v[48:49], v[48:49], v[24:25], v[36:37] op_sel:[1,1,0] op_sel_hi:[1,0,1] neg_lo:[1,0,0]
    v_pk_fma_f32 v[50:51], v[50:51], v[26:27], v[38:39] op_sel:[1,1,0] op_sel_hi:[1,0,1] neg_lo:[1,0,0]
    v_pk_mul_f32 v[36:37], v[64:65], v[24:25] op_sel:[0,0] op_sel_hi:[0,1]
    v_pk_mul_f32 v[38:39], v[66:67], v[26:27] op_sel:[0,0] op_sel_hi:[0,1]
    v_pk_fma_f32 v[64:65], v[64:65], v[24:25], v[36:37] op_sel:[1,1,0] op_sel_hi:[1,0,1] neg_lo:[1,0,0]
    v_pk_fma_f32 v[66:67], v[66:67], v[26:27], v[38:39] op_sel:[1,1,0] op_sel_hi:[1,0,1] neg_lo:[1,0,0]
    v_pk_mul_f32 v[36:37], v[48:49], v[32:33] op_sel:[0,0] op_sel_hi:[0,1]
    v_pk_mul_f32 v[38:39], v[50:51], v[34:35] op_sel:[0,0] op_sel_hi:[0,1]
    v_pk_fma_f32 v[56:57], v[48:49], v[32:33], v[36:37] op_sel:[1,1,0] op_sel_hi:[1,0,1] neg_lo:[1,0,0]
    v_pk_fma_f32 v[58:59], v[50:51], v[34:35], v[38:39] op_sel:[1,1,0] op_sel_hi:[1,0,1] neg_lo:[1,0,0]
    v_cvt_pk_bf16_f32 v4, v64, v65
    v_cvt_pk_bf16_f32 v5, v66, v67
    v_cvt_pk_bf16_f32 v6, v56, v57
    v_cvt_pk_bf16_f32 v7, v58, v59
    ds_write2_b64 v230, v[4:5], v[6:7] offset0:0 offset1:68
    v_pk_mul_f32 v[36:37], v[64:65], v[24:25] op_sel:[0,0] op_sel_hi:[0,1]
    v_pk_mul_f32 v[38:39], v[66:67], v[26:27] op_sel:[0,0] op_sel_hi:[0,1]
    v_pk_fma_f32 v[64:65], v[64:65], v[24:25], v[36:37] op_sel:[1,1,0] op_sel_hi:[1,0,1] neg_lo:[1,0,0]
    v_pk_fma_f32 v[66:67], v[66:67], v[26:27], v[38:39] op_sel:[1,1,0] op_sel_hi:[1,0,1] neg_lo:[1,0,0]
    v_pk_mul_f32 v[36:37], v[56:57], v[24:25] op_sel:[0,0] op_sel_hi:[0,1]
    v_pk_mul_f32 v[38:39], v[58:59], v[26:27] op_sel:[0,0] op_sel_hi:[0,1]
    v_pk_fma_f32 v[56:57], v[56:57], v[24:25], v[36:37] op_sel:[1,1,0] op_sel_hi:[1,0,1] neg_lo:[1,0,0]
    v_pk_fma_f32 v[58:59], v[58:59], v[26:27], v[38:39] op_sel:[1,1,0] op_sel_hi:[1,0,1] neg_lo:[1,0,0]
    v_cvt_pk_bf16_f32 v40, v64, v65
    v_cvt_pk_bf16_f32 v41, v66, v67
    v_cvt_pk_bf16_f32 v42, v56, v57
    v_cvt_pk_bf16_f32 v43, v58, v59
    ds_write2_b64 v230, v[40:41], v[42:43] offset0:136 offset1:204
    s_cmp_lg_u32 s24, 3
    s_cbranch_scc1 L_us_69
        global_load_dwordx4 v[200:203], v249, s[4:5] offset:0
        global_load_dwordx4 v[204:207], v249, s[4:5] offset:1280
        global_load_dwordx4 v[208:211], v249, s[4:5] offset:2560
        global_load_dwordx4 v[212:215], v249, s[4:5] offset:3840
L_us_69:
    v_pk_mul_f32 v[36:37], v[64:65], v[24:25] op_sel:[0,0] op_sel_hi:[0,1]
    v_pk_mul_f32 v[38:39], v[66:67], v[26:27] op_sel:[0,0] op_sel_hi:[0,1]
    v_pk_fma_f32 v[64:65], v[64:65], v[24:25], v[36:37] op_sel:[1,1,0] op_sel_hi:[1,0,1] neg_lo:[1,0,0]
    v_pk_fma_f32 v[66:67], v[66:67], v[26:27], v[38:39] op_sel:[1,1,0] op_sel_hi:[1,0,1] neg_lo:[1,0,0]
    v_pk_mul_f32 v[36:37], v[56:57], v[24:25] op_sel:[0,0] op_sel_hi:[0,1]
    v_pk_mul_f32 v[38:39], v[58:59], v[26:27] op_sel:[0,0] op_sel_hi:[0,1]
    v_pk_fma_f32 v[56:57], v[56:57], v[24:25], v[36:37] op_sel:[1,1,0] op_sel_hi:[1,0,1] neg_lo:[1,0,0]
    v_pk_fma_f32 v[58:59], v[58:59], v[26:27], v[38:39] op_sel:[1,1,0] op_sel_hi:[1,0,1] neg_lo:[1,0,0]
    v_cvt_pk_bf16_f32 v44, v64, v65
    v_cvt_pk_bf16_f32 v45, v66, v67
    v_cvt_pk_bf16_f32 v46, v56, v57
    v_cvt_pk_bf16_f32 v47, v58, v59
    ds_write2_b64 v231, v[44:45], v[46:47] offset0:0 offset1:68
    v_pk_mul_f32 v[36:37], v[64:65], v[24:25] op_sel:[0,0] op_sel_hi:[0,1]
    v_pk_mul_f32 v[38:39], v[66:67], v[26:27] op_sel:[0,0] op_sel_hi:[0,1]
    v_pk_fma_f32 v[64:65], v[64:65], v[24:25], v[36:37] op_sel:[1,1,0] op_sel_hi:[1,0,1] neg_lo:[1,0,0]
    v_pk_fma_f32 v[66:67], v[66:67], v[26:27], v[38:39] op_sel:[1,1,0] op_sel_hi:[1,0,1] neg_lo:[1,0,0]
    v_pk_mul_f32 v[36:37], v[56:57], v[24:25] op_sel:[0,0] op_sel_hi:[0,1]
    v_pk_mul_f32 v[38:39], v[58:59], v[26:27] op_sel:[0,0] op_sel_hi:[0,1]
    v_pk_fma_f32 v[56:57], v[56:57], v[24:25], v[36:37] op_sel:[1,1,0] op_sel_hi:[1,0,1] neg_lo:[1,0,0]
    v_pk_fma_f32 v[58:59], v[58:59], v[26:27], v[38:39] op_sel:[1,1,0] op_sel_hi:[1,0,1] neg_lo:[1,0,0]
    v_cvt_pk_bf16_f32 v4, v64, v65
    v_cvt_pk_bf16_f32 v5, v66, v67
    v_cvt_pk_bf16_f32 v6, v56, v57
    v_cvt_pk_bf16_f32 v7, v58, v59
    ds_write2_b64 v231, v[4:5], v[6:7] offset0:136 offset1:204
    ds_read_b128 v[152:155], v232 offset:0
    ds_read_b128 v[156:159], v232 offset:64
    ds_read_b128 v[160:163], v232 offset:128
    ds_read_b128 v[164:167], v232 offset:192
    ds_read_b128 v[168:171], v232 offset:256
    ds_read_b128 v[172:175], v232 offset:320
    ds_read_b128 v[176:179], v232 offset:384
    ds_read_b128 v[180:183], v232 offset:448
    v_pk_mul_f32 v[36:37], v[24:25], v[24:25] op_sel:[0,0] op_sel_hi:[0,1]
    v_pk_mul_f32 v[38:39], v[26:27], v[26:27] op_sel:[0,0] op_sel_hi:[0,1]
    v_pk_fma_f32 v[72:73], v[24:25], v[24:25], v[36:37] op_sel:[1,1,0] op_sel_hi:[1,0,1] neg_lo:[1,0,0]
    v_pk_fma_f32 v[74:75], v[26:27], v[26:27], v[38:39] op_sel:[1,1,0] op_sel_hi:[1,0,1] neg_lo:[1,0,0]
    v_pk_mul_f32 v[36:37], v[56:57], v[24:25] op_sel:[0,0] op_sel_hi:[0,1]
    v_pk_mul_f32 v[38:39], v[58:59], v[26:27] op_sel:[0,0] op_sel_hi:[0,1]
    v_pk_fma_f32 v[64:65], v[56:57], v[24:25], v[36:37] op_sel:[1,1,0] op_sel_hi:[1,0,1] neg_lo:[1,0,0]
    v_pk_fma_f32 v[66:67], v[58:59], v[26:27], v[38:39] op_sel:[1,1,0] op_sel_hi:[1,0,1] neg_lo:[1,0,0]
    v_pk_mul_f32 v[36:37], v[56:57], v[72:73] op_sel:[0,0] op_sel_hi:[0,1]
    v_pk_mul_f32 v[38:39], v[58:59], v[74:75] op_sel:[0,0] op_sel_hi:[0,1]
    v_pk_fma_f32 v[56:57], v[56:57], v[72:73], v[36:37] op_sel:[1,1,0] op_sel_hi:[1,0,1] neg_lo:[1,0,0]
    v_pk_fma_f32 v[58:59], v[58:59], v[74:75], v[38:39] op_sel:[1,1,0] op_sel_hi:[1,0,1] neg_lo:[1,0,0]
    v_cvt_pk_bf16_f32 v40, v48, v49
    v_cvt_pk_bf16_f32 v41, v50, v51
    ds_write_b64 v230, v[40:41] offset:0
    v_cvt_pk_bf16_f32 v44, v64, v65
    v_cvt_pk_bf16_f32 v45, v66, v67
    v_cvt_pk_bf16_f32 v46, v56, v57
    v_cvt_pk_bf16_f32 v47, v58, v59
    ds_write2_b64 v228, v[44:45], v[46:47] offset0:0 offset1:68
    v_pk_mul_f32 v[36:37], v[64:65], v[72:73] op_sel:[0,0] op_sel_hi:[0,1]
    v_pk_mul_f32 v[38:39], v[66:67], v[74:75] op_sel:[0,0] op_sel_hi:[0,1]
    v_pk_fma_f32 v[64:65], v[64:65], v[72:73], v[36:37] op_sel:[1,1,0] op_sel_hi:[1,0,1] neg_lo:[1,0,0]
    v_pk_fma_f32 v[66:67], v[66:67], v[74:75], v[38:39] op_sel:[1,1,0] op_sel_hi:[1,0,1] neg_lo:[1,0,0]
    v_cvt_pk_bf16_f32 v4, v64, v65
    v_cvt_pk_bf16_f32 v5, v66, v67
    v_pk_mul_f32 v[36:37], v[56:57], v[72:73] op_sel:[0,0] op_sel_hi:[0,1]
    v_pk_mul_f32 v[38:39], v[58:59], v[74:75] op_sel:[0,0] op_sel_hi:[0,1]
    v_pk_fma_f32 v[56:57], v[56:57], v[72:73], v[36:37] op_sel:[1,1,0] op_sel_hi:[1,0,1] neg_lo:[1,0,0]
    v_pk_fma_f32 v[58:59], v[58:59], v[74:75], v[38:39] op_sel:[1,1,0] op_sel_hi:[1,0,1] neg_lo:[1,0,0]
    v_cvt_pk_bf16_f32 v6, v56, v57
    v_cvt_pk_bf16_f32 v7, v58, v59
    ds_write2_b64 v228, v[4:5], v[6:7] offset0:136 offset1:204
    v_pk_mul_f32 v[36:37], v[64:65], v[72:73] op_sel:[0,0] op_sel_hi:[0,1]
    v_pk_mul_f32 v[38:39], v[66:67], v[74:75] op_sel:[0,0] op_sel_hi:[0,1]
    v_pk_fma_f32 v[64:65], v[64:65], v[72:73], v[36:37] op_sel:[1,1,0] op_sel_hi:[1,0,1] neg_lo:[1,0,0]
    v_pk_fma_f32 v[66:67], v[66:67], v[74:75], v[38:39] op_sel:[1,1,0] op_sel_hi:[1,0,1] neg_lo:[1,0,0]
    v_cvt_pk_bf16_f32 v40, v64, v65
    v_cvt_pk_bf16_f32 v41, v66, v67
    v_pk_mul_f32 v[36:37], v[56:57], v[72:73] op_sel:[0,0] op_sel_hi:[0,1]
    v_pk_mul_f32 v[38:39], v[58:59], v[74:75] op_sel:[0,0] op_sel_hi:[0,1]
    v_pk_fma_f32 v[56:57], v[56:57], v[72:73], v[36:37] op_sel:[1,1,0] op_sel_hi:[1,0,1] neg_lo:[1,0,0]
    v_pk_fma_f32 v[58:59], v[58:59], v[74:75], v[38:39] op_sel:[1,1,0] op_sel_hi:[1,0,1] neg_lo:[1,0,0]
    v_cvt_pk_bf16_f32 v42, v56, v57
    v_cvt_pk_bf16_f32 v43, v58, v59
    ds_write2_b64 v229, v[40:41], v[42:43] offset0:0 offset1:68
    v_pk_mul_f32 v[36:37], v[64:65], v[72:73] op_sel:[0,0] op_sel_hi:[0,1]
    v_pk_mul_f32 v[38:39], v[66:67], v[74:75] op_sel:[0,0] op_sel_hi:[0,1]
    v_pk_fma_f32 v[64:65], v[64:65], v[72:73], v[36:37] op_sel:[1,1,0] op_sel_hi:[1,0,1] neg_lo:[1,0,0]
    v_pk_fma_f32 v[66:67], v[66:67], v[74:75], v[38:39] op_sel:[1,1,0] op_sel_hi:[1,0,1] neg_lo:[1,0,0]
    v_cvt_pk_bf16_f32 v44, v64, v65
    v_cvt_pk_bf16_f32 v45, v66, v67
    v_pk_mul_f32 v[36:37], v[56:57], v[72:73] op_sel:[0,0] op_sel_hi:[0,1]
    v_pk_mul_f32 v[38:39], v[58:59], v[74:75] op_sel:[0,0] op_sel_hi:[0,1]
    v_pk_fma_f32 v[56:57], v[56:57], v[72:73], v[36:37] op_sel:[1,1,0] op_sel_hi:[1,0,1] neg_lo:[1,0,0]
    v_pk_fma_f32 v[58:59], v[58:59], v[74:75], v[38:39] op_sel:[1,1,0] op_sel_hi:[1,0,1] neg_lo:[1,0,0]
    v_cvt_pk_bf16_f32 v46, v56, v57
    v_cvt_pk_bf16_f32 v47, v58, v59
    ds_write2_b64 v229, v[44:45], v[46:47] offset0:136 offset1:204
    ds_read_b128 v[48:51], v232 offset:0
    ds_read_b128 v[52:55], v232 offset:64
    ds_read_b128 v[56:59], v232 offset:128
    ds_read_b128 v[60:63], v232 offset:192
    ds_read_b128 v[64:67], v232 offset:256
    ds_read_b128 v[68:71], v232 offset:320
    ds_read_b128 v[72:75], v232 offset:384
    ds_read_b128 v[76:79], v232 offset:448
    s_waitcnt lgkmcnt(15)
    v_mfma_f32_16x16x32_bf16 v[220:223], v[152:155], v[88:91], 0
    v_mfma_f32_16x16x32_bf16 v[216:219], v[120:123], v[88:91], 0
    v_mfma_f32_16x16x32_bf16 v[220:223], v[156:159], v[92:95], v[220:223]
    v_mfma_f32_16x16x32_bf16 v[216:219], v[124:127], v[92:95], v[216:219]
    v_mfma_f32_16x16x32_bf16 v[220:223], v[160:163], v[96:99], v[220:223]
    v_mfma_f32_16x16x32_bf16 v[216:219], v[128:131], v[96:99], v[216:219]
    v_mfma_f32_16x16x32_bf16 v[220:223], v[164:167], v[100:103], v[220:223]
    v_mfma_f32_16x16x32_bf16 v[216:219], v[132:135], v[100:103], v[216:219]
    v_mfma_f32_16x16x32_bf16 v[220:223], v[168:171], v[104:107], v[220:223]
    v_mfma_f32_16x16x32_bf16 v[216:219], v[136:139], v[104:107], v[216:219]
    v_mfma_f32_16x16x32_bf16 v[220:223], v[172:175], v[108:111], v[220:223]
    v_mfma_f32_16x16x32_bf16 v[216:219], v[140:143], v[108:111], v[216:219]
    s_waitcnt lgkmcnt(14)
    v_mfma_f32_16x16x32_bf16 v[220:223], v[176:179], v[112:115], v[220:223]
    v_mfma_f32_16x16x32_bf16 v[216:219], v[144:147], v[112:115], v[216:219]
    s_waitcnt lgkmcnt(13)
    v_mfma_f32_16x16x32_bf16 v[220:223], v[180:183], v[116:119], v[220:223]
    v_mfma_f32_16x16x32_bf16 v[216:219], v[148:151], v[116:119], v[216:219]
    s_waitcnt lgkmcnt(7)
    v_mfma_f32_16x16x32_bf16 v[224:227], v[88:91], v[48:51], 0
    s_waitcnt lgkmcnt(6)
    v_mfma_f32_16x16x32_bf16 v[224:227], v[92:95], v[52:55], v[224:227]
    s_waitcnt lgkmcnt(5)
    v_mfma_f32_16x16x32_bf16 v[224:227], v[96:99], v[56:59], v[224:227]
    s_waitcnt lgkmcnt(4)
    v_mfma_f32_16x16x32_bf16 v[224:227], v[100:103], v[60:63], v[224:227]
    s_waitcnt lgkmcnt(3)
    v_mfma_f32_16x16x32_bf16 v[224:227], v[104:107], v[64:67], v[224:227]
    s_waitcnt lgkmcnt(2)
    v_mfma_f32_16x16x32_bf16 v[224:227], v[108:111], v[68:71], v[224:227]
    s_waitcnt lgkmcnt(1)
    v_mfma_f32_16x16x32_bf16 v[224:227], v[112:115], v[72:75], v[224:227]
    s_waitcnt lgkmcnt(0)
    v_mfma_f32_16x16x32_bf16 v[224:227], v[116:119], v[76:79], v[224:227]
    v_lshlrev_b32 v13, 16, v13
    v_cvt_pk_bf16_f32 v16, v223, v222
    v_cvt_pk_bf16_f32 v17, v222, v222
    v_cvt_pk_bf16_f32 v18, v221, v220
    v_cvt_pk_bf16_f32 v19, v220, v220
    v_cvt_pk_bf16_f32 v20, v222, v221
    v_mov_b32 v21, v19
    s_mov_b64 exec, 1
    v_add_f32 v216, v216, v13
    s_mov_b32 exec_lo, -1
    ds_write_b128 v233, v[16:19] offset:7216
    ds_write_b16 v233, v16 offset:8434
    ds_write_b32 v233, v17 offset:8436
    ds_write_b64 v233, v[20:21] offset:8440
    ds_write_b16 v233, v19 offset:8448
    v_readlane_b32 s47, v16, 63
    s_not_b64 exec, exec
    ds_write_b32 v234, v18 offset:9660
    ds_write_b32 v234, v16 offset:9596
    s_mov_b64 exec, -1
    s_pack_ll_b32_b16 s47, s47, s47
    s_nop 0
    v_cvt_pk_bf16_f32 v22, v219, v218
    v_cvt_pk_bf16_f32 v23, v217, v216
    v_cvt_pk_bf16_f32 v24, v218, v217
    ds_write_b64 v235, v[22:23] offset:8952
    ds_write_b16 v235, v22 offset:7734
    ds_write_b32 v235, v24 offset:7736
    ds_write_b16_d16_hi v235, v23 offset:7740
    v_cvt_pk_bf16_f32 v26, v227, v226
    v_cvt_pk_bf16_f32 v27, v225, v224
    v_cvt_pk_bf16_f32 v28, v224, v224
    v_mov_b32_e64 v29, v28
    s_mov_b32 exec_lo, 0x00ff00ff
    s_mov_b32 exec_hi, 0x00ff00ff
    ds_write_b64 v236, v[26:27] offset:9784
    s_mov_b64 exec, 0x100
    ds_write_b64 v236, v[28:29] offset:6968
    ds_write_b16 v236, v28 offset:8186
    ds_write_b32 v236, v28 offset:8188
    ds_write_b16 v236, v28 offset:8192
    s_mov_b64 exec, -1
    s_cmp_ge_u32 s24, 4
    s_cbranch_scc1 L_tr_70
    s_mov_b32 s43, 0x05040100
    s_mov_b32 s45, 0x07060302
        s_waitcnt vmcnt(4)
    v_perm_b32 v32, v188, v184, s43
    v_perm_b32 v33, v196, v192, s43
    v_perm_b32 v34, v188, v184, s45
    v_perm_b32 v35, v196, v192, s45
    ds_write2st64_b64 v243, v[32:33], v[34:35] offset0:0 offset1:9
    v_perm_b32 v36, v189, v185, s43
    v_perm_b32 v37, v197, v193, s43
    v_perm_b32 v38, v189, v185, s45
    v_perm_b32 v39, v197, v193, s45
    ds_write2st64_b64 v243, v[36:37], v[38:39] offset0:18 offset1:27
    v_perm_b32 v32, v190, v186, s43
    v_perm_b32 v33, v198, v194, s43
    v_perm_b32 v34, v190, v186, s45
    v_perm_b32 v35, v198, v194, s45
    ds_write2st64_b64 v243, v[32:33], v[34:35] offset0:36 offset1:45
    v_perm_b32 v36, v191, v187, s43
    v_perm_b32 v37, v199, v195, s43
    v_perm_b32 v38, v191, v187, s45
    v_perm_b32 v39, v199, v195, s45
    ds_write2st64_b64 v243, v[36:37], v[38:39] offset0:54 offset1:63
L_tr_70:
    s_mul_i32 s43, s22, 327680
    s_lshl_b32 s44, s51, 12
    s_add_u32 s43, s43, s44
    s_add_u32 s43, s43, 4194304
    v_lshl_add_u32 v246, v1, 7, s43
    s_mul_i32 s44, s51, 13
    s_sub_u32 s44, s44, 32
    v_add_u32_e64 v247, s44, v1
    v_min_u32 v247, 1023, v247
    s_lshl_b32 s43, s22, 17
    s_add_u32 s43, s43, 8388608
    v_lshl_add_u32 v247, v247, 7, s43
    v_cmp_gt_u32 vcc, 32, v1
    s_nop 1
    v_cndmask_b32_e64 v246, v247, v246, vcc
    s_lshl_b32 s43, s22, 9
    s_mul_i32 s44, s26, 0
    s_add_u32 s43, s43, s44
    s_add_u32 s43, s43, 16312704
    v_lshl_add_u32 v247, v1, 7, s43
    v_cmp_gt_u32 vcc, 45, v1
    s_nop 1
    v_cndmask_b32_e64 v246, v247, v246, vcc
    s_mul_i32 s46, s70, 160
    s_movk_i32 s45, 1120
    v_lshl_add_u32 v4, v1, 4, s46
    v_mul_u32_u24 v5, 6554, v1
    v_lshrrev_b32 v6, 16, v5
    v_mad_u32_u24 v232, v6, s45, v4
    v_add_u32 v5, 419456, v5
    v_add_u32 v4, 1024, v4
    v_lshrrev_b32_e64 v6, 16, v5
    v_mad_u32_u24 v233, v6, s45, v4
    v_add_u32 v5, 419456, v5
    v_add_u32 v4, 1024, v4
    v_lshrrev_b32_e64 v6, 16, v5
    v_mad_u32_u24 v234, v6, s45, v4
    v_add_u32 v5, 419456, v5
    v_add_u32 v4, 1024, v4
    v_lshrrev_b32_e64 v6, 16, v5
    v_mad_u32_u24 v235, v6, s45, v4
    v_add_u32 v5, 419456, v5
    v_add_u32 v4, 1024, v4
    v_lshrrev_b32_e64 v6, 16, v5
    v_mad_u32_u24 v236, v6, s45, v4
    ds_read2_b32 v[48:49], v237 offset0:240 offset1:241
    ds_read2_b32 v[50:51], v237 offset0:242 offset1:243
    ds_read2_b32 v[80:81], v237 offset0:112 offset1:113
    ds_read2_b32 v[82:83], v237 offset0:114 offset1:115
    ds_read2_b32 v[112:113], v238 offset0:0 offset1:1
    ds_read2_b32 v[114:115], v238 offset0:2 offset1:3
    ds_read2_b32 v[52:53], v237 offset0:224 offset1:225
    ds_read2_b32 v[54:55], v237 offset0:226 offset1:227
    ds_read2_b32 v[84:85], v237 offset0:96 offset1:97
    ds_read2_b32 v[86:87], v237 offset0:98 offset1:99
    ds_read2_b32 v[56:57], v237 offset0:208 offset1:209
    ds_read2_b32 v[58:59], v237 offset0:210 offset1:211
    ds_read2_b32 v[88:89], v237 offset0:80 offset1:81
    ds_read2_b32 v[90:91], v237 offset0:82 offset1:83
    ds_read2_b32 v[60:61], v237 offset0:192 offset1:193
    ds_read2_b32 v[62:63], v237 offset0:194 offset1:195
    ds_read2_b32 v[92:93], v237 offset0:64 offset1:65
    ds_read2_b32 v[94:95], v237 offset0:66 offset1:67
    ds_read2_b32 v[64:65], v237 offset0:176 offset1:177
    ds_read2_b32 v[66:67], v237 offset0:178 offset1:179
    ds_read2_b32 v[96:97], v237 offset0:48 offset1:49
    ds_read2_b32 v[98:99], v237 offset0:50 offset1:51
    ds_read2_b32 v[68:69], v237 offset0:160 offset1:161
    ds_read2_b32 v[70:71], v237 offset0:162 offset1:163
    ds_read2_b32 v[100:101], v237 offset0:32 offset1:33
    ds_read2_b32 v[102:103], v237 offset0:34 offset1:35
    ds_read2_b32 v[72:73], v237 offset0:144 offset1:145
    ds_read2_b32 v[74:75], v237 offset0:146 offset1:147
    ds_read2_b32 v[104:105], v237 offset0:16 offset1:17
    ds_read2_b32 v[106:107], v237 offset0:18 offset1:19
    ds_read2_b32 v[76:77], v237 offset0:128 offset1:129
    ds_read2_b32 v[78:79], v237 offset0:130 offset1:131
    ds_read2_b32 v[108:109], v237 offset0:0 offset1:1
    ds_read2_b32 v[110:111], v237 offset0:2 offset1:3
    ds_read_b64 v[116:117], v239 offset:9400
    ds_read_b64 v[118:119], v239 offset:9408
    ds_read_b64 v[120:121], v239 offset:9416
    ds_read_b64 v[122:123], v239 offset:9424
    ds_read_b64 v[124:125], v239 offset:9272
    ds_read_b64 v[126:127], v239 offset:9280
    ds_read_b64 v[128:129], v239 offset:9288
    ds_read_b64 v[130:131], v239 offset:9296
    ds_read_b64 v[132:133], v239 offset:9144
    ds_read_b64 v[134:135], v239 offset:9152
    ds_read_b64 v[136:137], v239 offset:9160
    ds_read_b64 v[138:139], v239 offset:9168
    ds_read2_b32 v[140:141], v240 offset0:48 offset1:49
    ds_read2_b32 v[142:143], v240 offset0:50 offset1:51
    ds_read2_b32 v[144:145], v240 offset0:32 offset1:33
    ds_read2_b32 v[146:147], v240 offset0:34 offset1:35
    ds_read2_b32 v[148:149], v240 offset0:16 offset1:17
    ds_read2_b32 v[150:151], v240 offset0:18 offset1:19
    ds_read2_b32 v[152:153], v240 offset0:0 offset1:1
    ds_read2_b32 v[154:155], v240 offset0:2 offset1:3
    s_cmp_lt_u32 s24, 4
    s_cbranch_scc1 L_eb_71
    s_mul_i32 s43, s22, 80
    s_add_u32 s43, s43, s51
    s_add_u32 s43, s43, s24
    s_sub_u32 s43, s43, 8
    s_mul_i32 s43, s43, 1280
    v_lshl_add_u32 v245, v1, 7, s43
    s_mov_b64 exec, 0xfffff
    global_load_dword v253, v245, s[60:61]
    s_mov_b64 exec, -1
        s_barrier
L_eb_71:
    s_cmp_ge_u32 s24, 4
    s_cbranch_scc1 L_tr_72
    s_mov_b32 s43, 0x05040100
    s_mov_b32 s45, 0x07060302
        s_waitcnt vmcnt(0)
    v_perm_b32 v32, v204, v200, s43
    v_perm_b32 v33, v212, v208, s43
    v_perm_b32 v34, v204, v200, s45
    v_perm_b32 v35, v212, v208, s45
    ds_write2st64_b64 v244, v[32:33], v[34:35] offset0:0 offset1:9
    v_perm_b32 v36, v205, v201, s43
    v_perm_b32 v37, v213, v209, s43
    v_perm_b32 v38, v205, v201, s45
    v_perm_b32 v39, v213, v209, s45
    ds_write2st64_b64 v244, v[36:37], v[38:39] offset0:18 offset1:27
    v_perm_b32 v32, v206, v202, s43
    v_perm_b32 v33, v214, v210, s43
    v_perm_b32 v34, v206, v202, s45
    v_perm_b32 v35, v214, v210, s45
    ds_write2st64_b64 v244, v[32:33], v[34:35] offset0:36 offset1:45
    v_perm_b32 v36, v207, v203, s43
    v_perm_b32 v37, v215, v211, s43
    v_perm_b32 v38, v207, v203, s45
    v_perm_b32 v39, v215, v211, s45
    ds_write2st64_b64 v244, v[36:37], v[38:39] offset0:54 offset1:63
    s_waitcnt lgkmcnt(0)
    s_barrier
L_tr_72:
    ds_read_b128 v[216:219], v248 offset:2048
    ds_read_b128 v[208:211], v248 offset:0
    ds_read_b128 v[220:223], v248 offset:3072
    ds_read_b128 v[224:227], v248 offset:4096
    ds_read_b128 v[212:215], v248 offset:1024
    ds_read_b128 v[228:231], v248 offset:5120
    ds_read_b128 v[188:191], v241 offset:464
    ds_read_b128 v[192:195], v241 offset:480
    ds_read_b128 v[196:199], v241 offset:416
    ds_read_b128 v[200:203], v241 offset:352
    s_mov_b32 s28, s60
    s_and_b32 s29, s61, 0xffff
    s_mov_b32 s30, 819200
    s_mov_b32 s31, 0x20000
    s_mul_i32 s45, s24, 102400
    s_setprio 3
    s_waitcnt lgkmcnt(3)
    v_mfma_f32_16x16x32_bf16 v[16:19], v[188:191], v[216:219], 0
    v_mfma_f32_16x16x32_bf16 v[32:35], v[188:191], v[208:211], 0
    ds_read_b128 v[204:207], v241 offset:288
    s_waitcnt lgkmcnt(3)
    v_mfma_f32_16x16x32_bf16 v[20:23], v[192:195], v[220:223], 0
    v_mfma_f32_16x16x32_bf16 v[24:27], v[192:195], v[216:219], 0
    v_mfma_f32_16x16x32_bf16 v[28:31], v[192:195], v[224:227], 0
    v_mfma_f32_16x16x32_bf16 v[36:39], v[192:195], v[212:215], 0
    v_and_b32 v228, s47, v228
    v_and_b32 v229, s47, v229
    v_and_b32 v230, s47, v230
    v_and_b32_e64 v231, s47, v231
    s_nop 1
    v_mfma_f32_16x16x32_bf16 v[172:175], v[228:231], v[192:195], 0
    v_mfma_f32_16x16x32_bf16 v[164:167], v[112:115], v[192:195], 0
    v_mfma_f32_16x16x32_bf16 v[156:159], v[48:51], v[192:195], 0
    v_mfma_f32_16x16x32_bf16 v[160:163], v[80:83], v[192:195], 0
    ds_read_b128 v[188:191], v241 offset:224
    s_waitcnt lgkmcnt(3)
    v_mfma_f32_16x16x32_bf16 v[160:163], v[84:87], v[196:199], v[160:163]
    v_mfma_f32_16x16x32_bf16 v[156:159], v[52:55], v[196:199], v[156:159]
    s_mov_b32 exec_hi, 0xffff
    global_load_dword v254, v246, s[20:21] sc1
    s_mov_b32 exec_hi, -1
    ds_read_b128 v[192:195], v241 offset:160
    s_waitcnt lgkmcnt(3)
    s_nop 0
    v_mfma_f32_16x16x32_bf16 v[156:159], v[56:59], v[200:203], v[156:159]
    v_cvt_pk_bf16_f32 v4, v16, v20
    v_cvt_pk_bf16_f32 v5, v24, v28
    v_mfma_f32_16x16x32_bf16 v[160:163], v[88:91], v[200:203], v[160:163]
    v_cvt_pk_bf16_f32 v6, v17, v21
    v_cvt_pk_bf16_f32 v7, v25, v29
    ds_read_b128 v[196:199], v241 offset:96
    s_waitcnt lgkmcnt(3)
    s_nop 0
    v_mfma_f32_16x16x32_bf16 v[160:163], v[92:95], v[204:207], v[160:163]
    v_cvt_pk_bf16_f32 v8, v18, v22
    v_cvt_pk_bf16_f32 v9, v26, v30
    v_mfma_f32_16x16x32_bf16 v[156:159], v[60:63], v[204:207], v[156:159]
    v_cvt_pk_bf16_f32 v10, v19, v23
    v_cvt_pk_bf16_f32 v11, v27, v31
    ds_read_b128 v[200:203], v241 offset:32
    s_waitcnt lgkmcnt(3)
    s_nop 0
    v_mfma_f32_16x16x32_bf16 v[156:159], v[64:67], v[188:191], v[156:159]
    v_cvt_pk_bf16_f32 v12, v32, v36
    v_cvt_pk_bf16_f32 v13, v33, v37
    v_mfma_f32_16x16x32_bf16 v[160:163], v[96:99], v[188:191], v[160:163]
    v_cvt_pk_bf16_f32 v14, v34, v38
    v_cvt_pk_bf16_f32 v15, v35, v39
    ds_read_b128 v[204:207], v241 offset:976
    s_waitcnt lgkmcnt(3)
    v_mfma_f32_16x16x32_bf16 v[160:163], v[100:103], v[192:195], v[160:163]
    v_mfma_f32_16x16x32_bf16 v[156:159], v[68:71], v[192:195], v[156:159]
    ds_read_b128 v[188:191], v241 offset:992
    s_waitcnt lgkmcnt(3)
    v_mfma_f32_16x16x32_bf16 v[156:159], v[72:75], v[196:199], v[156:159]
    v_mfma_f32_16x16x32_bf16 v[160:163], v[104:107], v[196:199], v[160:163]
    ds_read_b128 v[192:195], v241 offset:928
    s_waitcnt lgkmcnt(3)
    v_mfma_f32_16x16x32_bf16 v[160:163], v[108:111], v[200:203], v[160:163]
    v_mfma_f32_16x16x32_bf16 v[156:159], v[76:79], v[200:203], v[156:159]
    v_mfma_f32_16x16x32_bf16 v[164:167], v[4:7], v[116:119], v[164:167]
    v_mfma_f32_16x16x32_bf16 v[164:167], v[8:11], v[120:123], v[164:167]
    v_mfma_f32_16x16x32_bf16 v[168:171], v[4:7], v[124:127], 0
    v_mfma_f32_16x16x32_bf16 v[168:171], v[8:11], v[128:131], v[168:171]
    v_mfma_f32_16x16x32_bf16 v[172:175], v[4:7], v[132:135], v[172:175]
    v_mfma_f32_16x16x32_bf16 v[172:175], v[8:11], v[136:139], v[172:175]
    v_mfma_f32_16x16x32_bf16 v[172:175], v[12:15], v[140:143], v[172:175]
    v_mfma_f32_16x16x32_bf16 v[176:179], v[12:15], v[144:147], 0
    v_mfma_f32_16x16x32_bf16 v[180:183], v[12:15], v[148:151], 0
    v_mfma_f32_16x16x32_bf16 v[184:187], v[12:15], v[152:155], 0
    ds_read_b128 v[196:199], v241 offset:864
    s_waitcnt lgkmcnt(3)
    v_mfma_f32_16x16x32_bf16 v[16:19], v[204:207], v[216:219], 0
    v_mfma_f32_16x16x32_bf16 v[32:35], v[204:207], v[208:211], 0
    ds_read_b128 v[200:203], v241 offset:800
    s_waitcnt lgkmcnt(3)
    v_mfma_f32_16x16x32_bf16 v[20:23], v[188:191], v[220:223], 0
    v_mfma_f32_16x16x32_bf16 v[24:27], v[188:191], v[216:219], 0
    v_mfma_f32_16x16x32_bf16 v[28:31], v[188:191], v[224:227], 0
    v_mfma_f32_16x16x32_bf16 v[36:39], v[188:191], v[212:215], 0
    v_mfma_f32_16x16x32_bf16 v[176:179], v[228:231], v[188:191], v[176:179]
    v_mfma_f32_16x16x32_bf16 v[168:171], v[112:115], v[188:191], v[168:171]
    v_mfma_f32_16x16x32_bf16 v[160:163], v[48:51], v[188:191], v[160:163]
    v_mfma_f32_16x16x32_bf16 v[164:167], v[80:83], v[188:191], v[164:167]
    ds_read_b128 v[204:207], v241 offset:736
    s_waitcnt lgkmcnt(3)
    v_mfma_f32_16x16x32_bf16 v[164:167], v[84:87], v[192:195], v[164:167]
    v_mfma_f32_16x16x32_bf16 v[160:163], v[52:55], v[192:195], v[160:163]
    ds_read_b128 v[188:191], v241 offset:672
    s_waitcnt lgkmcnt(3)
    v_mfma_f32_16x16x32_bf16 v[160:163], v[56:59], v[196:199], v[160:163]
    s_nop 0
    v_cvt_pk_bf16_f32 v4, v16, v20
    v_cvt_pk_bf16_f32 v5, v24, v28
    v_mfma_f32_16x16x32_bf16 v[164:167], v[88:91], v[196:199], v[164:167]
    v_cvt_pk_bf16_f32 v6, v17, v21
    v_cvt_pk_bf16_f32 v7, v25, v29
    s_add_u32 m0, s55, 0
    s_nop 0
    buffer_load_dwordx4 v232, s[28:31], s45 offen lds
    ds_read_b128 v[192:195], v241 offset:608
    s_waitcnt lgkmcnt(3)
    s_nop 0
    v_mfma_f32_16x16x32_bf16 v[164:167], v[92:95], v[200:203], v[164:167]
    v_cvt_pk_bf16_f32 v8, v18, v22
    v_cvt_pk_bf16_f32 v9, v26, v30
    v_mfma_f32_16x16x32_bf16 v[160:163], v[60:63], v[200:203], v[160:163]
    v_cvt_pk_bf16_f32 v10, v19, v23
    v_cvt_pk_bf16_f32 v11, v27, v31
    ds_read_b128 v[196:199], v241 offset:544
    s_waitcnt lgkmcnt(3)
    s_nop 0
    v_mfma_f32_16x16x32_bf16 v[160:163], v[64:67], v[204:207], v[160:163]
    v_cvt_pk_bf16_f32 v12, v32, v36
    v_cvt_pk_bf16_f32 v13, v33, v37
    v_mfma_f32_16x16x32_bf16 v[164:167], v[96:99], v[204:207], v[164:167]
    v_cvt_pk_bf16_f32 v14, v34, v38
    v_cvt_pk_bf16_f32 v15, v35, v39
    ds_read_b128 v[200:203], v241 offset:1488
    s_waitcnt lgkmcnt(3)
    v_mfma_f32_16x16x32_bf16 v[164:167], v[100:103], v[188:191], v[164:167]
    v_mfma_f32_16x16x32_bf16 v[160:163], v[68:71], v[188:191], v[160:163]
    ds_read_b128 v[204:207], v241 offset:1504
    s_waitcnt lgkmcnt(3)
    v_mfma_f32_16x16x32_bf16 v[160:163], v[72:75], v[192:195], v[160:163]
    v_mfma_f32_16x16x32_bf16 v[164:167], v[104:107], v[192:195], v[164:167]
    s_add_u32 m0, s55, 1024
    s_nop 0
    buffer_load_dwordx4 v233, s[28:31], s45 offen lds
    ds_read_b128 v[188:191], v241 offset:1440
    s_waitcnt lgkmcnt(3)
    v_mfma_f32_16x16x32_bf16 v[164:167], v[108:111], v[196:199], v[164:167]
    v_mfma_f32_16x16x32_bf16 v[160:163], v[76:79], v[196:199], v[160:163]
    v_mfma_f32_16x16x32_bf16 v[168:171], v[4:7], v[116:119], v[168:171]
    v_mfma_f32_16x16x32_bf16 v[168:171], v[8:11], v[120:123], v[168:171]
    v_mfma_f32_16x16x32_bf16 v[172:175], v[4:7], v[124:127], v[172:175]
    v_mfma_f32_16x16x32_bf16 v[172:175], v[8:11], v[128:131], v[172:175]
    v_mfma_f32_16x16x32_bf16 v[176:179], v[4:7], v[132:135], v[176:179]
    v_mfma_f32_16x16x32_bf16 v[176:179], v[8:11], v[136:139], v[176:179]
    v_mfma_f32_16x16x32_bf16 v[176:179], v[12:15], v[140:143], v[176:179]
    v_mfma_f32_16x16x32_bf16 v[180:183], v[12:15], v[144:147], v[180:183]
    v_mfma_f32_16x16x32_bf16 v[184:187], v[12:15], v[148:151], v[184:187]
    s_setprio 2
    ds_read_b128 v[192:195], v241 offset:1376
    s_waitcnt lgkmcnt(3)
    v_mfma_f32_16x16x32_bf16 v[16:19], v[200:203], v[216:219], 0
    v_mfma_f32_16x16x32_bf16 v[32:35], v[200:203], v[208:211], 0
    ds_read_b128 v[196:199], v241 offset:1312
    s_waitcnt lgkmcnt(3)
    v_mfma_f32_16x16x32_bf16 v[20:23], v[204:207], v[220:223], 0
    v_mfma_f32_16x16x32_bf16 v[24:27], v[204:207], v[216:219], 0
    v_mfma_f32_16x16x32_bf16 v[28:31], v[204:207], v[224:227], 0
    v_mfma_f32_16x16x32_bf16 v[36:39], v[204:207], v[212:215], 0
    v_mfma_f32_16x16x32_bf16 v[180:183], v[228:231], v[204:207], v[180:183]
    v_mfma_f32_16x16x32_bf16 v[172:175], v[112:115], v[204:207], v[172:175]
    v_mfma_f32_16x16x32_bf16 v[164:167], v[48:51], v[204:207], v[164:167]
    v_mfma_f32_16x16x32_bf16 v[168:171], v[80:83], v[204:207], v[168:171]
    ds_read_b128 v[200:203], v241 offset:1248
    s_waitcnt lgkmcnt(3)
    v_mfma_f32_16x16x32_bf16 v[168:171], v[84:87], v[188:191], v[168:171]
    v_mfma_f32_16x16x32_bf16 v[164:167], v[52:55], v[188:191], v[164:167]
    ds_read_b128 v[204:207], v241 offset:1184
    s_waitcnt lgkmcnt(3)
    s_nop 0
    v_mfma_f32_16x16x32_bf16 v[164:167], v[56:59], v[192:195], v[164:167]
    v_cvt_pk_bf16_f32 v40, v156, v157
    v_cvt_pk_bf16_f32 v41, v158, v159
    v_mfma_f32_16x16x32_bf16 v[168:171], v[88:91], v[192:195], v[168:171]
    v_cvt_pk_bf16_f32 v42, v160, v161
    v_cvt_pk_bf16_f32 v43, v162, v163
    s_add_u32 m0, s55, 2048
    s_nop 0
    buffer_load_dwordx4 v234, s[28:31], s45 offen lds
    ds_read_b128 v[188:191], v241 offset:1120
    s_waitcnt lgkmcnt(3)
    v_mfma_f32_16x16x32_bf16 v[168:171], v[92:95], v[196:199], v[168:171]
    v_permlane16_swap_b32 v40, v42
    v_permlane16_swap_b32 v41, v43
    v_mfma_f32_16x16x32_bf16 v[164:167], v[60:63], v[196:199], v[164:167]
    global_store_dwordx4 v242, v[40:43], s[20:21] sc1
    v_add_u32 v242, 656384, v242
    ds_read_b128 v[192:195], v241 offset:1056
    s_waitcnt lgkmcnt(3)
    s_nop 0
    v_mfma_f32_16x16x32_bf16 v[164:167], v[64:67], v[200:203], v[164:167]
    v_cvt_pk_bf16_f32 v4, v16, v20
    v_cvt_pk_bf16_f32 v5, v24, v28
    v_mfma_f32_16x16x32_bf16 v[168:171], v[96:99], v[200:203], v[168:171]
    v_cvt_pk_bf16_f32 v6, v17, v21
    v_cvt_pk_bf16_f32 v7, v25, v29
    ds_read_b128 v[196:199], v241 offset:2000
    s_waitcnt lgkmcnt(3)
    s_nop 0
    v_mfma_f32_16x16x32_bf16 v[168:171], v[100:103], v[204:207], v[168:171]
    v_cvt_pk_bf16_f32 v8, v18, v22
    v_cvt_pk_bf16_f32 v9, v26, v30
    v_mfma_f32_16x16x32_bf16 v[164:167], v[68:71], v[204:207], v[164:167]
    v_cvt_pk_bf16_f32 v10, v19, v23
    v_cvt_pk_bf16_f32 v11, v27, v31
    ds_read_b128 v[200:203], v241 offset:2016
    s_waitcnt lgkmcnt(3)
    s_nop 0
    v_mfma_f32_16x16x32_bf16 v[164:167], v[72:75], v[188:191], v[164:167]
    v_cvt_pk_bf16_f32 v12, v32, v36
    v_cvt_pk_bf16_f32 v13, v33, v37
    v_mfma_f32_16x16x32_bf16 v[168:171], v[104:107], v[188:191], v[168:171]
    v_cvt_pk_bf16_f32 v14, v34, v38
    v_cvt_pk_bf16_f32 v15, v35, v39
    s_add_u32 m0, s55, 3072
    s_nop 0
    buffer_load_dwordx4 v235, s[28:31], s45 offen lds
    ds_read_b128 v[204:207], v241 offset:1952
    s_waitcnt lgkmcnt(3)
    v_mfma_f32_16x16x32_bf16 v[168:171], v[108:111], v[192:195], v[168:171]
    v_mfma_f32_16x16x32_bf16 v[164:167], v[76:79], v[192:195], v[164:167]
    v_mfma_f32_16x16x32_bf16 v[172:175], v[4:7], v[116:119], v[172:175]
    v_mfma_f32_16x16x32_bf16 v[172:175], v[8:11], v[120:123], v[172:175]
    v_mfma_f32_16x16x32_bf16 v[176:179], v[4:7], v[124:127], v[176:179]
    v_mfma_f32_16x16x32_bf16 v[176:179], v[8:11], v[128:131], v[176:179]
    v_mfma_f32_16x16x32_bf16 v[180:183], v[4:7], v[132:135], v[180:183]
    v_mfma_f32_16x16x32_bf16 v[180:183], v[8:11], v[136:139], v[180:183]
    v_mfma_f32_16x16x32_bf16 v[180:183], v[12:15], v[140:143], v[180:183]
    v_mfma_f32_16x16x32_bf16 v[184:187], v[12:15], v[144:147], v[184:187]
    ds_read_b128 v[188:191], v241 offset:1888
    s_waitcnt lgkmcnt(3)
    v_mfma_f32_16x16x32_bf16 v[16:19], v[196:199], v[216:219], 0
    v_mfma_f32_16x16x32_bf16 v[32:35], v[196:199], v[208:211], 0
    ds_read_b128 v[192:195], v241 offset:1824
    s_waitcnt lgkmcnt(3)
    v_mfma_f32_16x16x32_bf16 v[20:23], v[200:203], v[220:223], 0
    v_mfma_f32_16x16x32_bf16 v[24:27], v[200:203], v[216:219], 0
    v_mfma_f32_16x16x32_bf16 v[28:31], v[200:203], v[224:227], 0
    v_mfma_f32_16x16x32_bf16 v[36:39], v[200:203], v[212:215], 0
    v_mfma_f32_16x16x32_bf16 v[184:187], v[228:231], v[200:203], v[184:187]
    v_mfma_f32_16x16x32_bf16 v[176:179], v[112:115], v[200:203], v[176:179]
    v_mfma_f32_16x16x32_bf16 v[168:171], v[48:51], v[200:203], v[168:171]
    v_mfma_f32_16x16x32_bf16 v[172:175], v[80:83], v[200:203], v[172:175]
    ds_read_b128 v[196:199], v241 offset:1760
    s_waitcnt lgkmcnt(3)
    v_mfma_f32_16x16x32_bf16 v[172:175], v[84:87], v[204:207], v[172:175]
    v_mfma_f32_16x16x32_bf16 v[168:171], v[52:55], v[204:207], v[168:171]
    ds_read_b128 v[200:203], v241 offset:1696
    s_waitcnt lgkmcnt(3)
    v_mfma_f32_16x16x32_bf16 v[168:171], v[56:59], v[188:191], v[168:171]
    v_cvt_pk_bf16_f32 v4, v16, v20
    v_cvt_pk_bf16_f32 v5, v24, v28
    v_mfma_f32_16x16x32_bf16 v[172:175], v[88:91], v[188:191], v[172:175]
    v_cvt_pk_bf16_f32 v6, v17, v21
    v_cvt_pk_bf16_f32 v7, v25, v29
    s_add_u32 m0, s55, 4096
    s_nop 0
    buffer_load_dwordx4 v236, s[28:31], s45 offen lds
    ds_read_b128 v[204:207], v241 offset:1632
    s_waitcnt lgkmcnt(3)
    v_mfma_f32_16x16x32_bf16 v[172:175], v[92:95], v[192:195], v[172:175]
    v_cvt_pk_bf16_f32 v8, v18, v22
    v_cvt_pk_bf16_f32 v9, v26, v30
    v_mfma_f32_16x16x32_bf16 v[168:171], v[60:63], v[192:195], v[168:171]
    v_cvt_pk_bf16_f32 v10, v19, v23
    v_cvt_pk_bf16_f32 v11, v27, v31
    ds_read_b128 v[188:191], v241 offset:1568
    s_waitcnt lgkmcnt(3)
    s_nop 0
    v_mfma_f32_16x16x32_bf16 v[168:171], v[64:67], v[196:199], v[168:171]
    v_cvt_pk_bf16_f32 v12, v32, v36
    v_cvt_pk_bf16_f32 v13, v33, v37
    v_mfma_f32_16x16x32_bf16 v[172:175], v[96:99], v[196:199], v[172:175]
    v_cvt_pk_bf16_f32 v14, v34, v38
    v_cvt_pk_bf16_f32 v15, v35, v39
    ds_read_b128 v[192:195], v241 offset:2512
    s_waitcnt lgkmcnt(3)
    v_mfma_f32_16x16x32_bf16 v[172:175], v[100:103], v[200:203], v[172:175]
    v_mfma_f32_16x16x32_bf16 v[168:171], v[68:71], v[200:203], v[168:171]
    ds_read_b128 v[196:199], v241 offset:2528
    s_waitcnt lgkmcnt(3)
    v_mfma_f32_16x16x32_bf16 v[168:171], v[72:75], v[204:207], v[168:171]
    v_mfma_f32_16x16x32_bf16 v[172:175], v[104:107], v[204:207], v[172:175]
    s_add_u32 m0, s55, 5120
    s_add_u32 s45, s45, 40960
    buffer_load_dwordx4 v232, s[28:31], s45 offen lds
    ds_read_b128 v[200:203], v241 offset:2464
    s_waitcnt lgkmcnt(3)
    v_mfma_f32_16x16x32_bf16 v[172:175], v[108:111], v[188:191], v[172:175]
    v_mfma_f32_16x16x32_bf16 v[168:171], v[76:79], v[188:191], v[168:171]
    v_mfma_f32_16x16x32_bf16 v[176:179], v[4:7], v[116:119], v[176:179]
    v_mfma_f32_16x16x32_bf16 v[176:179], v[8:11], v[120:123], v[176:179]
    v_mfma_f32_16x16x32_bf16 v[180:183], v[4:7], v[124:127], v[180:183]
    v_mfma_f32_16x16x32_bf16 v[180:183], v[8:11], v[128:131], v[180:183]
    v_mfma_f32_16x16x32_bf16 v[184:187], v[4:7], v[132:135], v[184:187]
    v_mfma_f32_16x16x32_bf16 v[184:187], v[8:11], v[136:139], v[184:187]
    v_mfma_f32_16x16x32_bf16 v[184:187], v[12:15], v[140:143], v[184:187]
    s_setprio 1
    ds_read_b128 v[204:207], v241 offset:2400
    s_waitcnt lgkmcnt(3)
    v_mfma_f32_16x16x32_bf16 v[16:19], v[192:195], v[216:219], 0
    ds_read_b128 v[188:191], v241 offset:2336
    s_waitcnt lgkmcnt(3)
    v_mfma_f32_16x16x32_bf16 v[20:23], v[196:199], v[220:223], 0
    v_mfma_f32_16x16x32_bf16 v[24:27], v[196:199], v[216:219], 0
    v_mfma_f32_16x16x32_bf16 v[28:31], v[196:199], v[224:227], 0
    v_mfma_f32_16x16x32_bf16 v[180:183], v[112:115], v[196:199], v[180:183]
    v_mfma_f32_16x16x32_bf16 v[172:175], v[48:51], v[196:199], v[172:175]
    v_mfma_f32_16x16x32_bf16 v[176:179], v[80:83], v[196:199], v[176:179]
    ds_read_b128 v[192:195], v241 offset:2272
    s_waitcnt lgkmcnt(3)
    v_mfma_f32_16x16x32_bf16 v[176:179], v[84:87], v[200:203], v[176:179]
    v_mfma_f32_16x16x32_bf16 v[172:175], v[52:55], v[200:203], v[172:175]
    ds_read_b128 v[196:199], v241 offset:2208
    s_waitcnt lgkmcnt(3)
    v_mfma_f32_16x16x32_bf16 v[172:175], v[56:59], v[204:207], v[172:175]
    v_cvt_pk_bf16_f32 v44, v164, v165
    v_cvt_pk_bf16_f32 v45, v166, v167
    v_mfma_f32_16x16x32_bf16 v[176:179], v[88:91], v[204:207], v[176:179]
    v_cvt_pk_bf16_f32 v46, v168, v169
    v_cvt_pk_bf16_f32 v47, v170, v171
    s_add_u32 m0, s55, 6144
    s_nop 0
    buffer_load_dwordx4 v233, s[28:31], s45 offen lds
    ds_read_b128 v[200:203], v241 offset:2144
    s_waitcnt lgkmcnt(3)
    v_mfma_f32_16x16x32_bf16 v[176:179], v[92:95], v[188:191], v[176:179]
    v_permlane16_swap_b32 v44, v46
    v_permlane16_swap_b32 v45, v47
    v_mfma_f32_16x16x32_bf16 v[172:175], v[60:63], v[188:191], v[172:175]
    global_store_dwordx4 v242, v[44:47], s[20:21] sc1
    v_add_u32 v242, 656384, v242
    ds_read_b128 v[204:207], v241 offset:2080
    s_waitcnt lgkmcnt(3)
    s_nop 0
    v_mfma_f32_16x16x32_bf16 v[172:175], v[64:67], v[192:195], v[172:175]
    v_cvt_pk_bf16_f32 v4, v16, v20
    v_cvt_pk_bf16_f32 v5, v24, v28
    v_mfma_f32_16x16x32_bf16 v[176:179], v[96:99], v[192:195], v[176:179]
    v_cvt_pk_bf16_f32 v6, v17, v21
    v_cvt_pk_bf16_f32 v7, v25, v29
    ds_read_b128 v[188:191], v241 offset:3024
    s_waitcnt lgkmcnt(3)
    s_nop 0
    v_mfma_f32_16x16x32_bf16 v[176:179], v[100:103], v[196:199], v[176:179]
    v_cvt_pk_bf16_f32 v8, v18, v22
    v_cvt_pk_bf16_f32 v9, v26, v30
    v_mfma_f32_16x16x32_bf16 v[172:175], v[68:71], v[196:199], v[172:175]
    v_cvt_pk_bf16_f32 v10, v19, v23
    v_cvt_pk_bf16_f32 v11, v27, v31
    ds_read_b128 v[192:195], v241 offset:3040
    s_waitcnt lgkmcnt(3)
    v_mfma_f32_16x16x32_bf16 v[172:175], v[72:75], v[200:203], v[172:175]
    v_mfma_f32_16x16x32_bf16 v[176:179], v[104:107], v[200:203], v[176:179]
    s_add_u32 m0, s55, 7168
    s_nop 0
    buffer_load_dwordx4 v234, s[28:31], s45 offen lds
    ds_read_b128 v[196:199], v241 offset:2976
    s_waitcnt lgkmcnt(3)
    v_mfma_f32_16x16x32_bf16 v[176:179], v[108:111], v[204:207], v[176:179]
    v_mfma_f32_16x16x32_bf16 v[172:175], v[76:79], v[204:207], v[172:175]
    v_mfma_f32_16x16x32_bf16 v[180:183], v[4:7], v[116:119], v[180:183]
    v_mfma_f32_16x16x32_bf16 v[180:183], v[8:11], v[120:123], v[180:183]
    v_mfma_f32_16x16x32_bf16 v[184:187], v[4:7], v[124:127], v[184:187]
    v_mfma_f32_16x16x32_bf16 v[184:187], v[8:11], v[128:131], v[184:187]
    ds_read_b128 v[200:203], v241 offset:2912
    s_waitcnt lgkmcnt(3)
    v_mfma_f32_16x16x32_bf16 v[16:19], v[188:191], v[216:219], 0
    ds_read_b128 v[204:207], v241 offset:2848
    s_waitcnt lgkmcnt(3)
    v_mfma_f32_16x16x32_bf16 v[20:23], v[192:195], v[220:223], 0
    v_mfma_f32_16x16x32_bf16 v[24:27], v[192:195], v[216:219], 0
    v_mfma_f32_16x16x32_bf16 v[28:31], v[192:195], v[224:227], 0
    v_mfma_f32_16x16x32_bf16 v[184:187], v[112:115], v[192:195], v[184:187]
    v_mfma_f32_16x16x32_bf16 v[176:179], v[48:51], v[192:195], v[176:179]
    v_mfma_f32_16x16x32_bf16 v[180:183], v[80:83], v[192:195], v[180:183]
    ds_read_b128 v[188:191], v241 offset:2784
    s_waitcnt lgkmcnt(3)
    v_mfma_f32_16x16x32_bf16 v[180:183], v[84:87], v[196:199], v[180:183]
    v_mfma_f32_16x16x32_bf16 v[176:179], v[52:55], v[196:199], v[176:179]
    ds_read_b128 v[192:195], v241 offset:2720
    s_waitcnt lgkmcnt(3)
    s_nop 0
    v_mfma_f32_16x16x32_bf16 v[176:179], v[56:59], v[200:203], v[176:179]
    v_cvt_pk_bf16_f32 v4, v16, v20
    v_cvt_pk_bf16_f32 v5, v24, v28
    v_mfma_f32_16x16x32_bf16 v[180:183], v[88:91], v[200:203], v[180:183]
    v_cvt_pk_bf16_f32 v6, v17, v21
    v_cvt_pk_bf16_f32 v7, v25, v29
    s_add_u32 m0, s55, 8192
    s_nop 0
    buffer_load_dwordx4 v235, s[28:31], s45 offen lds
    ds_read_b128 v[196:199], v241 offset:2656
    s_waitcnt lgkmcnt(3)
    v_mfma_f32_16x16x32_bf16 v[180:183], v[92:95], v[204:207], v[180:183]
    v_cvt_pk_bf16_f32 v8, v18, v22
    v_cvt_pk_bf16_f32 v9, v26, v30
    v_mfma_f32_16x16x32_bf16 v[176:179], v[60:63], v[204:207], v[176:179]
    v_cvt_pk_bf16_f32 v10, v19, v23
    v_cvt_pk_bf16_f32 v11, v27, v31
    ds_read_b128 v[200:203], v241 offset:2592
    s_waitcnt lgkmcnt(3)
    v_mfma_f32_16x16x32_bf16 v[176:179], v[64:67], v[188:191], v[176:179]
    v_mfma_f32_16x16x32_bf16 v[180:183], v[96:99], v[188:191], v[180:183]
    ds_read_b128 v[204:207], v241 offset:3552
    s_waitcnt lgkmcnt(3)
    v_mfma_f32_16x16x32_bf16 v[180:183], v[100:103], v[192:195], v[180:183]
    v_mfma_f32_16x16x32_bf16 v[176:179], v[68:71], v[192:195], v[176:179]
    ds_read_b128 v[188:191], v241 offset:3488
    s_waitcnt lgkmcnt(3)
    v_mfma_f32_16x16x32_bf16 v[176:179], v[72:75], v[196:199], v[176:179]
    v_mfma_f32_16x16x32_bf16 v[180:183], v[104:107], v[196:199], v[180:183]
    s_add_u32 m0, s55, 9216
    s_nop 0
    buffer_load_dwordx4 v236, s[28:31], s45 offen lds
    ds_read_b128 v[192:195], v241 offset:3424
    s_waitcnt lgkmcnt(3)
    v_mfma_f32_16x16x32_bf16 v[180:183], v[108:111], v[200:203], v[180:183]
    v_mfma_f32_16x16x32_bf16 v[176:179], v[76:79], v[200:203], v[176:179]
    v_mfma_f32_16x16x32_bf16 v[184:187], v[4:7], v[116:119], v[184:187]
    v_mfma_f32_16x16x32_bf16 v[184:187], v[8:11], v[120:123], v[184:187]
    s_setprio 0
    ds_read_b128 v[196:199], v241 offset:3360
    s_waitcnt lgkmcnt(3)
    s_nop 0
    v_mfma_f32_16x16x32_bf16 v[180:183], v[48:51], v[204:207], v[180:183]
    v_cvt_pk_bf16_f32 v40, v172, v173
    v_cvt_pk_bf16_f32 v41, v174, v175
    v_mfma_f32_16x16x32_bf16 v[184:187], v[80:83], v[204:207], v[184:187]
    v_cvt_pk_bf16_f32 v42, v176, v177
    v_cvt_pk_bf16_f32 v43, v178, v179
    ds_read_b128 v[200:203], v241 offset:3296
    s_waitcnt lgkmcnt(3)
    v_mfma_f32_16x16x32_bf16 v[184:187], v[84:87], v[188:191], v[184:187]
    v_permlane16_swap_b32 v40, v42
    v_permlane16_swap_b32 v41, v43
    v_mfma_f32_16x16x32_bf16 v[180:183], v[52:55], v[188:191], v[180:183]
    global_store_dwordx4 v242, v[40:43], s[20:21] sc1
    v_add_u32 v242, 656384, v242
    ds_read_b128 v[204:207], v241 offset:3232
    s_waitcnt lgkmcnt(3)
    v_mfma_f32_16x16x32_bf16 v[180:183], v[56:59], v[192:195], v[180:183]
    v_mfma_f32_16x16x32_bf16 v[184:187], v[88:91], v[192:195], v[184:187]
    s_add_u32 m0, s55, 10240
    s_add_u32 s45, s45, 40960
    buffer_load_dwordx4 v232, s[28:31], s45 offen lds
    ds_read_b128 v[188:191], v241 offset:3168
    s_waitcnt lgkmcnt(3)
    v_mfma_f32_16x16x32_bf16 v[184:187], v[92:95], v[196:199], v[184:187]
    v_mfma_f32_16x16x32_bf16 v[180:183], v[60:63], v[196:199], v[180:183]
    ds_read_b128 v[192:195], v241 offset:3104
    s_waitcnt lgkmcnt(3)
    v_mfma_f32_16x16x32_bf16 v[180:183], v[64:67], v[200:203], v[180:183]
    v_mfma_f32_16x16x32_bf16 v[184:187], v[96:99], v[200:203], v[184:187]
    ds_read_b128 v[196:199], v241 offset:4064
    s_waitcnt lgkmcnt(3)
    v_mfma_f32_16x16x32_bf16 v[184:187], v[100:103], v[204:207], v[184:187]
    v_mfma_f32_16x16x32_bf16 v[180:183], v[68:71], v[204:207], v[180:183]
    ds_read_b128 v[200:203], v241 offset:4000
    s_waitcnt lgkmcnt(3)
    v_mfma_f32_16x16x32_bf16 v[180:183], v[72:75], v[188:191], v[180:183]
    v_mfma_f32_16x16x32_bf16 v[184:187], v[104:107], v[188:191], v[184:187]
    s_add_u32 m0, s55, 11264
    s_nop 0
    buffer_load_dwordx4 v233, s[28:31], s45 offen lds
    ds_read_b128 v[204:207], v241 offset:3936
    s_waitcnt lgkmcnt(3)
    v_mfma_f32_16x16x32_bf16 v[184:187], v[108:111], v[192:195], v[184:187]
    v_mfma_f32_16x16x32_bf16 v[180:183], v[76:79], v[192:195], v[180:183]
    ds_read_b128 v[188:191], v241 offset:3872
    s_waitcnt lgkmcnt(3)
    v_mfma_f32_16x16x32_bf16 v[184:187], v[48:51], v[196:199], v[184:187]
    ds_read_b128 v[192:195], v241 offset:3808
    s_waitcnt lgkmcnt(3)
    v_mfma_f32_16x16x32_bf16 v[184:187], v[52:55], v[200:203], v[184:187]
    ds_read_b128 v[196:199], v241 offset:3744
    s_waitcnt lgkmcnt(3)
    v_mfma_f32_16x16x32_bf16 v[184:187], v[56:59], v[204:207], v[184:187]
    s_add_u32 m0, s55, 12288
    s_mov_b32 exec_hi, 0
    buffer_load_dwordx4 v234, s[28:31], s45 offen lds
    s_mov_b32 exec_hi, -1
    ds_read_b128 v[200:203], v241 offset:3680
    s_waitcnt lgkmcnt(3)
    v_mfma_f32_16x16x32_bf16 v[184:187], v[60:63], v[188:191], v[184:187]
    ds_read_b128 v[204:207], v241 offset:3616
    s_waitcnt lgkmcnt(3)
    v_mfma_f32_16x16x32_bf16 v[184:187], v[64:67], v[192:195], v[184:187]
    s_waitcnt lgkmcnt(2)
    v_mfma_f32_16x16x32_bf16 v[184:187], v[68:71], v[196:199], v[184:187]
    s_waitcnt lgkmcnt(1)
    v_mfma_f32_16x16x32_bf16 v[184:187], v[72:75], v[200:203], v[184:187]
    s_waitcnt lgkmcnt(0)
    v_mfma_f32_16x16x32_bf16 v[184:187], v[76:79], v[204:207], v[184:187]
    v_cvt_pk_bf16_f32 v44, v180, v181
    v_cvt_pk_bf16_f32 v45, v182, v183
    s_nop 5
    v_cvt_pk_bf16_f32 v46, v184, v185
    v_cvt_pk_bf16_f32 v47, v186, v187
    s_nop 0
    v_permlane16_swap_b32 v44, v46
    v_permlane16_swap_b32 v45, v47
    global_store_dwordx4 v242, v[44:47], s[20:21] sc1
    v_lshlrev_b32 v4, 2, v1
    s_mov_b32 s27, 0
L_poll_74:
    global_load_dword v6, v4, s[66:67] sc1
    s_waitcnt vmcnt(0)
    v_and_b32 v7, 0x80808080, v6
    v_cmp_ne_u32 vcc, 0x80808080, v7
    s_nop 0
    s_cbranch_vccz L_polled_75
    s_add_u32 s27, s27, 1
    s_cmp_lt_u32 s27, 262144
    s_cbranch_scc1 L_poll_74
L_polled_75:
L_ann_73:
    v_cmp_eq_u32 vcc, s72, v6
    s_lshl_b32 s40, s22, 3
    s_lshr_b64 s[40:41], vcc, s40
    s_and_b32 s40, s40, 0xff
    s_cmp_eq_u32 s40, 0xff
    s_cselect_b32 s68, 1, 0
    s_barrier
    s_cmp_lt_u32 s24, 4
    s_cbranch_scc1 L_fcompute
    s_cmp_lg_u32 s24, 7
    s_cbranch_scc1 L_cdone
    v_mov_b32_e64 v251, 1
    s_mov_b64 exec, 0xff
    global_atomic_add v250, v251, s[20:21] sc1
    s_mov_b64 exec, -1
L_cdone:
    s_mov_b32 s32, s20
    s_and_b32 s33, s21, 0xffff
    s_mov_b32 s34, 2625536
    s_mov_b32 s35, 0x20000
    v_and_b32_e64 v2, 15, v0
    v_bfe_u32 v3, v0, 4, 2
    s_lshl_b32 s45, s70, 3
    s_add_u32 s45, s45, s22
    s_lshl_b32 s45, s45, 7
    s_add_u32 s45, s45, 16384000
    v_mov_b32 v232, s45
    v_mov_b32 v239, 0
    s_lshl_b32 s45, s69, 8
    s_add_u32 s45, s45, 16252928
    v_lshl_add_u32 v238, v1, 2, s45
    v_lshlrev_b32_e64 v234, 4, v1
    s_mul_i32 s37, s26, 2560
    s_mul_i32 s36, s70, 10240
    s_mul_i32 s44, s69, 82048
    s_add_u32 s36, s36, s44
    s_add_u32 s36, s36, s37
    s_add_u32 s37, s37, s71
    v_lshrrev_b32 v235, 1, v2
    v_lshlrev_b32 v235, 6, v235
    v_and_b32 v236, 1, v1
    v_lshl_add_u32 v235, v236, 3, v235
    v_lshl_add_u32 v235, v3, 4, v235
    v_add_u32 v235, s37, v235
    s_add_u32 s45, s23, 2
    v_and_b32 v236, 1, v3
    v_add_u32 v236, s45, v236
    v_and_b32 v236, 3, v236
    v_lshrrev_b32 v237, 1, v3
    v_lshl_add_u32 v236, v236, 1, v237
    v_mul_u32_u24 v236, 5120, v236
    s_lshl_b32 s45, s26, 8
    s_add_u32 s45, s45, 102400
    v_lshl_add_u32 v237, v2, 4, s45
    v_add_u32 v236, v236, v237
    v_lshl_add_u32 v237, v1, 2, s37
    s_barrier
    s_branch L_floader
L_codeend:
L_qglob_12:
    s_waitcnt lgkmcnt(9)
    v_mfma_f32_16x16x32_bf16 v[32:35], v[168:171], v[152:155], v[32:35]
    ds_read_b128 v[160:163], v5 offset:0
    ds_read_b64_tr_b16 v[188:189], v10 offset:15360
    s_waitcnt lgkmcnt(9)
    v_mfma_f32_16x16x32_bf16 v[36:39], v[172:175], v[152:155], v[36:39]
    ds_read_b64_tr_b16 v[190:191], v11 offset:15360
    ds_read_b128 v[164:167], v5 offset:2048
    s_waitcnt lgkmcnt(9)
    v_mfma_f32_16x16x32_bf16 v[40:43], v[176:179], v[152:155], v[40:43]
    ds_read_b64_tr_b16 v[192:193], v10 offset:15400
    s_waitcnt lgkmcnt(8)
    v_mfma_f32_16x16x32_bf16 v[44:47], v[180:183], v[152:155], v[44:47]
    ds_read_b64_tr_b16 v[194:195], v11 offset:15400
    s_waitcnt lgkmcnt(7)
    v_mfma_f32_16x16x32_bf16 v[48:51], v[184:187], v[152:155], v[48:51]
    ds_read_b64_tr_b16 v[196:197], v10 offset:15440
    s_waitcnt lgkmcnt(7)
    v_mfma_f32_16x16x32_bf16 v[52:55], v[168:171], v[156:159], v[52:55]
    ds_read_b64_tr_b16 v[198:199], v11 offset:15440
    v_mfma_f32_16x16x32_bf16 v[56:59], v[172:175], v[156:159], v[56:59]
    ds_read_b64_tr_b16 v[200:201], v10 offset:15480
    v_mfma_f32_16x16x32_bf16 v[60:63], v[176:179], v[156:159], v[60:63]
    ds_read_b64_tr_b16 v[202:203], v11 offset:15480
    v_mfma_f32_16x16x32_bf16 v[64:67], v[180:183], v[156:159], v[64:67]
    ds_read_b64_tr_b16 v[204:205], v12 offset:15360
    v_mfma_f32_16x16x32_bf16 v[68:71], v[184:187], v[156:159], v[68:71]
    ds_read_b64_tr_b16 v[206:207], v13 offset:15360
    s_waitcnt lgkmcnt(9)
    v_mfma_f32_16x16x32_bf16 v[32:35], v[188:191], v[160:163], v[32:35]
    ds_read_b128 v[224:227], v4 offset:4096
    s_waitcnt lgkmcnt(9)
    v_mfma_f32_16x16x32_bf16 v[52:55], v[188:191], v[164:167], v[52:55]
    ds_read_b128 v[232:235], v5 offset:4096
    s_waitcnt lgkmcnt(8)
    v_mfma_f32_16x16x32_bf16 v[36:39], v[192:195], v[160:163], v[36:39]
    ds_read_b128 v[236:239], v5 offset:6144
    v_mfma_f32_16x16x32_bf16 v[56:59], v[192:195], v[164:167], v[56:59]
    ds_read_b128 v[228:231], v4 offset:6144
    s_waitcnt lgkmcnt(8)
    v_mfma_f32_16x16x32_bf16 v[40:43], v[196:199], v[160:163], v[40:43]
    v_mfma_f32_16x16x32_bf16 v[60:63], v[196:199], v[164:167], v[60:63]
    v_cvt_pk_bf16_f32 v208, v32, v33
    v_cvt_pk_bf16_f32 v209, v34, v35
    s_waitcnt lgkmcnt(6)
    v_mfma_f32_16x16x32_bf16 v[44:47], v[200:203], v[160:163], v[44:47]
    v_cvt_pk_bf16_f32 v210, v52, v53
    v_cvt_pk_bf16_f32 v211, v54, v55
    v_mfma_f32_16x16x32_bf16 v[64:67], v[200:203], v[164:167], v[64:67]
    global_store_dwordx4 v18, v[208:211], s[20:21] offset:-2048 sc1
    s_waitcnt lgkmcnt(4)
    v_mfma_f32_16x16x32_bf16 v[48:51], v[204:207], v[160:163], v[48:51]
    v_cvt_pk_bf16_f32 v212, v36, v37
    v_cvt_pk_bf16_f32 v213, v38, v39
    v_mfma_f32_16x16x32_bf16 v[68:71], v[204:207], v[164:167], v[68:71]
    v_cvt_pk_bf16_f32 v214, v56, v57
    v_cvt_pk_bf16_f32 v215, v58, v59
    s_waitcnt lgkmcnt(3)
    v_mfma_f32_16x16x32_bf16 v[72:75], v[168:171], v[224:227], v[72:75]
    global_store_dwordx4 v18, v[212:215], s[20:21] offset:-1024 sc1
    s_waitcnt lgkmcnt(2)
    v_mfma_f32_16x16x32_bf16 v[72:75], v[188:191], v[232:235], v[72:75]
    v_cvt_pk_bf16_f32 v216, v40, v41
    v_cvt_pk_bf16_f32 v217, v42, v43
    s_waitcnt lgkmcnt(1)
    v_mfma_f32_16x16x32_bf16 v[92:95], v[188:191], v[236:239], v[92:95]
    v_cvt_pk_bf16_f32 v218, v60, v61
    v_cvt_pk_bf16_f32 v219, v62, v63
    s_waitcnt lgkmcnt(0)
    v_mfma_f32_16x16x32_bf16 v[92:95], v[168:171], v[228:231], v[92:95]
    global_store_dwordx4 v18, v[216:219], s[20:21] offset:0 sc1
    v_mfma_f32_16x16x32_bf16 v[76:79], v[172:175], v[224:227], v[76:79]
    v_cvt_pk_bf16_f32 v220, v44, v45
    v_cvt_pk_bf16_f32 v221, v46, v47
    v_mfma_f32_16x16x32_bf16 v[76:79], v[192:195], v[232:235], v[76:79]
    v_cvt_pk_bf16_f32 v222, v64, v65
    v_cvt_pk_bf16_f32 v223, v66, v67
    v_mfma_f32_16x16x32_bf16 v[96:99], v[192:195], v[236:239], v[96:99]
    global_store_dwordx4 v18, v[220:223], s[20:21] offset:1024 sc1
    v_mfma_f32_16x16x32_bf16 v[96:99], v[172:175], v[228:231], v[96:99]
    v_cvt_pk_bf16_f32 v208, v48, v49
    v_cvt_pk_bf16_f32 v209, v50, v51
    v_mfma_f32_16x16x32_bf16 v[80:83], v[176:179], v[224:227], v[80:83]
    v_cvt_pk_bf16_f32 v210, v68, v69
    v_cvt_pk_bf16_f32 v211, v70, v71
    v_mfma_f32_16x16x32_bf16 v[80:83], v[196:199], v[232:235], v[80:83]
    global_store_dwordx4 v18, v[208:211], s[20:21] offset:2048 sc1
    v_mfma_f32_16x16x32_bf16 v[100:103], v[196:199], v[236:239], v[100:103]
    ds_read_b128 v[152:155], v4 offset:8192
    v_add_u32 v18, 5120, v18
    v_cvt_pk_bf16_f32 v212, v72, v73
    v_mfma_f32_16x16x32_bf16 v[100:103], v[176:179], v[228:231], v[100:103]
    ds_read_b128 v[160:163], v5 offset:8192
    v_cvt_pk_bf16_f32 v213, v74, v75
    v_cvt_pk_bf16_f32 v214, v92, v93
    v_mfma_f32_16x16x32_bf16 v[84:87], v[180:183], v[224:227], v[84:87]
    ds_read_b128 v[164:167], v5 offset:10240
    v_cvt_pk_bf16_f32 v215, v94, v95
    global_store_dwordx4 v18, v[212:215], s[20:21] offset:-2048 sc1
    v_mfma_f32_16x16x32_bf16 v[84:87], v[200:203], v[232:235], v[84:87]
    ds_read_b128 v[156:159], v4 offset:10240
    v_cvt_pk_bf16_f32 v216, v76, v77
    v_cvt_pk_bf16_f32 v217, v78, v79
    v_mfma_f32_16x16x32_bf16 v[104:107], v[200:203], v[236:239], v[104:107]
    v_cvt_pk_bf16_f32 v218, v96, v97
    v_cvt_pk_bf16_f32 v219, v98, v99
    v_mfma_f32_16x16x32_bf16 v[104:107], v[180:183], v[228:231], v[104:107]
    global_store_dwordx4 v18, v[216:219], s[20:21] offset:-1024 sc1
    v_mfma_f32_16x16x32_bf16 v[88:91], v[184:187], v[224:227], v[88:91]
    v_cvt_pk_bf16_f32 v220, v80, v81
    v_cvt_pk_bf16_f32 v221, v82, v83
    v_mfma_f32_16x16x32_bf16 v[88:91], v[204:207], v[232:235], v[88:91]
    v_cvt_pk_bf16_f32 v222, v100, v101
    v_cvt_pk_bf16_f32 v223, v102, v103
    v_mfma_f32_16x16x32_bf16 v[108:111], v[204:207], v[236:239], v[108:111]
    global_store_dwordx4 v18, v[220:223], s[20:21] offset:0 sc1
    v_mfma_f32_16x16x32_bf16 v[108:111], v[184:187], v[228:231], v[108:111]
    v_cvt_pk_bf16_f32 v208, v84, v85
    v_cvt_pk_bf16_f32 v209, v86, v87
    s_waitcnt lgkmcnt(3)
    v_mfma_f32_16x16x32_bf16 v[112:115], v[168:171], v[152:155], v[112:115]
    v_cvt_pk_bf16_f32 v210, v104, v105
    v_cvt_pk_bf16_f32 v211, v106, v107
    s_waitcnt lgkmcnt(2)
    v_mfma_f32_16x16x32_bf16 v[112:115], v[188:191], v[160:163], v[112:115]
    global_store_dwordx4 v18, v[208:211], s[20:21] offset:1024 sc1
    s_waitcnt lgkmcnt(1)
    v_mfma_f32_16x16x32_bf16 v[132:135], v[188:191], v[164:167], v[132:135]
    s_waitcnt lgkmcnt(0)
    v_mfma_f32_16x16x32_bf16 v[132:135], v[168:171], v[156:159], v[132:135]
    v_cvt_pk_bf16_f32 v212, v88, v89
    v_cvt_pk_bf16_f32 v213, v90, v91
    v_mfma_f32_16x16x32_bf16 v[116:119], v[172:175], v[152:155], v[116:119]
    v_cvt_pk_bf16_f32 v214, v108, v109
    v_cvt_pk_bf16_f32 v215, v110, v111
    v_mfma_f32_16x16x32_bf16 v[116:119], v[192:195], v[160:163], v[116:119]
    global_store_dwordx4 v18, v[212:215], s[20:21] offset:2048 sc1
    v_mfma_f32_16x16x32_bf16 v[136:139], v[192:195], v[164:167], v[136:139]
    v_mfma_f32_16x16x32_bf16 v[136:139], v[172:175], v[156:159], v[136:139]
    v_add_u32 v18, 5120, v18
    v_cvt_pk_bf16_f32 v216, v112, v113
    v_mfma_f32_16x16x32_bf16 v[120:123], v[176:179], v[152:155], v[120:123]
    v_cvt_pk_bf16_f32 v217, v114, v115
    v_cvt_pk_bf16_f32 v218, v132, v133
    v_mfma_f32_16x16x32_bf16 v[120:123], v[196:199], v[160:163], v[120:123]
    v_cvt_pk_bf16_f32 v219, v134, v135
    global_store_dwordx4 v18, v[216:219], s[20:21] offset:-2048 sc1
    v_mfma_f32_16x16x32_bf16 v[140:143], v[196:199], v[164:167], v[140:143]
    v_mfma_f32_16x16x32_bf16 v[140:143], v[176:179], v[156:159], v[140:143]
    v_cvt_pk_bf16_f32 v220, v116, v117
    v_cvt_pk_bf16_f32 v221, v118, v119
    v_mfma_f32_16x16x32_bf16 v[124:127], v[180:183], v[152:155], v[124:127]
    v_cvt_pk_bf16_f32 v222, v136, v137
    v_cvt_pk_bf16_f32 v223, v138, v139
    v_mfma_f32_16x16x32_bf16 v[124:127], v[200:203], v[160:163], v[124:127]
    global_store_dwordx4 v18, v[220:223], s[20:21] offset:-1024 sc1
    v_mfma_f32_16x16x32_bf16 v[144:147], v[200:203], v[164:167], v[144:147]
    v_mfma_f32_16x16x32_bf16 v[144:147], v[180:183], v[156:159], v[144:147]
    v_cvt_pk_bf16_f32 v208, v120, v121
    v_cvt_pk_bf16_f32 v209, v122, v123
    v_mfma_f32_16x16x32_bf16 v[128:131], v[184:187], v[152:155], v[128:131]
    v_cvt_pk_bf16_f32 v210, v140, v141
    v_cvt_pk_bf16_f32 v211, v142, v143
    v_mfma_f32_16x16x32_bf16 v[128:131], v[204:207], v[160:163], v[128:131]
    global_store_dwordx4 v18, v[208:211], s[20:21] offset:0 sc1
    v_mfma_f32_16x16x32_bf16 v[148:151], v[204:207], v[164:167], v[148:151]
    v_mfma_f32_16x16x32_bf16 v[148:151], v[184:187], v[156:159], v[148:151]
    v_cvt_pk_bf16_f32 v212, v124, v125
    v_cvt_pk_bf16_f32 v213, v126, v127
    v_cvt_pk_bf16_f32 v214, v144, v145
    v_cvt_pk_bf16_f32 v215, v146, v147
    global_store_dwordx4 v18, v[212:215], s[20:21] offset:1024 sc1
    v_cvt_pk_bf16_f32 v216, v128, v129
    v_cvt_pk_bf16_f32 v217, v130, v131
    s_nop 0
    v_cvt_pk_bf16_f32 v218, v148, v149
    v_cvt_pk_bf16_f32 v219, v150, v151
    global_store_dwordx4 v18, v[216:219], s[20:21] offset:2048 sc1
    s_mov_b64 exec, 1
    s_waitcnt vmcnt(0)
    global_store_dword v15, v19, s[20:21] sc1
    s_mov_b64 exec, -1
    s_branch L_qjoin_13
L_qglob_14:
    s_lshl_b32 s45, s44, 7
    v_add_u32 v26, s45, v23
    s_waitcnt lgkmcnt(9)
    v_mfma_f32_16x16x32_bf16 v[32:35], v[168:171], v[152:155], v[32:35]
    ds_read_b128 v[160:163], v5 offset:0
    ds_read_b64_tr_b16 v[188:189], v10 offset:15360
    s_waitcnt lgkmcnt(9)
    v_mfma_f32_16x16x32_bf16 v[36:39], v[172:175], v[152:155], v[36:39]
    ds_read_b64_tr_b16 v[190:191], v11 offset:15360
    ds_read_b128 v[164:167], v5 offset:2048
    s_waitcnt lgkmcnt(9)
    v_mfma_f32_16x16x32_bf16 v[40:43], v[176:179], v[152:155], v[40:43]
    ds_read_b64_tr_b16 v[192:193], v10 offset:15400
    s_waitcnt lgkmcnt(8)
    v_mfma_f32_16x16x32_bf16 v[44:47], v[180:183], v[152:155], v[44:47]
    ds_read_b64_tr_b16 v[194:195], v11 offset:15400
    s_waitcnt lgkmcnt(7)
    v_mfma_f32_16x16x32_bf16 v[48:51], v[184:187], v[152:155], v[48:51]
    ds_read_b64_tr_b16 v[196:197], v10 offset:15440
    s_waitcnt lgkmcnt(7)
    v_mfma_f32_16x16x32_bf16 v[52:55], v[168:171], v[156:159], v[52:55]
    ds_read_b64_tr_b16 v[198:199], v11 offset:15440
    v_mfma_f32_16x16x32_bf16 v[56:59], v[172:175], v[156:159], v[56:59]
    ds_read_b64_tr_b16 v[200:201], v10 offset:15480
    v_mfma_f32_16x16x32_bf16 v[60:63], v[176:179], v[156:159], v[60:63]
    ds_read_b64_tr_b16 v[202:203], v11 offset:15480
    v_mfma_f32_16x16x32_bf16 v[64:67], v[180:183], v[156:159], v[64:67]
    ds_read_b64_tr_b16 v[204:205], v12 offset:15360
    v_mfma_f32_16x16x32_bf16 v[68:71], v[184:187], v[156:159], v[68:71]
    ds_read_b64_tr_b16 v[206:207], v13 offset:15360
    s_waitcnt lgkmcnt(9)
    v_mfma_f32_16x16x32_bf16 v[32:35], v[188:191], v[160:163], v[32:35]
    ds_read_b128 v[224:227], v4 offset:4096
    s_waitcnt lgkmcnt(9)
    v_mfma_f32_16x16x32_bf16 v[52:55], v[188:191], v[164:167], v[52:55]
    ds_read_b128 v[232:235], v5 offset:4096
    s_waitcnt lgkmcnt(8)
    v_mfma_f32_16x16x32_bf16 v[36:39], v[192:195], v[160:163], v[36:39]
    ds_read_b128 v[236:239], v5 offset:6144
    v_mfma_f32_16x16x32_bf16 v[56:59], v[192:195], v[164:167], v[56:59]
    ds_read_b128 v[228:231], v4 offset:6144
    s_waitcnt lgkmcnt(8)
    v_mfma_f32_16x16x32_bf16 v[40:43], v[196:199], v[160:163], v[40:43]
    s_nop 0
    ds_read_b128 v[136:139], v26 offset:0
    v_mfma_f32_16x16x32_bf16 v[60:63], v[196:199], v[164:167], v[60:63]
    ds_read_b128 v[124:127], v20
    v_cvt_pk_bf16_f32 v208, v32, v33
    v_cvt_pk_bf16_f32 v209, v34, v35
    s_waitcnt lgkmcnt(8)
    v_mfma_f32_16x16x32_bf16 v[44:47], v[200:203], v[160:163], v[44:47]
    v_xor_b32 v20, 64, v20
    v_cvt_pk_bf16_f32 v210, v52, v53
    v_cvt_pk_bf16_f32 v211, v54, v55
    v_mfma_f32_16x16x32_bf16 v[64:67], v[200:203], v[164:167], v[64:67]
    ds_read_b128 v[128:131], v21
    global_store_dwordx4 v18, v[208:211], s[20:21] offset:-2048 sc1
    s_waitcnt lgkmcnt(7)
    v_mfma_f32_16x16x32_bf16 v[48:51], v[204:207], v[160:163], v[48:51]
    v_xor_b32 v21, 64, v21
    v_cvt_pk_bf16_f32 v212, v36, v37
    v_cvt_pk_bf16_f32 v213, v38, v39
    v_mfma_f32_16x16x32_bf16 v[68:71], v[204:207], v[164:167], v[68:71]
    ds_read_b128 v[132:135], v22
    v_cvt_pk_bf16_f32 v214, v56, v57
    v_cvt_pk_bf16_f32 v215, v58, v59
    s_waitcnt lgkmcnt(7)
    v_mfma_f32_16x16x32_bf16 v[72:75], v[168:171], v[224:227], v[72:75]
    v_xor_b32 v22, 64, v22
    global_store_dwordx4 v18, v[212:215], s[20:21] offset:-1024 sc1
    s_waitcnt lgkmcnt(6)
    v_mfma_f32_16x16x32_bf16 v[72:75], v[188:191], v[232:235], v[72:75]
    v_cvt_pk_bf16_f32 v216, v40, v41
    v_cvt_pk_bf16_f32 v217, v42, v43
    s_waitcnt lgkmcnt(5)
    v_mfma_f32_16x16x32_bf16 v[92:95], v[188:191], v[236:239], v[92:95]
    v_cvt_pk_bf16_f32 v218, v60, v61
    v_cvt_pk_bf16_f32 v219, v62, v63
    s_waitcnt lgkmcnt(4)
    v_mfma_f32_16x16x32_bf16 v[92:95], v[168:171], v[228:231], v[92:95]
    s_waitcnt lgkmcnt(2)
    v_mfma_f32_16x16x32_bf16 v[112:115], v[136:139], v[124:127], v[112:115]
    s_waitcnt lgkmcnt(1)
    v_mfma_f32_16x16x32_bf16 v[116:119], v[136:139], v[128:131], v[116:119]
    s_waitcnt lgkmcnt(0)
    v_mfma_f32_16x16x32_bf16 v[120:123], v[136:139], v[132:135], v[120:123]
    global_store_dwordx4 v18, v[216:219], s[20:21] offset:0 sc1
    v_mfma_f32_16x16x32_bf16 v[76:79], v[172:175], v[224:227], v[76:79]
    ds_read_b128 v[136:139], v26 offset:64
    v_cvt_pk_bf16_f32 v220, v44, v45
    v_cvt_pk_bf16_f32 v221, v46, v47
    v_mfma_f32_16x16x32_bf16 v[76:79], v[192:195], v[232:235], v[76:79]
    ds_read_b128 v[124:127], v20
    v_cvt_pk_bf16_f32 v222, v64, v65
    v_cvt_pk_bf16_f32 v223, v66, v67
    v_mfma_f32_16x16x32_bf16 v[96:99], v[192:195], v[236:239], v[96:99]
    v_xor_b32_e64 v20, 64, v20
    global_store_dwordx4 v18, v[220:223], s[20:21] offset:1024 sc1
    v_mfma_f32_16x16x32_bf16 v[96:99], v[172:175], v[228:231], v[96:99]
    ds_read_b128 v[128:131], v21
    v_cvt_pk_bf16_f32 v208, v48, v49
    v_cvt_pk_bf16_f32 v209, v50, v51
    v_mfma_f32_16x16x32_bf16 v[80:83], v[176:179], v[224:227], v[80:83]
    v_xor_b32_e64 v21, 64, v21
    v_cvt_pk_bf16_f32 v210, v68, v69
    v_cvt_pk_bf16_f32 v211, v70, v71
    v_mfma_f32_16x16x32_bf16 v[80:83], v[196:199], v[232:235], v[80:83]
    ds_read_b128 v[132:135], v22
    global_store_dwordx4 v18, v[208:211], s[20:21] offset:2048 sc1
    v_mfma_f32_16x16x32_bf16 v[100:103], v[196:199], v[236:239], v[100:103]
    v_xor_b32_e64 v22, 64, v22
    v_add_u32 v18, 5120, v18
    v_cvt_pk_bf16_f32 v212, v72, v73
    v_mfma_f32_16x16x32_bf16 v[100:103], v[176:179], v[228:231], v[100:103]
    v_cvt_pk_bf16_f32 v213, v74, v75
    v_cvt_pk_bf16_f32 v214, v92, v93
    v_mfma_f32_16x16x32_bf16 v[84:87], v[180:183], v[224:227], v[84:87]
    v_cvt_pk_bf16_f32 v215, v94, v95
    global_store_dwordx4 v18, v[212:215], s[20:21] offset:-2048 sc1
    v_mfma_f32_16x16x32_bf16 v[84:87], v[200:203], v[232:235], v[84:87]
    s_waitcnt lgkmcnt(2)
    v_mfma_f32_16x16x32_bf16 v[112:115], v[136:139], v[124:127], v[112:115]
    s_waitcnt lgkmcnt(1)
    v_mfma_f32_16x16x32_bf16 v[116:119], v[136:139], v[128:131], v[116:119]
    s_waitcnt lgkmcnt(0)
    s_nop 0
    v_mfma_f32_16x16x32_bf16 v[120:123], v[136:139], v[132:135], v[120:123]
    v_cvt_pk_bf16_f32 v216, v76, v77
    v_cvt_pk_bf16_f32 v217, v78, v79
    v_mfma_f32_16x16x32_bf16 v[104:107], v[200:203], v[236:239], v[104:107]
    v_cvt_pk_bf16_f32 v218, v96, v97
    v_cvt_pk_bf16_f32 v219, v98, v99
    v_mfma_f32_16x16x32_bf16 v[104:107], v[180:183], v[228:231], v[104:107]
    global_store_dwordx4 v18, v[216:219], s[20:21] offset:-1024 sc1
    v_mfma_f32_16x16x32_bf16 v[88:91], v[184:187], v[224:227], v[88:91]
    v_cvt_pk_bf16_f32 v220, v80, v81
    v_cvt_pk_bf16_f32 v221, v82, v83
    v_mfma_f32_16x16x32_bf16 v[88:91], v[204:207], v[232:235], v[88:91]
    v_cvt_pk_bf16_f32 v222, v100, v101
    v_cvt_pk_bf16_f32 v223, v102, v103
    v_mfma_f32_16x16x32_bf16 v[108:111], v[204:207], v[236:239], v[108:111]
    global_store_dwordx4 v18, v[220:223], s[20:21] offset:0 sc1
    v_mfma_f32_16x16x32_bf16 v[108:111], v[184:187], v[228:231], v[108:111]
    v_cvt_pk_bf16_f32 v208, v84, v85
    v_cvt_pk_bf16_f32 v209, v86, v87
    v_cvt_pk_bf16_f32 v210, v104, v105
    v_cvt_pk_bf16_f32 v211, v106, v107
    global_store_dwordx4 v18, v[208:211], s[20:21] offset:1024 sc1
    v_cvt_pk_bf16_f32 v212, v88, v89
    v_cvt_pk_bf16_f32 v213, v90, v91
    s_nop 0
    v_cvt_pk_bf16_f32 v214, v108, v109
    v_cvt_pk_bf16_f32 v215, v110, v111
    global_store_dwordx4 v18, v[212:215], s[20:21] offset:2048 sc1
    s_mov_b64 exec, 1
    s_waitcnt vmcnt(0)
    global_store_dword v15, v19, s[20:21] sc1
    s_mov_b64 exec, -1
    s_branch L_qjoin_15
L_qslow_33:
    v_max3_f32 v176, v144, v145, v146
    v_max3_f32 v220, v188, v189, v190
    v_max_f32 v176, v147, v176
    v_max_f32_e64 v220, v191, v220
    v_max3_f32 v178, -v144, -v145, -v146
    v_max3_f32 v222, -v188, -v189, -v190
    v_max_f32 v178, -v147, v178
    v_max_f32 v222, -v191, v222
    v_max3_f32 v180, v148, v149, v150
    v_max3_f32 v224, v192, v193, v194
    v_max_f32 v180, v151, v180
    v_max_f32 v224, v195, v224
    v_max3_f32 v182, -v148, -v149, -v150
    v_max3_f32 v226, -v192, -v193, -v194
    v_max_f32 v182, -v151, v182
    v_max_f32 v226, -v195, v226
    v_max3_f32 v184, v152, v153, v154
    v_max3_f32 v228, v196, v197, v198
    v_max_f32 v184, v155, v184
    v_max_f32 v228, v199, v228
    v_permlane32_swap_b32 v176, v180
    v_permlane32_swap_b32 v220, v224
    v_permlane32_swap_b32 v178, v182
    v_permlane32_swap_b32 v222, v226
    v_max_f32 v176, v176, v180
    v_max_f32 v220, v220, v224
    v_max_f32 v178, v178, v182
    v_max_f32 v222, v222, v226
    s_nop 0
    v_permlane16_swap_b32 v176, v178
    v_permlane16_swap_b32 v220, v222
    v_max_f32 v184, v184, v176
    v_max_f32 v228, v228, v220
    v_max_f32 v184, v184, v178
    v_max_f32 v228, v228, v222
    v_mov_b32 v176, v184
    v_mov_b32 v220, v228
    v_mov_b32 v178, v184
    v_mov_b32 v222, v228
    s_nop 0
    v_permlane16_swap_b32 v176, v178
    v_permlane16_swap_b32 v220, v222
    v_mov_b32 v180, v176
    v_mov_b32 v224, v220
    v_mov_b32 v182, v178
    v_mov_b32 v226, v222
    v_permlane32_swap_b32 v176, v180
    v_permlane32_swap_b32 v220, v224
    v_permlane32_swap_b32 v178, v182
    v_permlane32_swap_b32 v222, v226
    v_sub_f32 v156, v144, v176
    v_sub_f32 v200, v188, v220
    v_sub_f32 v157, v145, v176
    v_sub_f32 v201, v189, v220
    v_sub_f32 v158, v146, v176
    v_sub_f32 v202, v190, v220
    v_sub_f32 v159, v147, v176
    v_sub_f32 v203, v191, v220
    v_sub_f32 v160, -v144, v178
    v_sub_f32 v204, -v188, v222
    v_sub_f32 v161, -v145, v178
    v_sub_f32 v205, -v189, v222
    v_sub_f32 v162, -v146, v178
    v_sub_f32 v206, -v190, v222
    v_sub_f32 v163, -v147, v178
    v_sub_f32 v207, -v191, v222
    v_sub_f32 v164, v148, v180
    v_sub_f32 v208, v192, v224
    v_sub_f32 v165, v149, v180
    v_sub_f32 v209, v193, v224
    v_sub_f32 v166, v150, v180
    v_sub_f32 v210, v194, v224
    v_sub_f32 v167, v151, v180
    v_sub_f32 v211, v195, v224
    v_sub_f32 v168, -v148, v182
    v_sub_f32 v212, -v192, v226
    v_sub_f32 v169, -v149, v182
    v_sub_f32 v213, -v193, v226
    v_sub_f32 v170, -v150, v182
    v_sub_f32 v214, -v194, v226
    v_sub_f32 v171, -v151, v182
    v_sub_f32 v215, -v195, v226
    v_sub_f32 v172, v152, v184
    v_sub_f32 v216, v196, v228
    v_sub_f32 v173, v153, v184
    v_sub_f32 v217, v197, v228
    v_sub_f32 v174, v154, v184
    v_sub_f32 v218, v198, v228
    v_sub_f32 v175, v155, v184
    v_sub_f32 v219, v199, v228
    v_exp_f32 v156, v156
    v_exp_f32 v200, v200
    v_exp_f32 v157, v157
    v_exp_f32 v201, v201
    v_exp_f32 v158, v158
    v_exp_f32 v202, v202
    v_exp_f32 v159, v159
    v_exp_f32 v203, v203
    v_exp_f32 v160, v160
    v_exp_f32 v204, v204
    v_exp_f32 v161, v161
    v_exp_f32 v205, v205
    v_exp_f32 v162, v162
    v_exp_f32 v206, v206
    v_exp_f32 v163, v163
    v_exp_f32 v207, v207
    v_exp_f32 v164, v164
    v_exp_f32 v208, v208
    v_exp_f32 v165, v165
    v_exp_f32 v209, v209
    v_exp_f32 v166, v166
    v_exp_f32 v210, v210
    v_exp_f32 v167, v167
    v_exp_f32 v211, v211
    v_exp_f32 v168, v168
    v_exp_f32 v212, v212
    v_exp_f32 v169, v169
    v_exp_f32 v213, v213
    v_exp_f32 v170, v170
    v_exp_f32 v214, v214
    v_exp_f32 v171, v171
    v_exp_f32 v215, v215
    v_exp_f32 v172, v172
    v_exp_f32 v216, v216
    v_exp_f32 v173, v173
    v_exp_f32 v217, v217
    v_exp_f32 v174, v174
    v_exp_f32 v218, v218
    v_exp_f32 v175, v175
    v_exp_f32 v219, v219
    v_pk_add_f32 v[176:177], v[156:157], v[158:159]
    v_pk_add_f32 v[220:221], v[200:201], v[202:203]
    v_pk_add_f32 v[178:179], v[160:161], v[162:163]
    v_pk_add_f32 v[222:223], v[204:205], v[206:207]
    v_pk_add_f32 v[180:181], v[164:165], v[166:167]
    v_pk_add_f32 v[224:225], v[208:209], v[210:211]
    v_pk_add_f32 v[182:183], v[168:169], v[170:171]
    v_pk_add_f32 v[226:227], v[212:213], v[214:215]
    v_pk_add_f32 v[184:185], v[172:173], v[174:175]
    v_pk_add_f32 v[228:229], v[216:217], v[218:219]
    v_add_f32 v176, v176, v177
    v_add_f32 v220, v220, v221
    v_add_f32 v178, v178, v179
    v_add_f32 v222, v222, v223
    v_add_f32 v180, v180, v181
    v_add_f32 v224, v224, v225
    v_add_f32 v182, v182, v183
    v_add_f32 v226, v226, v227
    v_add_f32 v184, v184, v185
    v_add_f32 v228, v228, v229
    v_permlane32_swap_b32 v176, v180
    v_permlane32_swap_b32 v220, v224
    v_permlane32_swap_b32 v178, v182
    v_permlane32_swap_b32 v222, v226
    v_add_f32 v176, v176, v180
    v_add_f32 v220, v220, v224
    v_add_f32 v178, v178, v182
    v_add_f32 v222, v222, v226
    s_nop 0
    v_permlane16_swap_b32 v176, v178
    v_permlane16_swap_b32 v220, v222
    v_add_f32 v184, v184, v176
    v_add_f32 v228, v228, v220
    v_add_f32 v184, v184, v178
    v_add_f32 v228, v228, v222
    s_branch L_qback_34
L_qslow_35:
    v_max3_f32 v176, v16, v17, v18
    v_max3_f32 v220, v28, v29, v30
    v_max_f32 v176, v19, v176
    v_max_f32 v220, v31, v220
    v_max3_f32 v178, -v16, -v17, -v18
    v_max3_f32 v222, -v28, -v29, -v30
    v_max_f32 v178, -v19, v178
    v_max_f32 v222, -v31, v222
    v_max3_f32 v180, v20, v21, v22
    v_max3_f32 v224, v32, v33, v34
    v_max_f32 v180, v23, v180
    v_max_f32 v224, v35, v224
    v_max3_f32 v182, -v20, -v21, -v22
    v_max3_f32 v226, -v32, -v33, -v34
    v_max_f32 v182, -v23, v182
    v_max_f32 v226, -v35, v226
    v_max3_f32 v184, v24, v25, v26
    v_max3_f32 v228, v36, v37, v38
    v_max_f32 v184, v27, v184
    v_max_f32 v228, v39, v228
    v_permlane32_swap_b32 v176, v180
    v_permlane32_swap_b32 v220, v224
    v_permlane32_swap_b32 v178, v182
    v_permlane32_swap_b32 v222, v226
    v_max_f32 v176, v176, v180
    v_max_f32 v220, v220, v224
    v_max_f32 v178, v178, v182
    v_max_f32 v222, v222, v226
    s_nop 0
    v_permlane16_swap_b32 v176, v178
    v_permlane16_swap_b32 v220, v222
    v_max_f32 v184, v184, v176
    v_max_f32 v228, v228, v220
    v_max_f32 v184, v184, v178
    v_max_f32 v228, v228, v222
    v_mov_b32 v176, v184
    v_mov_b32 v220, v228
    v_mov_b32 v178, v184
    v_mov_b32 v222, v228
    s_nop 0
    v_permlane16_swap_b32 v176, v178
    v_permlane16_swap_b32 v220, v222
    v_mov_b32 v180, v176
    v_mov_b32 v224, v220
    v_mov_b32 v182, v178
    v_mov_b32 v226, v222
    v_permlane32_swap_b32 v176, v180
    v_permlane32_swap_b32 v220, v224
    v_permlane32_swap_b32 v178, v182
    v_permlane32_swap_b32 v222, v226
    v_sub_f32 v156, v16, v176
    v_sub_f32 v200, v28, v220
    v_sub_f32 v157, v17, v176
    v_sub_f32 v201, v29, v220
    v_sub_f32 v158, v18, v176
    v_sub_f32 v202, v30, v220
    v_sub_f32 v159, v19, v176
    v_sub_f32 v203, v31, v220
    v_sub_f32 v160, -v16, v178
    v_sub_f32 v204, -v28, v222
    v_sub_f32 v161, -v17, v178
    v_sub_f32 v205, -v29, v222
    v_sub_f32 v162, -v18, v178
    v_sub_f32 v206, -v30, v222
    v_sub_f32 v163, -v19, v178
    v_sub_f32 v207, -v31, v222
    v_sub_f32 v164, v20, v180
    v_sub_f32 v208, v32, v224
    v_sub_f32 v165, v21, v180
    v_sub_f32 v209, v33, v224
    v_sub_f32 v166, v22, v180
    v_sub_f32 v210, v34, v224
    v_sub_f32 v167, v23, v180
    v_sub_f32 v211, v35, v224
    v_sub_f32 v168, -v20, v182
    v_sub_f32 v212, -v32, v226
    v_sub_f32 v169, -v21, v182
    v_sub_f32 v213, -v33, v226
    v_sub_f32 v170, -v22, v182
    v_sub_f32 v214, -v34, v226
    v_sub_f32 v171, -v23, v182
    v_sub_f32 v215, -v35, v226
    v_sub_f32 v172, v24, v184
    v_sub_f32 v216, v36, v228
    v_sub_f32 v173, v25, v184
    v_sub_f32 v217, v37, v228
    v_sub_f32 v174, v26, v184
    v_sub_f32 v218, v38, v228
    v_sub_f32 v175, v27, v184
    v_sub_f32 v219, v39, v228
    v_exp_f32 v156, v156
    v_exp_f32 v200, v200
    v_exp_f32 v157, v157
    v_exp_f32 v201, v201
    v_exp_f32 v158, v158
    v_exp_f32 v202, v202
    v_exp_f32 v159, v159
    v_exp_f32 v203, v203
    v_exp_f32 v160, v160
    v_exp_f32 v204, v204
    v_exp_f32 v161, v161
    v_exp_f32 v205, v205
    v_exp_f32 v162, v162
    v_exp_f32 v206, v206
    v_exp_f32 v163, v163
    v_exp_f32 v207, v207
    v_exp_f32 v164, v164
    v_exp_f32 v208, v208
    v_exp_f32 v165, v165
    v_exp_f32 v209, v209
    v_exp_f32 v166, v166
    v_exp_f32 v210, v210
    v_exp_f32 v167, v167
    v_exp_f32 v211, v211
    v_exp_f32 v168, v168
    v_exp_f32 v212, v212
    v_exp_f32 v169, v169
    v_exp_f32 v213, v213
    v_exp_f32 v170, v170
    v_exp_f32 v214, v214
    v_exp_f32 v171, v171
    v_exp_f32 v215, v215
    v_exp_f32 v172, v172
    v_exp_f32 v216, v216
    v_exp_f32 v173, v173
    v_exp_f32 v217, v217
    v_exp_f32 v174, v174
    v_exp_f32 v218, v218
    v_exp_f32 v175, v175
    v_exp_f32 v219, v219
    v_pk_add_f32 v[176:177], v[156:157], v[158:159]
    v_pk_add_f32 v[220:221], v[200:201], v[202:203]
    v_pk_add_f32 v[178:179], v[160:161], v[162:163]
    v_pk_add_f32 v[222:223], v[204:205], v[206:207]
    v_pk_add_f32 v[180:181], v[164:165], v[166:167]
    v_pk_add_f32 v[224:225], v[208:209], v[210:211]
    v_pk_add_f32 v[182:183], v[168:169], v[170:171]
    v_pk_add_f32 v[226:227], v[212:213], v[214:215]
    v_pk_add_f32 v[184:185], v[172:173], v[174:175]
    v_pk_add_f32 v[228:229], v[216:217], v[218:219]
    v_add_f32 v176, v176, v177
    v_add_f32 v220, v220, v221
    v_add_f32 v178, v178, v179
    v_add_f32 v222, v222, v223
    v_add_f32 v180, v180, v181
    v_add_f32 v224, v224, v225
    v_add_f32 v182, v182, v183
    v_add_f32 v226, v226, v227
    v_add_f32 v184, v184, v185
    v_add_f32 v228, v228, v229
    v_permlane32_swap_b32 v176, v180
    v_permlane32_swap_b32 v220, v224
    v_permlane32_swap_b32 v178, v182
    v_permlane32_swap_b32 v222, v226
    v_add_f32 v176, v176, v180
    v_add_f32 v220, v220, v224
    v_add_f32 v178, v178, v182
    v_add_f32 v222, v222, v226
    s_nop 0
    v_permlane16_swap_b32 v176, v178
    v_permlane16_swap_b32 v220, v222
    v_add_f32 v184, v184, v176
    v_add_f32 v228, v228, v220
    v_add_f32 v184, v184, v178
    v_add_f32 v228, v228, v222
    s_branch L_qback_36
L_kslow_47:
    v_max3_f32 v17, v32, v33, v34
    v_min3_f32 v19, v32, v33, v34
    v_max3_f32 v17, v17, v35, v36
    v_min3_f32 v19, v19, v35, v36
    v_max3_f32 v17, v17, v37, v38
    v_min3_f32 v19, v19, v37, v38
    v_max3_f32 v17, v17, v39, v40
    v_min3_f32 v19, v19, v39, v40
    v_max3_f32 v17, v17, v41, v42
    v_min3_f32 v19, v19, v41, v42
    v_max3_f32 v17, v17, v43, v44
    v_min3_f32 v19, v19, v43, v44
    v_max3_f32 v17, v17, v45, v46
    v_min3_f32 v19, v19, v45, v46
    v_max3_f32 v17, v17, v47, v48
    v_min3_f32 v19, v19, v47, v48
    v_max3_f32 v17, v17, v49, v50
    v_min3_f32 v19, v19, v49, v50
    v_max_f32 v17, v17, v51
    v_min_f32 v19, v19, v51
    v_sub_f32 v112, v32, v17
    v_sub_f32 v132, v19, v32
    v_sub_f32 v113, v33, v17
    v_sub_f32 v133, v19, v33
    v_sub_f32 v114, v34, v17
    v_sub_f32 v134, v19, v34
    v_sub_f32 v115, v35, v17
    v_sub_f32 v135, v19, v35
    v_sub_f32 v116, v36, v17
    v_sub_f32 v136, v19, v36
    v_sub_f32 v117, v37, v17
    v_sub_f32 v137, v19, v37
    v_sub_f32 v118, v38, v17
    v_sub_f32 v138, v19, v38
    v_sub_f32 v119, v39, v17
    v_sub_f32 v139, v19, v39
    v_sub_f32 v120, v40, v17
    v_sub_f32 v140, v19, v40
    v_sub_f32 v121, v41, v17
    v_sub_f32 v141, v19, v41
    v_sub_f32 v122, v42, v17
    v_sub_f32 v142, v19, v42
    v_sub_f32 v123, v43, v17
    v_sub_f32 v143, v19, v43
    v_sub_f32 v124, v44, v17
    v_sub_f32 v144, v19, v44
    v_sub_f32 v125, v45, v17
    v_sub_f32 v145, v19, v45
    v_sub_f32 v126, v46, v17
    v_sub_f32 v146, v19, v46
    v_sub_f32 v127, v47, v17
    v_sub_f32 v147, v19, v47
    v_sub_f32 v128, v48, v17
    v_sub_f32 v148, v19, v48
    v_sub_f32 v129, v49, v17
    v_sub_f32 v149, v19, v49
    v_sub_f32 v130, v50, v17
    v_sub_f32 v150, v19, v50
    v_sub_f32 v131, v51, v17
    v_sub_f32 v151, v19, v51
    v_exp_f32 v112, v112
    v_exp_f32 v132, v132
    v_exp_f32 v113, v113
    v_exp_f32 v133, v133
    v_exp_f32 v114, v114
    v_exp_f32 v134, v134
    v_exp_f32 v115, v115
    v_exp_f32 v135, v135
    v_exp_f32 v116, v116
    v_exp_f32 v136, v136
    v_exp_f32 v117, v117
    v_exp_f32 v137, v137
    v_exp_f32 v118, v118
    v_exp_f32 v138, v138
    v_exp_f32 v119, v119
    v_exp_f32 v139, v139
    v_exp_f32 v120, v120
    v_exp_f32 v140, v140
    v_exp_f32 v121, v121
    v_exp_f32 v141, v141
    v_exp_f32 v122, v122
    v_exp_f32 v142, v142
    v_exp_f32 v123, v123
    v_exp_f32 v143, v143
    v_exp_f32 v124, v124
    v_exp_f32 v144, v144
    v_exp_f32 v125, v125
    v_exp_f32 v145, v145
    v_exp_f32 v126, v126
    v_exp_f32 v146, v146
    v_exp_f32 v127, v127
    v_exp_f32 v147, v147
    v_exp_f32 v128, v128
    v_exp_f32 v148, v148
    v_exp_f32 v129, v129
    v_exp_f32 v149, v149
    v_exp_f32 v130, v130
    v_exp_f32 v150, v150
    v_exp_f32 v131, v131
    v_exp_f32 v151, v151
    v_max3_f32 v17, v52, v53, v54
    v_min3_f32 v19, v52, v53, v54
    v_max3_f32 v17, v17, v55, v56
    v_min3_f32 v19, v19, v55, v56
    v_max3_f32 v17, v17, v57, v58
    v_min3_f32 v19, v19, v57, v58
    v_max3_f32 v17, v17, v59, v60
    v_min3_f32 v19, v19, v59, v60
    v_max3_f32 v17, v17, v61, v62
    v_min3_f32 v19, v19, v61, v62
    v_max3_f32 v17, v17, v63, v64
    v_min3_f32 v19, v19, v63, v64
    v_max3_f32 v17, v17, v65, v66
    v_min3_f32 v19, v19, v65, v66
    v_max3_f32 v17, v17, v67, v68
    v_min3_f32 v19, v19, v67, v68
    v_max3_f32 v17, v17, v69, v70
    v_min3_f32 v19, v19, v69, v70
    v_max_f32 v17, v17, v71
    v_min_f32 v19, v19, v71
    v_sub_f32 v72, v52, v17
    v_sub_f32 v92, v19, v52
    v_sub_f32 v73, v53, v17
    v_sub_f32 v93, v19, v53
    v_sub_f32 v74, v54, v17
    v_sub_f32 v94, v19, v54
    v_sub_f32 v75, v55, v17
    v_sub_f32 v95, v19, v55
    v_sub_f32 v76, v56, v17
    v_sub_f32 v96, v19, v56
    v_sub_f32 v77, v57, v17
    v_sub_f32 v97, v19, v57
    v_sub_f32 v78, v58, v17
    v_sub_f32 v98, v19, v58
    v_sub_f32 v79, v59, v17
    v_sub_f32 v99, v19, v59
    v_sub_f32 v80, v60, v17
    v_sub_f32 v100, v19, v60
    v_sub_f32 v81, v61, v17
    v_sub_f32 v101, v19, v61
    v_sub_f32 v82, v62, v17
    v_sub_f32 v102, v19, v62
    v_sub_f32 v83, v63, v17
    v_sub_f32 v103, v19, v63
    v_sub_f32 v84, v64, v17
    v_sub_f32 v104, v19, v64
    v_sub_f32 v85, v65, v17
    v_sub_f32 v105, v19, v65
    v_sub_f32 v86, v66, v17
    v_sub_f32 v106, v19, v66
    v_sub_f32 v87, v67, v17
    v_sub_f32 v107, v19, v67
    v_sub_f32 v88, v68, v17
    v_sub_f32 v108, v19, v68
    v_sub_f32 v89, v69, v17
    v_sub_f32 v109, v19, v69
    v_sub_f32 v90, v70, v17
    v_sub_f32 v110, v19, v70
    v_sub_f32 v91, v71, v17
    v_sub_f32 v111, v19, v71
    v_exp_f32 v72, v72
    v_exp_f32 v92, v92
    v_exp_f32 v73, v73
    v_exp_f32 v93, v93
    v_exp_f32 v74, v74
    v_exp_f32 v94, v94
    v_exp_f32 v75, v75
    v_exp_f32 v95, v95
    v_exp_f32 v76, v76
    v_exp_f32 v96, v96
    v_exp_f32 v77, v77
    v_exp_f32 v97, v97
    v_exp_f32 v78, v78
    v_exp_f32 v98, v98
    v_exp_f32 v79, v79
    v_exp_f32 v99, v99
    v_exp_f32 v80, v80
    v_exp_f32 v100, v100
    v_exp_f32 v81, v81
    v_exp_f32 v101, v101
    v_exp_f32 v82, v82
    v_exp_f32 v102, v102
    v_exp_f32 v83, v83
    v_exp_f32 v103, v103
    v_exp_f32 v84, v84
    v_exp_f32 v104, v104
    v_exp_f32 v85, v85
    v_exp_f32 v105, v105
    v_exp_f32 v86, v86
    v_exp_f32 v106, v106
    v_exp_f32 v87, v87
    v_exp_f32 v107, v107
    v_exp_f32 v88, v88
    v_exp_f32 v108, v108
    v_exp_f32 v89, v89
    v_exp_f32 v109, v109
    v_exp_f32 v90, v90
    v_exp_f32 v110, v110
    v_exp_f32 v91, v91
    v_exp_f32 v111, v111
    v_pk_add_f32 v[16:17], v[112:113], v[114:115]
    v_pk_add_f32 v[18:19], v[132:133], v[134:135]
    v_pk_add_f32 v[16:17], v[16:17], v[116:117]
    v_pk_add_f32 v[18:19], v[18:19], v[136:137]
    v_pk_add_f32 v[16:17], v[16:17], v[118:119]
    v_pk_add_f32 v[18:19], v[18:19], v[138:139]
    v_pk_add_f32 v[16:17], v[16:17], v[120:121]
    v_pk_add_f32 v[18:19], v[18:19], v[140:141]
    v_pk_add_f32 v[16:17], v[16:17], v[122:123]
    v_pk_add_f32 v[18:19], v[18:19], v[142:143]
    v_pk_add_f32 v[16:17], v[16:17], v[124:125]
    v_pk_add_f32 v[18:19], v[18:19], v[144:145]
    v_pk_add_f32 v[16:17], v[16:17], v[126:127]
    v_pk_add_f32 v[18:19], v[18:19], v[146:147]
    v_pk_add_f32 v[16:17], v[16:17], v[128:129]
    v_pk_add_f32 v[18:19], v[18:19], v[148:149]
    v_pk_add_f32 v[16:17], v[16:17], v[130:131]
    v_pk_add_f32 v[18:19], v[18:19], v[150:151]
    v_add_f32 v16, v16, v17
    v_add_f32 v18, v18, v19
    v_pk_add_f32 v[20:21], v[72:73], v[74:75]
    v_pk_add_f32 v[22:23], v[92:93], v[94:95]
    v_pk_add_f32 v[20:21], v[20:21], v[76:77]
    v_pk_add_f32 v[22:23], v[22:23], v[96:97]
    v_pk_add_f32 v[20:21], v[20:21], v[78:79]
    v_pk_add_f32 v[22:23], v[22:23], v[98:99]
    v_pk_add_f32 v[20:21], v[20:21], v[80:81]
    v_pk_add_f32 v[22:23], v[22:23], v[100:101]
    v_pk_add_f32 v[20:21], v[20:21], v[82:83]
    v_pk_add_f32 v[22:23], v[22:23], v[102:103]
    v_pk_add_f32 v[20:21], v[20:21], v[84:85]
    v_pk_add_f32 v[22:23], v[22:23], v[104:105]
    v_pk_add_f32 v[20:21], v[20:21], v[86:87]
    v_pk_add_f32 v[22:23], v[22:23], v[106:107]
    v_pk_add_f32 v[20:21], v[20:21], v[88:89]
    v_pk_add_f32 v[22:23], v[22:23], v[108:109]
    v_pk_add_f32 v[20:21], v[20:21], v[90:91]
    v_pk_add_f32 v[22:23], v[22:23], v[110:111]
    v_add_f32 v20, v20, v21
    v_add_f32_e64 v22, v22, v23
    s_branch L_kback_48
L_fredo:
    s_cmp_lg_u32 s38, 0
    s_cbranch_scc1 L_fok
    s_mov_b64 exec, 1
    s_mov_b32 s27, 0
L_poll_76:
    global_atomic_add v18, v17, v19, s[20:21] sc0 sc1
    s_waitcnt vmcnt(0)
    v_cmp_ne_u32 vcc, 0x44444444, v18
    s_nop 0
    s_cbranch_vccz L_polled_77
    s_add_u32 s27, s27, 1
    s_cmp_lt_u32 s27, 262144
    s_cbranch_scc1 L_poll_76
L_polled_77:
    s_mov_b32 s38, 1
    s_movk_i32 s52, 0x0404
    s_branch L_fagain
.section .rodata,"a"
.p2align 6
.amdhsa_kernel gated_mix__ssm_conv_s4d__linear_kernel_hedgehog__prompt_kernel
  .amdhsa_next_free_vgpr 256
  .amdhsa_next_free_sgpr 102
  .amdhsa_accum_offset 256
  .amdhsa_group_segment_fixed_size 0
  .amdhsa_kernarg_size 120
  .amdhsa_user_sgpr_count 2
  .amdhsa_user_sgpr_kernarg_segment_ptr 1
  .amdhsa_system_sgpr_workgroup_id_x 1
  .amdhsa_float_denorm_mode_32 3
.end_amdhsa_kernel
.text
```
